```python
import torch

def _softmax(x, axis=-1):
    return torch.softmax(x, dim=axis)
def _gelu(x):
    return torch.nn.functional.gelu(x, approximate="tanh")
def _silu(x):
    return torch.nn.functional.silu(x)
def _sigmoid(x):
    return torch.sigmoid(x)
def _layernorm(x, axis=-1, eps=1e-5):
    m = x.mean(dim=axis, keepdim=True)
    v = x.var(dim=axis, keepdim=True, unbiased=False)
    return (x - m) / torch.sqrt(v + eps)
def _scatter_add(tgt, idx, src, axis=0):
    return tgt.clone().index_add_(axis, idx, src)
def _segment_sum(src, seg, n):
    out = torch.zeros((n,) + src.shape[1:], dtype=src.dtype)
    return out.index_add_(0, seg, src)
def _pad(x, pw):
    flat = tuple(v for pair in reversed(pw) for v in pair)
    return torch.nn.functional.pad(x, flat)

kernel_name = 'standalone__gqa_block_cached__near_ridge'

def setup_inputs():

    _w = (lambda a: (lambda t: t.to(torch.bfloat16) if t.is_floating_point() else t)(torch.as_tensor(a)))
    B, Sq, D = 16, 224, 512
    Hq, Hkv, Sk, Dh = 32, 32, 512, 128
    assert Hq % Hkv == 0, (Hq, Hkv)
    return {
        "x": _w((lambda *s: torch.randn(*s, dtype=torch.bfloat16) * 0.8)(B, Sq, D)),
        "k_cache": _w((lambda *s: torch.randn(*s, dtype=torch.bfloat16) * 0.8)(B, Hkv, Sk, Dh)),
        "v_cache": _w((lambda *s: torch.randn(*s, dtype=torch.bfloat16) * 0.05)(B, Hkv, Sk, Dh)),
        "wq": _w((lambda *s: torch.randn(*s, dtype=torch.bfloat16) * 0.8)(D, Hq * Dh) * (D ** -0.5)),
        "wo": _w((lambda *s: torch.randn(*s, dtype=torch.bfloat16) * 0.05)(Hq * Dh, D) * ((Hq * Dh) ** -0.5)),
    }

def reference(x, k_cache, v_cache, wq, wo):
    B, Sq, D = x.shape
    Hq, Dh = 32, 128
    Hkv = k_cache.shape[1]
    rep = Hq // Hkv
    q = (lambda x, *d: x.permute(*d))((x @ wq).reshape(B, Sq, Hq, Dh), 0, 2, 1, 3)
    k = (lambda x, n, axis: torch.repeat_interleave(x, n, dim=axis))(k_cache, rep, axis=1)
    v = (lambda x, n, axis: torch.repeat_interleave(x, n, dim=axis))(v_cache, rep, axis=1)
    scores = torch.einsum("bhqd,bhkd->bhqk", q, k) * (Dh ** -0.5)
    p = _softmax(scores, axis=-1)
    o = torch.einsum("bhqk,bhkd->bhqd", p, v)
    return (lambda x, *d: x.permute(*d))(o, 0, 2, 1, 3).reshape(B, Sq, Hq * Dh) @ wo
```

```asm
; @launch grid=(256,1,1) block=(256,1,1) lds=163840
.amdgcn_target "amdgcn-amd-amdhsa--gfx950"
.text
.globl standalone__gqa_block_cached__near_ridge_kernel
.p2align 8
.type standalone__gqa_block_cached__near_ridge_kernel,@function
standalone__gqa_block_cached__near_ridge_kernel:
    s_cmp_ge_u32 s2, 256
    s_cbranch_scc1 L_end
    s_load_dwordx4 s[32:35], s[0:1], 0
    s_load_dwordx4 s[36:39], s[0:1], 16
    s_load_dwordx2 s[40:41], s[0:1], 32
    s_load_dwordx2 s[42:43], s[0:1], 56
    s_load_dwordx4 s[64:67], s[0:1], 40
    v_lshrrev_b32 v1, 6, v0
    v_and_b32 v0, 63, v0
    v_readfirstlane_b32 s4, v1
    s_and_b32 s3, s2, 7
    s_lshl_b32 s3, s3, 1
    s_bfe_u32 s5, s2, 65539
    s_or_b32 s5, s5, s3
    s_bfe_u32 s6, s2, 65540
    s_lshr_b32 s7, s2, 5
    v_lshrrev_b32 v23, 4, v0
    v_and_b32 v31, 15, v0
    v_lshlrev_b32 v24, 2, v23
    v_xor_b32 v24, v24, v31
    v_lshlrev_b32 v24, 4, v24
    v_lshl_add_u32 v1, v23, 13, v24
    v_add_u32 v2, 31744, v1
    v_add_u32 v3, 63488, v1
    v_add_u32 v4, 95232, v1
    v_lshrrev_b32 v24, 3, v0
    v_and_b32 v25, 6, v24
    v_and_b32 v26, 7, v0
    v_xor_b32 v25, v25, v26
    v_lshlrev_b32 v25, 4, v25
    v_lshl_add_u32 v5, v24, 10, v25
    s_cmp_eq_u32 s7, 7
    s_cselect_b32 s95, 0, s7
    s_lshl_b32 s3, s4, 1
    s_add_u32 s3, s3, s95
    s_add_u32 s57, s3, 1
    s_sub_u32 s58, s57, 7
    s_cmp_ge_u32 s57, 7
    s_cselect_b32 s57, s58, s57
    s_lshl_b32 s57, s57, 14
    s_add_u32 s57, s57, 2048
    v_add_u32 v7, s57, v5
    v_add_u32 v8, 7168, v7
    s_add_u32 s57, s3, 0
    s_sub_u32 s58, s57, 7
    s_cmp_ge_u32 s57, 7
    s_cselect_b32 s57, s58, s57
    s_lshl_b32 s57, s57, 14
    s_add_u32 s57, s57, 4096
    v_add_u32 v5, s57, v5
    v_add_u32 v6, 7168, v5
    s_cmp_eq_u32 s4, 3
    s_cselect_b32 s3, 0x40000000, 0
    v_add_u32 v7, s3, v7
    v_add_u32 v8, s3, v8
    s_lshl_b32 s48, s4, 15
    s_lshl_b32 s3, s4, 12
    s_add_u32 s56, s3, 131072
    s_lshl_b32 s3, s7, 2
    s_add_u32 s57, s3, s4
    s_lshl_b32 s49, s57, 8
    s_mul_i32 s3, s5, 224
    s_mul_i32 s50, s6, 112
    s_add_u32 s50, s50, s3
    s_lshl_b32 s50, s50, 10
    s_lshl_b32 s3, s5, 5
    s_add_u32 s3, s3, s57
    s_lshl_b32 s46, s3, 17
    s_mov_b32 s3, s5
    s_and_b32 s3, s3, 7
    s_lshl_b32 s98, s3, 7
    s_mov_b32 s99, s50
    s_add_u32 s50, s99, s98
    s_lshl_b32 s3, s3, 19
    s_add_u32 s49, s49, s3
    s_waitcnt lgkmcnt(0)
    s_sub_u32 s32, s32, 4096
    s_subb_u32 s33, s33, 0
    s_mov_b32 s8, s32
    s_and_b32 s9, s33, 65535
    s_mov_b32 s10, 3674112
    s_mov_b32 s11, 131072
    s_mov_b32 s12, s38
    s_and_b32 s13, s39, 65535
    s_mov_b32 s14, 4194304
    s_mov_b32 s15, 131072
    s_add_u32 m0, s56, 0
    s_nop 0
    buffer_load_dwordx4 v5, s[8:11], s50 offen offset:0 lds
    buffer_load_dwordx4 v6, s[8:11], s50 offen offset:1024 lds
    buffer_load_dwordx4 v7, s[8:11], s50 offen offset:2048 lds
    buffer_load_dwordx4 v8, s[8:11], s50 offen offset:3072 lds
    s_add_u32 s98, s98, 128
    s_and_b32 s98, s98, 1023
    s_add_u32 s50, s99, s98
    s_add_u32 m0, s48, 0
    s_nop 0
    buffer_load_dwordx4 v1, s[12:15], s49 offen offset:0 lds
    buffer_load_dwordx4 v2, s[12:15], s49 offen offset:1024 lds
    buffer_load_dwordx4 v3, s[12:15], s49 offen offset:2048 lds
    buffer_load_dwordx4 v4, s[12:15], s49 offen offset:3072 lds
    s_add_u32 s49, s49, 131072
    s_and_b32 s49, s49, 4194303
    s_add_u32 m0, s48, 4096
    s_nop 0
    buffer_load_dwordx4 v1, s[12:15], s49 offen offset:0 lds
    buffer_load_dwordx4 v2, s[12:15], s49 offen offset:1024 lds
    buffer_load_dwordx4 v3, s[12:15], s49 offen offset:2048 lds
    buffer_load_dwordx4 v4, s[12:15], s49 offen offset:3072 lds
    s_add_u32 s49, s49, 131072
    s_and_b32 s49, s49, 4194303
    s_add_u32 s16, s34, s46
    s_addc_u32 s17, s35, 0
    s_and_b32 s17, s17, 65535
    s_mov_b32 s18, 131072
    s_mov_b32 s19, 131072
    s_add_u32 s20, s36, s46
    s_addc_u32 s21, s37, 0
    s_and_b32 s21, s21, 65535
    s_mov_b32 s22, 131072
    s_mov_b32 s23, 131072
    s_mov_b32 s24, s40
    s_and_b32 s25, s41, 65535
    s_mov_b32 s26, 4194304
    s_mov_b32 s27, 131072
    s_mov_b32 s28, s42
    s_and_b32 s29, s43, 65535
    s_mov_b32 s30, 58720256
    s_mov_b32 s31, 131072
    s_add_u32 m0, s48, 8192
    s_nop 0
    buffer_load_dwordx4 v1, s[12:15], s49 offen offset:0 lds
    buffer_load_dwordx4 v2, s[12:15], s49 offen offset:1024 lds
    buffer_load_dwordx4 v3, s[12:15], s49 offen offset:2048 lds
    buffer_load_dwordx4 v4, s[12:15], s49 offen offset:3072 lds
    s_add_u32 s49, s49, 131072
    s_and_b32 s49, s49, 4194303
    s_add_u32 m0, s48, 12288
    s_nop 0
    buffer_load_dwordx4 v1, s[12:15], s49 offen offset:0 lds
    buffer_load_dwordx4 v2, s[12:15], s49 offen offset:1024 lds
    buffer_load_dwordx4 v3, s[12:15], s49 offen offset:2048 lds
    buffer_load_dwordx4 v4, s[12:15], s49 offen offset:3072 lds
    s_add_u32 s49, s49, 131072
    s_and_b32 s49, s49, 4194303
    s_add_u32 m0, s56, 16384
    s_nop 0
    buffer_load_dwordx4 v5, s[8:11], s50 offen offset:0 lds
    buffer_load_dwordx4 v6, s[8:11], s50 offen offset:1024 lds
    buffer_load_dwordx4 v7, s[8:11], s50 offen offset:2048 lds
    buffer_load_dwordx4 v8, s[8:11], s50 offen offset:3072 lds
    s_add_u32 s98, s98, 128
    s_and_b32 s98, s98, 1023
    s_add_u32 s50, s99, s98
    s_add_u32 m0, s48, 16384
    s_nop 0
    buffer_load_dwordx4 v1, s[12:15], s49 offen offset:0 lds
    buffer_load_dwordx4 v2, s[12:15], s49 offen offset:1024 lds
    buffer_load_dwordx4 v3, s[12:15], s49 offen offset:2048 lds
    buffer_load_dwordx4 v4, s[12:15], s49 offen offset:3072 lds
    s_add_u32 s49, s49, 131072
    s_and_b32 s49, s49, 4194303
    s_add_u32 m0, s48, 20480
    s_nop 0
    buffer_load_dwordx4 v1, s[12:15], s49 offen offset:0 lds
    buffer_load_dwordx4 v2, s[12:15], s49 offen offset:1024 lds
    buffer_load_dwordx4 v3, s[12:15], s49 offen offset:2048 lds
    buffer_load_dwordx4 v4, s[12:15], s49 offen offset:3072 lds
    s_add_u32 s49, s49, 131072
    s_and_b32 s49, s49, 4194303
    v_lshrrev_b32 v29, 1, v0
    v_lshlrev_b32 v29, 10, v29
    v_and_b32 v28, 1, v0
    v_lshl_add_u32 v29, v28, 7, v29
    s_and_b32 s3, s5, 7
    s_lshl_b32 s3, s3, 1
    s_add_u32 s3, s3, s6
    s_lshl_b32 s47, s3, 15
    s_lshl_b32 s3, s7, 19
    s_add_u32 s47, s47, s3
    s_lshl_b32 s3, s4, 8
    s_add_u32 s47, s47, s3
    buffer_load_dword v30, v29, s[24:27], s47 offen offset:0
    s_add_u32 s36, s42, 62914560
    s_addc_u32 s37, s43, 0
    s_and_b32 s37, s37, 65535
    s_mov_b32 s38, 131072
    s_mov_b32 s39, 131072
    s_mov_b32 s40, s66
    s_and_b32 s41, s67, 65535
    s_mov_b32 s42, 256
    s_mov_b32 s43, 131072
    s_lshl_b32 s44, s5, 1
    s_add_u32 s44, s44, s6
    s_lshl_b32 s3, s44, 12
    s_lshl_b32 s57, s7, 2
    s_add_u32 s3, s3, s57
    s_cmp_eq_u32 s4, 0
    s_cselect_b32 s45, s3, 0x40000000
    v_cmp_eq_u32 vcc, 0, v0
    v_mov_b32 v24, 1073741824
    v_mov_b32 v25, 0
    v_mov_b32 v29, 0
    v_cndmask_b32 v28, v24, 0, vcc
    buffer_store_dword v25, v28, s[36:39], s45 offen offset:0 sc1
    s_nop 1
    v_lshrrev_b32 v24, 2, v31
    v_and_b32 v25, 3, v31
    v_lshlrev_b32 v26, 11, v23
    v_lshl_add_u32 v26, v24, 8, v26
    v_add_u32 v26, s48, v26
    v_lshl_add_u32 v26, v25, 4, v26
    v_xor_b32 v27, 0, v24
    v_lshl_add_u32 v9, v27, 6, v26
    v_xor_b32 v27, 1, v24
    v_lshl_add_u32 v10, v27, 6, v26
    v_xor_b32 v27, 2, v24
    v_lshl_add_u32 v11, v27, 6, v26
    v_xor_b32 v27, 3, v24
    v_lshl_add_u32 v12, v27, 6, v26
    v_and_b32 v24, 6, v31
    v_xor_b32 v24, v24, v23
    v_lshlrev_b32 v25, 7, v31
    v_add_u32 v25, 131072, v25
    v_lshl_add_u32 v13, v24, 4, v25
    v_xor_b32 v14, 64, v13
    v_xor_b32 v24, v23, v31
    v_lshlrev_b32 v24, 4, v24
    v_lshl_add_u32 v15, v23, 8, v24
    v_xor_b32 v16, 64, v15
    v_xor_b32 v17, 128, v15
    v_xor_b32 v18, 192, v15
    v_lshlrev_b32 v24, 1, v23
    v_xor_b32 v24, v24, v31
    v_lshlrev_b32 v24, 4, v24
    v_lshl_add_u32 v19, v23, 8, v24
    v_xor_b32 v20, 128, v19
    s_mov_b32 s51, 0
    s_mov_b32 s52, 0
    s_mov_b32 s60, 0
    s_mov_b32 s54, 1040356334
    s_mov_b32 s63, 1199570944
    v_mov_b32 v32, 0
    v_mov_b32 v33, 0
    v_mov_b32 v34, 0
    v_mov_b32 v35, 0
    v_mov_b32 v36, 0
    v_mov_b32 v37, 0
    v_mov_b32 v38, 0
    v_mov_b32 v39, 0
    v_mov_b32 v40, 0
    v_mov_b32 v41, 0
    v_mov_b32 v42, 0
    v_mov_b32 v43, 0
    v_mov_b32 v44, 0
    v_mov_b32 v45, 0
    v_mov_b32 v46, 0
    v_mov_b32 v47, 0
    v_mov_b32 v48, 0
    v_mov_b32 v49, 0
    v_mov_b32 v50, 0
    v_mov_b32 v51, 0
    v_mov_b32 v52, 0
    v_mov_b32 v53, 0
    v_mov_b32 v54, 0
    v_mov_b32 v55, 0
    v_mov_b32 v56, 0
    v_mov_b32 v57, 0
    v_mov_b32 v58, 0
    v_mov_b32 v59, 0
    v_mov_b32 v60, 0
    v_mov_b32 v61, 0
    v_mov_b32 v62, 0
    v_mov_b32 v63, 0
    v_mov_b32 v64, 0
    v_mov_b32 v65, 0
    v_mov_b32 v66, 0
    v_mov_b32 v67, 0
    v_mov_b32 v68, 0
    v_mov_b32 v69, 0
    v_mov_b32 v70, 0
    v_mov_b32 v71, 0
    v_mov_b32 v72, 0
    v_mov_b32 v73, 0
    v_mov_b32 v74, 0
    v_mov_b32 v75, 0
    v_mov_b32 v76, 0
    v_mov_b32 v77, 0
    v_mov_b32 v78, 0
    v_mov_b32 v79, 0
    v_mov_b32 v80, 0
    v_mov_b32 v81, 0
    v_mov_b32 v82, 0
    v_mov_b32 v83, 0
    v_mov_b32 v84, 0
    v_mov_b32 v85, 0
    v_mov_b32 v86, 0
    v_mov_b32 v87, 0
    v_mov_b32 v88, 0
    v_mov_b32 v89, 0
    v_mov_b32 v90, 0
    v_mov_b32 v91, 0
    v_mov_b32 v92, 0
    v_mov_b32 v93, 0
    v_mov_b32 v94, 0
    v_mov_b32 v95, 0
    v_mov_b32 v96, 0
    v_mov_b32 v97, 0
    v_mov_b32 v98, 0
    v_mov_b32 v99, 0
    v_mov_b32 v100, 0
    v_mov_b32 v101, 0
    v_mov_b32 v102, 0
    v_mov_b32 v103, 0
    v_mov_b32 v104, 0
    v_mov_b32 v105, 0
    v_mov_b32 v106, 0
    v_mov_b32 v107, 0
    v_mov_b32 v108, 0
    v_mov_b32 v109, 0
    v_mov_b32 v110, 0
    v_mov_b32 v111, 0
    v_mov_b32 v112, 0
    v_mov_b32 v113, 0
    v_mov_b32 v114, 0
    v_mov_b32 v115, 0
    v_mov_b32 v116, 0
    v_mov_b32 v117, 0
    v_mov_b32 v118, 0
    v_mov_b32 v119, 0
    v_mov_b32 v120, 0
    v_mov_b32 v121, 0
    v_mov_b32 v122, 0
    v_mov_b32 v123, 0
    v_mov_b32 v124, 0
    v_mov_b32 v125, 0
    v_mov_b32 v126, 0
    v_mov_b32 v127, 0
    v_mov_b32 v128, 0
    v_mov_b32 v129, 0
    v_mov_b32 v130, 0
    v_mov_b32 v131, 0
    v_mov_b32 v132, 0
    v_mov_b32 v133, 0
    v_mov_b32 v134, 0
    v_mov_b32 v135, 0
    v_mov_b32 v136, 0
    v_mov_b32 v137, 0
    v_mov_b32 v138, 0
    v_mov_b32 v139, 0
    v_mov_b32 v140, 0
    v_mov_b32 v141, 0
    v_mov_b32 v142, 0
    v_mov_b32 v143, 0
    v_mov_b32 v144, 0
    v_mov_b32 v145, 0
    v_mov_b32 v146, 0
    v_mov_b32 v147, 0
    v_mov_b32 v148, 0
    v_mov_b32 v149, 0
    v_mov_b32 v150, 0
    v_mov_b32 v151, 0
    v_mov_b32 v152, 0
    v_mov_b32 v153, 0
    v_mov_b32 v154, 0
    v_mov_b32 v155, 0
    v_mov_b32 v156, 0
    v_mov_b32 v157, 0
    v_mov_b32 v158, 0
    v_mov_b32 v159, 0
    v_mov_b32 v160, 0
    v_mov_b32 v161, 0
    v_mov_b32 v162, 0
    v_mov_b32 v163, 0
    v_mov_b32 v164, 0
    v_mov_b32 v165, 0
    v_mov_b32 v166, 0
    v_mov_b32 v167, 0
    v_mov_b32 v168, 0
    v_mov_b32 v169, 0
    v_mov_b32 v170, 0
    v_mov_b32 v171, 0
    v_mov_b32 v172, 0
    v_mov_b32 v173, 0
    v_mov_b32 v174, 0
    v_mov_b32 v175, 0
    v_mov_b32 v176, 0
    v_mov_b32 v177, 0
    v_mov_b32 v178, 0
    v_mov_b32 v179, 0
    v_mov_b32 v180, 0
    v_mov_b32 v181, 0
    v_mov_b32 v182, 0
    v_mov_b32 v183, 0
    v_mov_b32 v184, 0
    v_mov_b32 v185, 0
    v_mov_b32 v186, 0
    v_mov_b32 v187, 0
    v_mov_b32 v188, 0
    v_mov_b32 v189, 0
    v_mov_b32 v190, 0
    v_mov_b32 v191, 0
    v_mov_b32 v192, 0
    v_mov_b32 v193, 0
    v_mov_b32 v194, 0
    v_mov_b32 v195, 0
    v_mov_b32 v196, 0
    v_mov_b32 v197, 0
    v_mov_b32 v198, 0
    v_mov_b32 v199, 0
    v_mov_b32 v200, 0
    v_mov_b32 v201, 0
    v_mov_b32 v202, 0
    v_mov_b32 v203, 0
    v_mov_b32 v204, 0
    v_mov_b32 v205, 0
    v_mov_b32 v206, 0
    v_mov_b32 v207, 0
    v_mov_b32 v208, 0
    v_mov_b32 v209, 0
    v_mov_b32 v210, 0
    v_mov_b32 v211, 0
    v_mov_b32 v212, 0
    v_mov_b32 v213, 0
    v_mov_b32 v214, 0
    v_mov_b32 v215, 0
    v_mov_b32 v216, 0
    v_mov_b32 v217, 0
    v_mov_b32 v218, 0
    v_mov_b32 v219, 0
    v_mov_b32 v220, 0
    v_mov_b32 v221, 0
    v_mov_b32 v222, 0
    v_mov_b32 v223, 0
    v_mov_b32 v224, 0
    v_mov_b32 v225, 0
    v_mov_b32 v226, 0
    v_mov_b32 v227, 0
    v_mov_b32 v228, 0
    v_mov_b32 v229, 0
    v_mov_b32 v230, 0
    v_mov_b32 v231, 0
    v_mov_b32 v232, 0
    v_mov_b32 v233, 0
    v_mov_b32 v234, 0
    v_mov_b32 v235, 0
    v_mov_b32 v236, 0
    v_mov_b32 v237, 0
    v_mov_b32 v238, 0
    v_mov_b32 v239, 0
    v_mov_b32 v240, 0
    v_mov_b32 v241, 0
    v_mov_b32 v242, 0
    v_mov_b32 v243, 0
    v_mov_b32 v244, 0
    v_mov_b32 v245, 0
    v_mov_b32 v246, 0
    v_mov_b32 v247, 0
    v_mov_b32 v248, 0
    v_mov_b32 v249, 0
    v_mov_b32 v250, 0
    v_mov_b32 v251, 0
    v_mov_b32 v252, 0
    v_mov_b32 v253, 0
    v_mov_b32 v254, 0
    v_mov_b32 v255, 0
    s_waitcnt vmcnt(30)
    s_barrier
    s_waitcnt vmcnt(22)
    ds_read_b128 a[228:231], v13 offset:0
    ds_read_b128 a[232:235], v13 offset:2048
    ds_read_b128 a[236:239], v13 offset:4096
    ds_read_b128 a[240:243], v13 offset:6144
    ds_read_b128 a[244:247], v13 offset:8192
    ds_read_b128 a[248:251], v13 offset:10240
    ds_read_b128 a[252:255], v13 offset:12288
    ds_read_b64_tr_b16 a[196:197], v9 offset:0
    ds_read_b64_tr_b16 a[198:199], v9 offset:1024
    ds_read_b64_tr_b16 a[200:201], v9 offset:8
    ds_read_b64_tr_b16 a[202:203], v9 offset:1032
    ds_read_b64_tr_b16 a[204:205], v10 offset:0
    ds_read_b64_tr_b16 a[206:207], v10 offset:1024
    ds_read_b64_tr_b16 a[208:209], v10 offset:8
    ds_read_b64_tr_b16 a[210:211], v10 offset:1032
    s_waitcnt lgkmcnt(0)
    s_mov_b32 s55, 2
L_A:
    v_mfma_f32_16x16x32_bf16 v[32:35], a[196:199], a[228:231], v[32:35]
    s_add_u32 m0, s48, 24576
    v_mfma_f32_16x16x32_bf16 v[36:39], a[200:203], a[228:231], v[36:39]
    buffer_load_dwordx4 v1, s[12:15], s49 offen offset:0 lds
    v_mfma_f32_16x16x32_bf16 v[40:43], a[204:207], a[228:231], v[40:43]
    v_mfma_f32_16x16x32_bf16 v[44:47], a[208:211], a[228:231], v[44:47]
    v_mfma_f32_16x16x32_bf16 v[64:67], a[196:199], a[232:235], v[64:67]
    s_waitcnt vmcnt(22)
    v_mfma_f32_16x16x32_bf16 v[68:71], a[200:203], a[232:235], v[68:71]
    v_mfma_f32_16x16x32_bf16 v[72:75], a[204:207], a[232:235], v[72:75]
    ds_read_b64_tr_b16 a[212:213], v11 offset:0
    v_mfma_f32_16x16x32_bf16 v[76:79], a[208:211], a[232:235], v[76:79]
    buffer_load_dwordx4 v2, s[12:15], s49 offen offset:1024 lds
    v_mfma_f32_16x16x32_bf16 v[96:99], a[196:199], a[236:239], v[96:99]
    s_waitcnt lgkmcnt(1)
    ds_read_b64_tr_b16 a[214:215], v11 offset:1024
    v_mfma_f32_16x16x32_bf16 v[100:103], a[200:203], a[236:239], v[100:103]
    v_mfma_f32_16x16x32_bf16 v[104:107], a[204:207], a[236:239], v[104:107]
    ds_read_b64_tr_b16 a[216:217], v11 offset:8
    v_mfma_f32_16x16x32_bf16 v[108:111], a[208:211], a[236:239], v[108:111]
    v_mfma_f32_16x16x32_bf16 v[128:131], a[196:199], a[240:243], v[128:131]
    ds_read_b64_tr_b16 a[218:219], v11 offset:1032
    v_mfma_f32_16x16x32_bf16 v[132:135], a[200:203], a[240:243], v[132:135]
    buffer_load_dwordx4 v3, s[12:15], s49 offen offset:2048 lds
    v_mfma_f32_16x16x32_bf16 v[136:139], a[204:207], a[240:243], v[136:139]
    ds_read_b64_tr_b16 a[220:221], v12 offset:0
    v_mfma_f32_16x16x32_bf16 v[140:143], a[208:211], a[240:243], v[140:143]
    v_mfma_f32_16x16x32_bf16 v[160:163], a[196:199], a[244:247], v[160:163]
    ds_read_b64_tr_b16 a[222:223], v12 offset:1024
    v_mfma_f32_16x16x32_bf16 v[164:167], a[200:203], a[244:247], v[164:167]
    v_mfma_f32_16x16x32_bf16 v[168:171], a[204:207], a[244:247], v[168:171]
    ds_read_b64_tr_b16 a[224:225], v12 offset:8
    v_mfma_f32_16x16x32_bf16 v[172:175], a[208:211], a[244:247], v[172:175]
    buffer_load_dwordx4 v4, s[12:15], s49 offen offset:3072 lds
    v_mfma_f32_16x16x32_bf16 v[192:195], a[196:199], a[248:251], v[192:195]
    ds_read_b64_tr_b16 a[226:227], v12 offset:1032
    v_mfma_f32_16x16x32_bf16 v[196:199], a[200:203], a[248:251], v[196:199]
    s_add_u32 s49, s49, 131072
    s_and_b32 s49, s49, 4194303
    v_mfma_f32_16x16x32_bf16 v[200:203], a[204:207], a[248:251], v[200:203]
    v_mfma_f32_16x16x32_bf16 v[204:207], a[208:211], a[248:251], v[204:207]
    s_add_u32 m0, s48, 28672
    v_mfma_f32_16x16x32_bf16 v[224:227], a[196:199], a[252:255], v[224:227]
    v_mfma_f32_16x16x32_bf16 v[228:231], a[200:203], a[252:255], v[228:231]
    buffer_load_dwordx4 v1, s[12:15], s49 offen offset:0 lds
    v_mfma_f32_16x16x32_bf16 v[232:235], a[204:207], a[252:255], v[232:235]
    s_waitcnt lgkmcnt(0)
    v_mfma_f32_16x16x32_bf16 v[236:239], a[208:211], a[252:255], v[236:239]
    v_mfma_f32_16x16x32_bf16 v[48:51], a[212:215], a[228:231], v[48:51]
    v_mfma_f32_16x16x32_bf16 v[52:55], a[216:219], a[228:231], v[52:55]
    v_mfma_f32_16x16x32_bf16 v[56:59], a[220:223], a[228:231], v[56:59]
    v_mfma_f32_16x16x32_bf16 v[60:63], a[224:227], a[228:231], v[60:63]
    ds_read_b128 a[228:231], v14 offset:0
    v_mfma_f32_16x16x32_bf16 v[80:83], a[212:215], a[232:235], v[80:83]
    s_waitcnt vmcnt(17)
    v_mfma_f32_16x16x32_bf16 v[84:87], a[216:219], a[232:235], v[84:87]
    buffer_load_dwordx4 v2, s[12:15], s49 offen offset:1024 lds
    v_mfma_f32_16x16x32_bf16 v[88:91], a[220:223], a[232:235], v[88:91]
    ds_read_b64_tr_b16 a[196:197], v9 offset:8192
    v_mfma_f32_16x16x32_bf16 v[92:95], a[224:227], a[232:235], v[92:95]
    ds_read_b128 a[232:235], v14 offset:2048
    v_mfma_f32_16x16x32_bf16 v[112:115], a[212:215], a[236:239], v[112:115]
    ds_read_b64_tr_b16 a[198:199], v9 offset:9216
    v_mfma_f32_16x16x32_bf16 v[116:119], a[216:219], a[236:239], v[116:119]
    v_mfma_f32_16x16x32_bf16 v[120:123], a[220:223], a[236:239], v[120:123]
    ds_read_b64_tr_b16 a[200:201], v9 offset:8200
    v_mfma_f32_16x16x32_bf16 v[124:127], a[224:227], a[236:239], v[124:127]
    ds_read_b128 a[236:239], v14 offset:4096
    v_mfma_f32_16x16x32_bf16 v[144:147], a[212:215], a[240:243], v[144:147]
    ds_read_b64_tr_b16 a[202:203], v9 offset:9224
    v_mfma_f32_16x16x32_bf16 v[148:151], a[216:219], a[240:243], v[148:151]
    buffer_load_dwordx4 v3, s[12:15], s49 offen offset:2048 lds
    v_mfma_f32_16x16x32_bf16 v[152:155], a[220:223], a[240:243], v[152:155]
    ds_read_b64_tr_b16 a[204:205], v10 offset:8192
    v_mfma_f32_16x16x32_bf16 v[156:159], a[224:227], a[240:243], v[156:159]
    ds_read_b128 a[240:243], v14 offset:6144
    v_mfma_f32_16x16x32_bf16 v[176:179], a[212:215], a[244:247], v[176:179]
    ds_read_b64_tr_b16 a[206:207], v10 offset:9216
    v_mfma_f32_16x16x32_bf16 v[180:183], a[216:219], a[244:247], v[180:183]
    v_mfma_f32_16x16x32_bf16 v[184:187], a[220:223], a[244:247], v[184:187]
    ds_read_b64_tr_b16 a[208:209], v10 offset:8200
    v_mfma_f32_16x16x32_bf16 v[188:191], a[224:227], a[244:247], v[188:191]
    ds_read_b128 a[244:247], v14 offset:8192
    v_mfma_f32_16x16x32_bf16 v[208:211], a[212:215], a[248:251], v[208:211]
    ds_read_b64_tr_b16 a[210:211], v10 offset:9224
    v_mfma_f32_16x16x32_bf16 v[212:215], a[216:219], a[248:251], v[212:215]
    buffer_load_dwordx4 v4, s[12:15], s49 offen offset:3072 lds
    v_mfma_f32_16x16x32_bf16 v[216:219], a[220:223], a[248:251], v[216:219]
    v_mfma_f32_16x16x32_bf16 v[220:223], a[224:227], a[248:251], v[220:223]
    s_add_u32 s49, s49, 131072
    s_and_b32 s49, s49, 4194303
    ds_read_b128 a[248:251], v14 offset:10240
    v_mfma_f32_16x16x32_bf16 v[240:243], a[212:215], a[252:255], v[240:243]
    v_mfma_f32_16x16x32_bf16 v[244:247], a[216:219], a[252:255], v[244:247]
    v_mfma_f32_16x16x32_bf16 v[248:251], a[220:223], a[252:255], v[248:251]
    s_waitcnt lgkmcnt(1)
    v_mfma_f32_16x16x32_bf16 v[252:255], a[224:227], a[252:255], v[252:255]
    ds_read_b128 a[252:255], v14 offset:12288
    v_mfma_f32_16x16x32_bf16 v[32:35], a[196:199], a[228:231], v[32:35]
    s_add_u32 m0, s48, 0
    v_mfma_f32_16x16x32_bf16 v[36:39], a[200:203], a[228:231], v[36:39]
    buffer_load_dwordx4 v1, s[12:15], s49 offen offset:0 lds
    v_mfma_f32_16x16x32_bf16 v[40:43], a[204:207], a[228:231], v[40:43]
    v_mfma_f32_16x16x32_bf16 v[44:47], a[208:211], a[228:231], v[44:47]
    v_mfma_f32_16x16x32_bf16 v[64:67], a[196:199], a[232:235], v[64:67]
    s_waitcnt vmcnt(21)
    v_mfma_f32_16x16x32_bf16 v[68:71], a[200:203], a[232:235], v[68:71]
    v_mfma_f32_16x16x32_bf16 v[72:75], a[204:207], a[232:235], v[72:75]
    ds_read_b64_tr_b16 a[212:213], v11 offset:8192
    v_mfma_f32_16x16x32_bf16 v[76:79], a[208:211], a[232:235], v[76:79]
    buffer_load_dwordx4 v2, s[12:15], s49 offen offset:1024 lds
    v_mfma_f32_16x16x32_bf16 v[96:99], a[196:199], a[236:239], v[96:99]
    s_waitcnt lgkmcnt(1)
    ds_read_b64_tr_b16 a[214:215], v11 offset:9216
    v_mfma_f32_16x16x32_bf16 v[100:103], a[200:203], a[236:239], v[100:103]
    v_mfma_f32_16x16x32_bf16 v[104:107], a[204:207], a[236:239], v[104:107]
    ds_read_b64_tr_b16 a[216:217], v11 offset:8200
    v_mfma_f32_16x16x32_bf16 v[108:111], a[208:211], a[236:239], v[108:111]
    v_mfma_f32_16x16x32_bf16 v[128:131], a[196:199], a[240:243], v[128:131]
    ds_read_b64_tr_b16 a[218:219], v11 offset:9224
    v_mfma_f32_16x16x32_bf16 v[132:135], a[200:203], a[240:243], v[132:135]
    buffer_load_dwordx4 v3, s[12:15], s49 offen offset:2048 lds
    v_mfma_f32_16x16x32_bf16 v[136:139], a[204:207], a[240:243], v[136:139]
    ds_read_b64_tr_b16 a[220:221], v12 offset:8192
    v_mfma_f32_16x16x32_bf16 v[140:143], a[208:211], a[240:243], v[140:143]
    v_mfma_f32_16x16x32_bf16 v[160:163], a[196:199], a[244:247], v[160:163]
    ds_read_b64_tr_b16 a[222:223], v12 offset:9216
    v_mfma_f32_16x16x32_bf16 v[164:167], a[200:203], a[244:247], v[164:167]
    v_mfma_f32_16x16x32_bf16 v[168:171], a[204:207], a[244:247], v[168:171]
    ds_read_b64_tr_b16 a[224:225], v12 offset:8200
    v_mfma_f32_16x16x32_bf16 v[172:175], a[208:211], a[244:247], v[172:175]
    buffer_load_dwordx4 v4, s[12:15], s49 offen offset:3072 lds
    v_mfma_f32_16x16x32_bf16 v[192:195], a[196:199], a[248:251], v[192:195]
    ds_read_b64_tr_b16 a[226:227], v12 offset:9224
    v_mfma_f32_16x16x32_bf16 v[196:199], a[200:203], a[248:251], v[196:199]
    s_add_u32 s49, s49, 131072
    s_and_b32 s49, s49, 4194303
    v_mfma_f32_16x16x32_bf16 v[200:203], a[204:207], a[248:251], v[200:203]
    v_mfma_f32_16x16x32_bf16 v[204:207], a[208:211], a[248:251], v[204:207]
    s_add_u32 m0, s48, 4096
    v_mfma_f32_16x16x32_bf16 v[224:227], a[196:199], a[252:255], v[224:227]
    v_mfma_f32_16x16x32_bf16 v[228:231], a[200:203], a[252:255], v[228:231]
    buffer_load_dwordx4 v1, s[12:15], s49 offen offset:0 lds
    v_mfma_f32_16x16x32_bf16 v[232:235], a[204:207], a[252:255], v[232:235]
    s_waitcnt lgkmcnt(0)
    v_mfma_f32_16x16x32_bf16 v[236:239], a[208:211], a[252:255], v[236:239]
    s_waitcnt vmcnt(13)
    s_barrier
    v_mfma_f32_16x16x32_bf16 v[48:51], a[212:215], a[228:231], v[48:51]
    s_add_u32 m0, s56, 0
    v_mfma_f32_16x16x32_bf16 v[52:55], a[216:219], a[228:231], v[52:55]
    buffer_load_dwordx4 v5, s[8:11], s50 offen offset:0 lds
    v_mfma_f32_16x16x32_bf16 v[56:59], a[220:223], a[228:231], v[56:59]
    v_mfma_f32_16x16x32_bf16 v[60:63], a[224:227], a[228:231], v[60:63]
    ds_read_b128 a[228:231], v13 offset:16384
    v_mfma_f32_16x16x32_bf16 v[80:83], a[212:215], a[232:235], v[80:83]
    s_add_u32 m0, s48, 4096
    s_waitcnt vmcnt(15)
    v_mfma_f32_16x16x32_bf16 v[84:87], a[216:219], a[232:235], v[84:87]
    buffer_load_dwordx4 v2, s[12:15], s49 offen offset:1024 lds
    v_mfma_f32_16x16x32_bf16 v[88:91], a[220:223], a[232:235], v[88:91]
    ds_read_b64_tr_b16 a[196:197], v9 offset:16384
    v_mfma_f32_16x16x32_bf16 v[92:95], a[224:227], a[232:235], v[92:95]
    ds_read_b128 a[232:235], v13 offset:18432
    v_mfma_f32_16x16x32_bf16 v[112:115], a[212:215], a[236:239], v[112:115]
    s_add_u32 m0, s56, 0
    ds_read_b64_tr_b16 a[198:199], v9 offset:17408
    v_mfma_f32_16x16x32_bf16 v[116:119], a[216:219], a[236:239], v[116:119]
    buffer_load_dwordx4 v6, s[8:11], s50 offen offset:1024 lds
    v_mfma_f32_16x16x32_bf16 v[120:123], a[220:223], a[236:239], v[120:123]
    ds_read_b64_tr_b16 a[200:201], v9 offset:16392
    v_mfma_f32_16x16x32_bf16 v[124:127], a[224:227], a[236:239], v[124:127]
    ds_read_b128 a[236:239], v13 offset:20480
    v_mfma_f32_16x16x32_bf16 v[144:147], a[212:215], a[240:243], v[144:147]
    s_add_u32 m0, s48, 4096
    ds_read_b64_tr_b16 a[202:203], v9 offset:17416
    v_mfma_f32_16x16x32_bf16 v[148:151], a[216:219], a[240:243], v[148:151]
    buffer_load_dwordx4 v3, s[12:15], s49 offen offset:2048 lds
    v_mfma_f32_16x16x32_bf16 v[152:155], a[220:223], a[240:243], v[152:155]
    ds_read_b64_tr_b16 a[204:205], v10 offset:16384
    v_mfma_f32_16x16x32_bf16 v[156:159], a[224:227], a[240:243], v[156:159]
    ds_read_b128 a[240:243], v13 offset:22528
    v_mfma_f32_16x16x32_bf16 v[176:179], a[212:215], a[244:247], v[176:179]
    s_add_u32 m0, s56, 0
    ds_read_b64_tr_b16 a[206:207], v10 offset:17408
    v_mfma_f32_16x16x32_bf16 v[180:183], a[216:219], a[244:247], v[180:183]
    buffer_load_dwordx4 v7, s[8:11], s50 offen offset:2048 lds
    v_mfma_f32_16x16x32_bf16 v[184:187], a[220:223], a[244:247], v[184:187]
    ds_read_b64_tr_b16 a[208:209], v10 offset:16392
    v_mfma_f32_16x16x32_bf16 v[188:191], a[224:227], a[244:247], v[188:191]
    ds_read_b128 a[244:247], v13 offset:24576
    v_mfma_f32_16x16x32_bf16 v[208:211], a[212:215], a[248:251], v[208:211]
    s_add_u32 m0, s48, 4096
    ds_read_b64_tr_b16 a[210:211], v10 offset:17416
    v_mfma_f32_16x16x32_bf16 v[212:215], a[216:219], a[248:251], v[212:215]
    buffer_load_dwordx4 v4, s[12:15], s49 offen offset:3072 lds
    v_mfma_f32_16x16x32_bf16 v[216:219], a[220:223], a[248:251], v[216:219]
    v_mfma_f32_16x16x32_bf16 v[220:223], a[224:227], a[248:251], v[220:223]
    s_add_u32 s49, s49, 131072
    s_and_b32 s49, s49, 4194303
    ds_read_b128 a[248:251], v13 offset:26624
    v_mfma_f32_16x16x32_bf16 v[240:243], a[212:215], a[252:255], v[240:243]
    s_add_u32 m0, s56, 0
    v_mfma_f32_16x16x32_bf16 v[244:247], a[216:219], a[252:255], v[244:247]
    buffer_load_dwordx4 v8, s[8:11], s50 offen offset:3072 lds
    v_mfma_f32_16x16x32_bf16 v[248:251], a[220:223], a[252:255], v[248:251]
    s_waitcnt lgkmcnt(1)
    v_mfma_f32_16x16x32_bf16 v[252:255], a[224:227], a[252:255], v[252:255]
    s_add_u32 s98, s98, 128
    s_and_b32 s98, s98, 1023
    s_add_u32 s50, s99, s98
    ds_read_b128 a[252:255], v13 offset:28672
    v_mfma_f32_16x16x32_bf16 v[32:35], a[196:199], a[228:231], v[32:35]
    s_add_u32 m0, s48, 8192
    v_mfma_f32_16x16x32_bf16 v[36:39], a[200:203], a[228:231], v[36:39]
    buffer_load_dwordx4 v1, s[12:15], s49 offen offset:0 lds
    v_mfma_f32_16x16x32_bf16 v[40:43], a[204:207], a[228:231], v[40:43]
    v_mfma_f32_16x16x32_bf16 v[44:47], a[208:211], a[228:231], v[44:47]
    v_mfma_f32_16x16x32_bf16 v[64:67], a[196:199], a[232:235], v[64:67]
    s_waitcnt vmcnt(22)
    v_mfma_f32_16x16x32_bf16 v[68:71], a[200:203], a[232:235], v[68:71]
    v_mfma_f32_16x16x32_bf16 v[72:75], a[204:207], a[232:235], v[72:75]
    ds_read_b64_tr_b16 a[212:213], v11 offset:16384
    v_mfma_f32_16x16x32_bf16 v[76:79], a[208:211], a[232:235], v[76:79]
    buffer_load_dwordx4 v2, s[12:15], s49 offen offset:1024 lds
    v_mfma_f32_16x16x32_bf16 v[96:99], a[196:199], a[236:239], v[96:99]
    s_waitcnt lgkmcnt(1)
    ds_read_b64_tr_b16 a[214:215], v11 offset:17408
    v_mfma_f32_16x16x32_bf16 v[100:103], a[200:203], a[236:239], v[100:103]
    v_mfma_f32_16x16x32_bf16 v[104:107], a[204:207], a[236:239], v[104:107]
    ds_read_b64_tr_b16 a[216:217], v11 offset:16392
    v_mfma_f32_16x16x32_bf16 v[108:111], a[208:211], a[236:239], v[108:111]
    v_mfma_f32_16x16x32_bf16 v[128:131], a[196:199], a[240:243], v[128:131]
    ds_read_b64_tr_b16 a[218:219], v11 offset:17416
    v_mfma_f32_16x16x32_bf16 v[132:135], a[200:203], a[240:243], v[132:135]
    buffer_load_dwordx4 v3, s[12:15], s49 offen offset:2048 lds
    v_mfma_f32_16x16x32_bf16 v[136:139], a[204:207], a[240:243], v[136:139]
    ds_read_b64_tr_b16 a[220:221], v12 offset:16384
    v_mfma_f32_16x16x32_bf16 v[140:143], a[208:211], a[240:243], v[140:143]
    v_mfma_f32_16x16x32_bf16 v[160:163], a[196:199], a[244:247], v[160:163]
    ds_read_b64_tr_b16 a[222:223], v12 offset:17408
    v_mfma_f32_16x16x32_bf16 v[164:167], a[200:203], a[244:247], v[164:167]
    v_mfma_f32_16x16x32_bf16 v[168:171], a[204:207], a[244:247], v[168:171]
    ds_read_b64_tr_b16 a[224:225], v12 offset:16392
    v_mfma_f32_16x16x32_bf16 v[172:175], a[208:211], a[244:247], v[172:175]
    buffer_load_dwordx4 v4, s[12:15], s49 offen offset:3072 lds
    v_mfma_f32_16x16x32_bf16 v[192:195], a[196:199], a[248:251], v[192:195]
    ds_read_b64_tr_b16 a[226:227], v12 offset:17416
    v_mfma_f32_16x16x32_bf16 v[196:199], a[200:203], a[248:251], v[196:199]
    s_add_u32 s49, s49, 131072
    s_and_b32 s49, s49, 4194303
    v_mfma_f32_16x16x32_bf16 v[200:203], a[204:207], a[248:251], v[200:203]
    v_mfma_f32_16x16x32_bf16 v[204:207], a[208:211], a[248:251], v[204:207]
    s_add_u32 m0, s48, 12288
    v_mfma_f32_16x16x32_bf16 v[224:227], a[196:199], a[252:255], v[224:227]
    v_mfma_f32_16x16x32_bf16 v[228:231], a[200:203], a[252:255], v[228:231]
    buffer_load_dwordx4 v1, s[12:15], s49 offen offset:0 lds
    v_mfma_f32_16x16x32_bf16 v[232:235], a[204:207], a[252:255], v[232:235]
    s_waitcnt lgkmcnt(0)
    v_mfma_f32_16x16x32_bf16 v[236:239], a[208:211], a[252:255], v[236:239]
    v_mfma_f32_16x16x32_bf16 v[48:51], a[212:215], a[228:231], v[48:51]
    v_mfma_f32_16x16x32_bf16 v[52:55], a[216:219], a[228:231], v[52:55]
    v_mfma_f32_16x16x32_bf16 v[56:59], a[220:223], a[228:231], v[56:59]
    v_mfma_f32_16x16x32_bf16 v[60:63], a[224:227], a[228:231], v[60:63]
    ds_read_b128 a[228:231], v14 offset:16384
    v_mfma_f32_16x16x32_bf16 v[80:83], a[212:215], a[232:235], v[80:83]
    s_waitcnt vmcnt(17)
    v_mfma_f32_16x16x32_bf16 v[84:87], a[216:219], a[232:235], v[84:87]
    buffer_load_dwordx4 v2, s[12:15], s49 offen offset:1024 lds
    v_mfma_f32_16x16x32_bf16 v[88:91], a[220:223], a[232:235], v[88:91]
    ds_read_b64_tr_b16 a[196:197], v9 offset:24576
    v_mfma_f32_16x16x32_bf16 v[92:95], a[224:227], a[232:235], v[92:95]
    ds_read_b128 a[232:235], v14 offset:18432
    v_mfma_f32_16x16x32_bf16 v[112:115], a[212:215], a[236:239], v[112:115]
    ds_read_b64_tr_b16 a[198:199], v9 offset:25600
    v_mfma_f32_16x16x32_bf16 v[116:119], a[216:219], a[236:239], v[116:119]
    v_mfma_f32_16x16x32_bf16 v[120:123], a[220:223], a[236:239], v[120:123]
    ds_read_b64_tr_b16 a[200:201], v9 offset:24584
    v_mfma_f32_16x16x32_bf16 v[124:127], a[224:227], a[236:239], v[124:127]
    ds_read_b128 a[236:239], v14 offset:20480
    v_mfma_f32_16x16x32_bf16 v[144:147], a[212:215], a[240:243], v[144:147]
    ds_read_b64_tr_b16 a[202:203], v9 offset:25608
    v_mfma_f32_16x16x32_bf16 v[148:151], a[216:219], a[240:243], v[148:151]
    buffer_load_dwordx4 v3, s[12:15], s49 offen offset:2048 lds
    v_mfma_f32_16x16x32_bf16 v[152:155], a[220:223], a[240:243], v[152:155]
    ds_read_b64_tr_b16 a[204:205], v10 offset:24576
    v_mfma_f32_16x16x32_bf16 v[156:159], a[224:227], a[240:243], v[156:159]
    ds_read_b128 a[240:243], v14 offset:22528
    v_mfma_f32_16x16x32_bf16 v[176:179], a[212:215], a[244:247], v[176:179]
    ds_read_b64_tr_b16 a[206:207], v10 offset:25600
    v_mfma_f32_16x16x32_bf16 v[180:183], a[216:219], a[244:247], v[180:183]
    v_mfma_f32_16x16x32_bf16 v[184:187], a[220:223], a[244:247], v[184:187]
    ds_read_b64_tr_b16 a[208:209], v10 offset:24584
    v_mfma_f32_16x16x32_bf16 v[188:191], a[224:227], a[244:247], v[188:191]
    ds_read_b128 a[244:247], v14 offset:24576
    v_mfma_f32_16x16x32_bf16 v[208:211], a[212:215], a[248:251], v[208:211]
    ds_read_b64_tr_b16 a[210:211], v10 offset:25608
    v_mfma_f32_16x16x32_bf16 v[212:215], a[216:219], a[248:251], v[212:215]
    buffer_load_dwordx4 v4, s[12:15], s49 offen offset:3072 lds
    v_mfma_f32_16x16x32_bf16 v[216:219], a[220:223], a[248:251], v[216:219]
    v_mfma_f32_16x16x32_bf16 v[220:223], a[224:227], a[248:251], v[220:223]
    s_add_u32 s49, s49, 131072
    s_and_b32 s49, s49, 4194303
    ds_read_b128 a[248:251], v14 offset:26624
    v_mfma_f32_16x16x32_bf16 v[240:243], a[212:215], a[252:255], v[240:243]
    v_mfma_f32_16x16x32_bf16 v[244:247], a[216:219], a[252:255], v[244:247]
    v_mfma_f32_16x16x32_bf16 v[248:251], a[220:223], a[252:255], v[248:251]
    s_waitcnt lgkmcnt(1)
    v_mfma_f32_16x16x32_bf16 v[252:255], a[224:227], a[252:255], v[252:255]
    ds_read_b128 a[252:255], v14 offset:28672
    v_mfma_f32_16x16x32_bf16 v[32:35], a[196:199], a[228:231], v[32:35]
    s_add_u32 m0, s48, 16384
    v_mfma_f32_16x16x32_bf16 v[36:39], a[200:203], a[228:231], v[36:39]
    buffer_load_dwordx4 v1, s[12:15], s49 offen offset:0 lds
    v_mfma_f32_16x16x32_bf16 v[40:43], a[204:207], a[228:231], v[40:43]
    v_mfma_f32_16x16x32_bf16 v[44:47], a[208:211], a[228:231], v[44:47]
    v_mfma_f32_16x16x32_bf16 v[64:67], a[196:199], a[232:235], v[64:67]
    s_waitcnt vmcnt(21)
    v_mfma_f32_16x16x32_bf16 v[68:71], a[200:203], a[232:235], v[68:71]
    v_mfma_f32_16x16x32_bf16 v[72:75], a[204:207], a[232:235], v[72:75]
    ds_read_b64_tr_b16 a[212:213], v11 offset:24576
    v_mfma_f32_16x16x32_bf16 v[76:79], a[208:211], a[232:235], v[76:79]
    buffer_load_dwordx4 v2, s[12:15], s49 offen offset:1024 lds
    v_mfma_f32_16x16x32_bf16 v[96:99], a[196:199], a[236:239], v[96:99]
    s_waitcnt lgkmcnt(1)
    ds_read_b64_tr_b16 a[214:215], v11 offset:25600
    v_mfma_f32_16x16x32_bf16 v[100:103], a[200:203], a[236:239], v[100:103]
    v_mfma_f32_16x16x32_bf16 v[104:107], a[204:207], a[236:239], v[104:107]
    ds_read_b64_tr_b16 a[216:217], v11 offset:24584
    v_mfma_f32_16x16x32_bf16 v[108:111], a[208:211], a[236:239], v[108:111]
    v_mfma_f32_16x16x32_bf16 v[128:131], a[196:199], a[240:243], v[128:131]
    ds_read_b64_tr_b16 a[218:219], v11 offset:25608
    v_mfma_f32_16x16x32_bf16 v[132:135], a[200:203], a[240:243], v[132:135]
    buffer_load_dwordx4 v3, s[12:15], s49 offen offset:2048 lds
    v_mfma_f32_16x16x32_bf16 v[136:139], a[204:207], a[240:243], v[136:139]
    ds_read_b64_tr_b16 a[220:221], v12 offset:24576
    v_mfma_f32_16x16x32_bf16 v[140:143], a[208:211], a[240:243], v[140:143]
    v_mfma_f32_16x16x32_bf16 v[160:163], a[196:199], a[244:247], v[160:163]
    ds_read_b64_tr_b16 a[222:223], v12 offset:25600
    v_mfma_f32_16x16x32_bf16 v[164:167], a[200:203], a[244:247], v[164:167]
    v_mfma_f32_16x16x32_bf16 v[168:171], a[204:207], a[244:247], v[168:171]
    ds_read_b64_tr_b16 a[224:225], v12 offset:24584
    v_mfma_f32_16x16x32_bf16 v[172:175], a[208:211], a[244:247], v[172:175]
    buffer_load_dwordx4 v4, s[12:15], s49 offen offset:3072 lds
    v_mfma_f32_16x16x32_bf16 v[192:195], a[196:199], a[248:251], v[192:195]
    ds_read_b64_tr_b16 a[226:227], v12 offset:25608
    v_mfma_f32_16x16x32_bf16 v[196:199], a[200:203], a[248:251], v[196:199]
    s_add_u32 s49, s49, 131072
    s_and_b32 s49, s49, 4194303
    v_mfma_f32_16x16x32_bf16 v[200:203], a[204:207], a[248:251], v[200:203]
    v_mfma_f32_16x16x32_bf16 v[204:207], a[208:211], a[248:251], v[204:207]
    s_add_u32 m0, s48, 20480
    v_mfma_f32_16x16x32_bf16 v[224:227], a[196:199], a[252:255], v[224:227]
    v_mfma_f32_16x16x32_bf16 v[228:231], a[200:203], a[252:255], v[228:231]
    buffer_load_dwordx4 v1, s[12:15], s49 offen offset:0 lds
    v_mfma_f32_16x16x32_bf16 v[232:235], a[204:207], a[252:255], v[232:235]
    s_waitcnt lgkmcnt(0)
    v_mfma_f32_16x16x32_bf16 v[236:239], a[208:211], a[252:255], v[236:239]
    s_waitcnt vmcnt(13)
    s_barrier
    v_mfma_f32_16x16x32_bf16 v[48:51], a[212:215], a[228:231], v[48:51]
    s_add_u32 m0, s56, 16384
    v_mfma_f32_16x16x32_bf16 v[52:55], a[216:219], a[228:231], v[52:55]
    buffer_load_dwordx4 v5, s[8:11], s50 offen offset:0 lds
    v_mfma_f32_16x16x32_bf16 v[56:59], a[220:223], a[228:231], v[56:59]
    v_mfma_f32_16x16x32_bf16 v[60:63], a[224:227], a[228:231], v[60:63]
    ds_read_b128 a[228:231], v13 offset:0
    v_mfma_f32_16x16x32_bf16 v[80:83], a[212:215], a[232:235], v[80:83]
    s_add_u32 m0, s48, 20480
    s_waitcnt vmcnt(15)
    v_mfma_f32_16x16x32_bf16 v[84:87], a[216:219], a[232:235], v[84:87]
    buffer_load_dwordx4 v2, s[12:15], s49 offen offset:1024 lds
    v_mfma_f32_16x16x32_bf16 v[88:91], a[220:223], a[232:235], v[88:91]
    ds_read_b64_tr_b16 a[196:197], v9 offset:0
    v_mfma_f32_16x16x32_bf16 v[92:95], a[224:227], a[232:235], v[92:95]
    ds_read_b128 a[232:235], v13 offset:2048
    v_mfma_f32_16x16x32_bf16 v[112:115], a[212:215], a[236:239], v[112:115]
    s_add_u32 m0, s56, 16384
    ds_read_b64_tr_b16 a[198:199], v9 offset:1024
    v_mfma_f32_16x16x32_bf16 v[116:119], a[216:219], a[236:239], v[116:119]
    buffer_load_dwordx4 v6, s[8:11], s50 offen offset:1024 lds
    v_mfma_f32_16x16x32_bf16 v[120:123], a[220:223], a[236:239], v[120:123]
    ds_read_b64_tr_b16 a[200:201], v9 offset:8
    v_mfma_f32_16x16x32_bf16 v[124:127], a[224:227], a[236:239], v[124:127]
    ds_read_b128 a[236:239], v13 offset:4096
    v_mfma_f32_16x16x32_bf16 v[144:147], a[212:215], a[240:243], v[144:147]
    s_add_u32 m0, s48, 20480
    ds_read_b64_tr_b16 a[202:203], v9 offset:1032
    v_mfma_f32_16x16x32_bf16 v[148:151], a[216:219], a[240:243], v[148:151]
    buffer_load_dwordx4 v3, s[12:15], s49 offen offset:2048 lds
    v_mfma_f32_16x16x32_bf16 v[152:155], a[220:223], a[240:243], v[152:155]
    ds_read_b64_tr_b16 a[204:205], v10 offset:0
    v_mfma_f32_16x16x32_bf16 v[156:159], a[224:227], a[240:243], v[156:159]
    ds_read_b128 a[240:243], v13 offset:6144
    v_mfma_f32_16x16x32_bf16 v[176:179], a[212:215], a[244:247], v[176:179]
    s_add_u32 m0, s56, 16384
    ds_read_b64_tr_b16 a[206:207], v10 offset:1024
    v_mfma_f32_16x16x32_bf16 v[180:183], a[216:219], a[244:247], v[180:183]
    buffer_load_dwordx4 v7, s[8:11], s50 offen offset:2048 lds
    v_mfma_f32_16x16x32_bf16 v[184:187], a[220:223], a[244:247], v[184:187]
    ds_read_b64_tr_b16 a[208:209], v10 offset:8
    v_mfma_f32_16x16x32_bf16 v[188:191], a[224:227], a[244:247], v[188:191]
    ds_read_b128 a[244:247], v13 offset:8192
    v_mfma_f32_16x16x32_bf16 v[208:211], a[212:215], a[248:251], v[208:211]
    s_add_u32 m0, s48, 20480
    ds_read_b64_tr_b16 a[210:211], v10 offset:1032
    v_mfma_f32_16x16x32_bf16 v[212:215], a[216:219], a[248:251], v[212:215]
    buffer_load_dwordx4 v4, s[12:15], s49 offen offset:3072 lds
    v_mfma_f32_16x16x32_bf16 v[216:219], a[220:223], a[248:251], v[216:219]
    v_mfma_f32_16x16x32_bf16 v[220:223], a[224:227], a[248:251], v[220:223]
    s_add_u32 s49, s49, 131072
    s_and_b32 s49, s49, 4194303
    ds_read_b128 a[248:251], v13 offset:10240
    v_mfma_f32_16x16x32_bf16 v[240:243], a[212:215], a[252:255], v[240:243]
    s_add_u32 m0, s56, 16384
    v_mfma_f32_16x16x32_bf16 v[244:247], a[216:219], a[252:255], v[244:247]
    buffer_load_dwordx4 v8, s[8:11], s50 offen offset:3072 lds
    v_mfma_f32_16x16x32_bf16 v[248:251], a[220:223], a[252:255], v[248:251]
    s_waitcnt lgkmcnt(1)
    v_mfma_f32_16x16x32_bf16 v[252:255], a[224:227], a[252:255], v[252:255]
    s_add_u32 s98, s98, 128
    s_and_b32 s98, s98, 1023
    s_add_u32 s50, s99, s98
    ds_read_b128 a[252:255], v13 offset:12288
    s_sub_u32 s55, s55, 1
    s_cmp_lg_u32 s55, 0
    s_cbranch_scc1 L_A
    v_mfma_f32_16x16x32_bf16 v[32:35], a[196:199], a[228:231], v[32:35]
    s_add_u32 m0, s48, 24576
    v_mfma_f32_16x16x32_bf16 v[36:39], a[200:203], a[228:231], v[36:39]
    buffer_load_dwordx4 v1, s[12:15], s49 offen offset:0 lds
    v_mfma_f32_16x16x32_bf16 v[40:43], a[204:207], a[228:231], v[40:43]
    v_accvgpr_write_b32 a0, 0
    v_accvgpr_write_b32 a1, 0
    v_mfma_f32_16x16x32_bf16 v[44:47], a[208:211], a[228:231], v[44:47]
    v_accvgpr_write_b32 a2, 0
    v_accvgpr_write_b32 a3, 0
    v_mfma_f32_16x16x32_bf16 v[64:67], a[196:199], a[232:235], v[64:67]
    s_waitcnt vmcnt(22)
    v_mfma_f32_16x16x32_bf16 v[68:71], a[200:203], a[232:235], v[68:71]
    v_accvgpr_write_b32 a4, 0
    v_accvgpr_write_b32 a5, 0
    v_mfma_f32_16x16x32_bf16 v[72:75], a[204:207], a[232:235], v[72:75]
    ds_read_b64_tr_b16 a[212:213], v11 offset:0
    v_mfma_f32_16x16x32_bf16 v[76:79], a[208:211], a[232:235], v[76:79]
    buffer_load_dwordx4 v2, s[12:15], s49 offen offset:1024 lds
    v_mfma_f32_16x16x32_bf16 v[96:99], a[196:199], a[236:239], v[96:99]
    s_waitcnt lgkmcnt(1)
    ds_read_b64_tr_b16 a[214:215], v11 offset:1024
    v_mfma_f32_16x16x32_bf16 v[100:103], a[200:203], a[236:239], v[100:103]
    v_accvgpr_write_b32 a6, 0
    v_accvgpr_write_b32 a7, 0
    v_mfma_f32_16x16x32_bf16 v[104:107], a[204:207], a[236:239], v[104:107]
    ds_read_b64_tr_b16 a[216:217], v11 offset:8
    v_mfma_f32_16x16x32_bf16 v[108:111], a[208:211], a[236:239], v[108:111]
    v_accvgpr_write_b32 a8, 0
    v_accvgpr_write_b32 a9, 0
    v_mfma_f32_16x16x32_bf16 v[128:131], a[196:199], a[240:243], v[128:131]
    ds_read_b64_tr_b16 a[218:219], v11 offset:1032
    v_mfma_f32_16x16x32_bf16 v[132:135], a[200:203], a[240:243], v[132:135]
    buffer_load_dwordx4 v3, s[12:15], s49 offen offset:2048 lds
    v_mfma_f32_16x16x32_bf16 v[136:139], a[204:207], a[240:243], v[136:139]
    ds_read_b64_tr_b16 a[220:221], v12 offset:0
    v_mfma_f32_16x16x32_bf16 v[140:143], a[208:211], a[240:243], v[140:143]
    v_accvgpr_write_b32 a10, 0
    v_accvgpr_write_b32 a11, 0
    v_mfma_f32_16x16x32_bf16 v[160:163], a[196:199], a[244:247], v[160:163]
    ds_read_b64_tr_b16 a[222:223], v12 offset:1024
    v_mfma_f32_16x16x32_bf16 v[164:167], a[200:203], a[244:247], v[164:167]
    v_accvgpr_write_b32 a12, 0
    v_accvgpr_write_b32 a13, 0
    v_mfma_f32_16x16x32_bf16 v[168:171], a[204:207], a[244:247], v[168:171]
    ds_read_b64_tr_b16 a[224:225], v12 offset:8
    v_mfma_f32_16x16x32_bf16 v[172:175], a[208:211], a[244:247], v[172:175]
    buffer_load_dwordx4 v4, s[12:15], s49 offen offset:3072 lds
    v_mfma_f32_16x16x32_bf16 v[192:195], a[196:199], a[248:251], v[192:195]
    ds_read_b64_tr_b16 a[226:227], v12 offset:1032
    v_mfma_f32_16x16x32_bf16 v[196:199], a[200:203], a[248:251], v[196:199]
    s_add_u32 s49, s49, 131072
    s_and_b32 s49, s49, 4194303
    v_mfma_f32_16x16x32_bf16 v[200:203], a[204:207], a[248:251], v[200:203]
    v_accvgpr_write_b32 a14, 0
    v_accvgpr_write_b32 a15, 0
    v_mfma_f32_16x16x32_bf16 v[204:207], a[208:211], a[248:251], v[204:207]
    s_add_u32 m0, s48, 28672
    v_mfma_f32_16x16x32_bf16 v[224:227], a[196:199], a[252:255], v[224:227]
    v_accvgpr_write_b32 a16, 0
    v_accvgpr_write_b32 a17, 0
    v_mfma_f32_16x16x32_bf16 v[228:231], a[200:203], a[252:255], v[228:231]
    buffer_load_dwordx4 v1, s[12:15], s49 offen offset:0 lds
    v_mfma_f32_16x16x32_bf16 v[232:235], a[204:207], a[252:255], v[232:235]
    s_waitcnt lgkmcnt(0)
    v_mfma_f32_16x16x32_bf16 v[236:239], a[208:211], a[252:255], v[236:239]
    s_waitcnt vmcnt(63)
    s_lshl_b32 s3, s44, 3
    s_cmp_eq_u32 s4, 0
    s_cselect_b32 s3, s3, 0x40000000
    v_mov_b32 v25, 1
    buffer_atomic_add v25, v28, s[40:43], s3 offen sc1
    v_mfma_f32_16x16x32_bf16 v[48:51], a[212:215], a[228:231], v[48:51]
    v_accvgpr_write_b32 a18, 0
    v_accvgpr_write_b32 a19, 0
    v_mfma_f32_16x16x32_bf16 v[52:55], a[216:219], a[228:231], v[52:55]
    v_accvgpr_write_b32 a20, 0
    v_accvgpr_write_b32 a21, 0
    v_mfma_f32_16x16x32_bf16 v[56:59], a[220:223], a[228:231], v[56:59]
    v_accvgpr_write_b32 a22, 0
    v_accvgpr_write_b32 a23, 0
    v_mfma_f32_16x16x32_bf16 v[60:63], a[224:227], a[228:231], v[60:63]
    ds_read_b128 a[228:231], v14 offset:0
    v_mfma_f32_16x16x32_bf16 v[80:83], a[212:215], a[232:235], v[80:83]
    s_waitcnt vmcnt(18)
    v_mfma_f32_16x16x32_bf16 v[84:87], a[216:219], a[232:235], v[84:87]
    buffer_load_dwordx4 v2, s[12:15], s49 offen offset:1024 lds
    v_mfma_f32_16x16x32_bf16 v[88:91], a[220:223], a[232:235], v[88:91]
    ds_read_b64_tr_b16 a[196:197], v9 offset:8192
    v_mfma_f32_16x16x32_bf16 v[92:95], a[224:227], a[232:235], v[92:95]
    ds_read_b128 a[232:235], v14 offset:2048
    v_mfma_f32_16x16x32_bf16 v[112:115], a[212:215], a[236:239], v[112:115]
    ds_read_b64_tr_b16 a[198:199], v9 offset:9216
    v_mfma_f32_16x16x32_bf16 v[116:119], a[216:219], a[236:239], v[116:119]
    v_accvgpr_write_b32 a24, 0
    v_accvgpr_write_b32 a25, 0
    v_mfma_f32_16x16x32_bf16 v[120:123], a[220:223], a[236:239], v[120:123]
    ds_read_b64_tr_b16 a[200:201], v9 offset:8200
    v_mfma_f32_16x16x32_bf16 v[124:127], a[224:227], a[236:239], v[124:127]
    ds_read_b128 a[236:239], v14 offset:4096
    v_mfma_f32_16x16x32_bf16 v[144:147], a[212:215], a[240:243], v[144:147]
    ds_read_b64_tr_b16 a[202:203], v9 offset:9224
    v_mfma_f32_16x16x32_bf16 v[148:151], a[216:219], a[240:243], v[148:151]
    buffer_load_dwordx4 v3, s[12:15], s49 offen offset:2048 lds
    v_mfma_f32_16x16x32_bf16 v[152:155], a[220:223], a[240:243], v[152:155]
    ds_read_b64_tr_b16 a[204:205], v10 offset:8192
    v_mfma_f32_16x16x32_bf16 v[156:159], a[224:227], a[240:243], v[156:159]
    ds_read_b128 a[240:243], v14 offset:6144
    v_mfma_f32_16x16x32_bf16 v[176:179], a[212:215], a[244:247], v[176:179]
    ds_read_b64_tr_b16 a[206:207], v10 offset:9216
    v_mfma_f32_16x16x32_bf16 v[180:183], a[216:219], a[244:247], v[180:183]
    v_accvgpr_write_b32 a26, 0
    v_accvgpr_write_b32 a27, 0
    v_mfma_f32_16x16x32_bf16 v[184:187], a[220:223], a[244:247], v[184:187]
    ds_read_b64_tr_b16 a[208:209], v10 offset:8200
    v_mfma_f32_16x16x32_bf16 v[188:191], a[224:227], a[244:247], v[188:191]
    ds_read_b128 a[244:247], v14 offset:8192
    v_mfma_f32_16x16x32_bf16 v[208:211], a[212:215], a[248:251], v[208:211]
    ds_read_b64_tr_b16 a[210:211], v10 offset:9224
    v_mfma_f32_16x16x32_bf16 v[212:215], a[216:219], a[248:251], v[212:215]
    buffer_load_dwordx4 v4, s[12:15], s49 offen offset:3072 lds
    v_mfma_f32_16x16x32_bf16 v[216:219], a[220:223], a[248:251], v[216:219]
    v_accvgpr_write_b32 a28, 0
    v_accvgpr_write_b32 a29, 0
    v_mfma_f32_16x16x32_bf16 v[220:223], a[224:227], a[248:251], v[220:223]
    s_add_u32 s49, s49, 131072
    s_and_b32 s49, s49, 4194303
    ds_read_b128 a[248:251], v14 offset:10240
    v_mfma_f32_16x16x32_bf16 v[240:243], a[212:215], a[252:255], v[240:243]
    v_accvgpr_write_b32 a30, 0
    v_accvgpr_write_b32 a31, 0
    v_mfma_f32_16x16x32_bf16 v[244:247], a[216:219], a[252:255], v[244:247]
    v_accvgpr_write_b32 a32, 0
    v_accvgpr_write_b32 a33, 0
    v_mfma_f32_16x16x32_bf16 v[248:251], a[220:223], a[252:255], v[248:251]
    s_waitcnt lgkmcnt(1)
    v_mfma_f32_16x16x32_bf16 v[252:255], a[224:227], a[252:255], v[252:255]
    ds_read_b128 a[252:255], v14 offset:12288
    v_mfma_f32_16x16x32_bf16 v[32:35], a[196:199], a[228:231], v[32:35]
    s_add_u32 m0, s48, 0
    v_mfma_f32_16x16x32_bf16 v[36:39], a[200:203], a[228:231], v[36:39]
    buffer_load_dwordx4 v1, s[12:15], s49 offen offset:0 lds
    v_mfma_f32_16x16x32_bf16 v[40:43], a[204:207], a[228:231], v[40:43]
    v_accvgpr_write_b32 a34, 0
    v_accvgpr_write_b32 a35, 0
    v_mfma_f32_16x16x32_bf16 v[44:47], a[208:211], a[228:231], v[44:47]
    v_accvgpr_write_b32 a36, 0
    v_accvgpr_write_b32 a37, 0
    v_mfma_f32_16x16x32_bf16 v[64:67], a[196:199], a[232:235], v[64:67]
    s_waitcnt vmcnt(22)
    v_mfma_f32_16x16x32_bf16 v[68:71], a[200:203], a[232:235], v[68:71]
    v_accvgpr_write_b32 a38, 0
    v_accvgpr_write_b32 a39, 0
    v_mfma_f32_16x16x32_bf16 v[72:75], a[204:207], a[232:235], v[72:75]
    ds_read_b64_tr_b16 a[212:213], v11 offset:8192
    v_mfma_f32_16x16x32_bf16 v[76:79], a[208:211], a[232:235], v[76:79]
    buffer_load_dwordx4 v2, s[12:15], s49 offen offset:1024 lds
    v_mfma_f32_16x16x32_bf16 v[96:99], a[196:199], a[236:239], v[96:99]
    s_waitcnt lgkmcnt(1)
    ds_read_b64_tr_b16 a[214:215], v11 offset:9216
    v_mfma_f32_16x16x32_bf16 v[100:103], a[200:203], a[236:239], v[100:103]
    v_accvgpr_write_b32 a40, 0
    v_accvgpr_write_b32 a41, 0
    v_mfma_f32_16x16x32_bf16 v[104:107], a[204:207], a[236:239], v[104:107]
    ds_read_b64_tr_b16 a[216:217], v11 offset:8200
    v_mfma_f32_16x16x32_bf16 v[108:111], a[208:211], a[236:239], v[108:111]
    v_accvgpr_write_b32 a42, 0
    v_accvgpr_write_b32 a43, 0
    v_mfma_f32_16x16x32_bf16 v[128:131], a[196:199], a[240:243], v[128:131]
    ds_read_b64_tr_b16 a[218:219], v11 offset:9224
    v_mfma_f32_16x16x32_bf16 v[132:135], a[200:203], a[240:243], v[132:135]
    buffer_load_dwordx4 v3, s[12:15], s49 offen offset:2048 lds
    v_mfma_f32_16x16x32_bf16 v[136:139], a[204:207], a[240:243], v[136:139]
    ds_read_b64_tr_b16 a[220:221], v12 offset:8192
    v_mfma_f32_16x16x32_bf16 v[140:143], a[208:211], a[240:243], v[140:143]
    v_accvgpr_write_b32 a44, 0
    v_accvgpr_write_b32 a45, 0
    v_mfma_f32_16x16x32_bf16 v[160:163], a[196:199], a[244:247], v[160:163]
    ds_read_b64_tr_b16 a[222:223], v12 offset:9216
    v_mfma_f32_16x16x32_bf16 v[164:167], a[200:203], a[244:247], v[164:167]
    v_accvgpr_write_b32 a46, 0
    v_accvgpr_write_b32 a47, 0
    v_mfma_f32_16x16x32_bf16 v[168:171], a[204:207], a[244:247], v[168:171]
    ds_read_b64_tr_b16 a[224:225], v12 offset:8200
    v_mfma_f32_16x16x32_bf16 v[172:175], a[208:211], a[244:247], v[172:175]
    buffer_load_dwordx4 v4, s[12:15], s49 offen offset:3072 lds
    v_mfma_f32_16x16x32_bf16 v[192:195], a[196:199], a[248:251], v[192:195]
    ds_read_b64_tr_b16 a[226:227], v12 offset:9224
    v_mfma_f32_16x16x32_bf16 v[196:199], a[200:203], a[248:251], v[196:199]
    s_add_u32 s49, s49, 131072
    s_and_b32 s49, s49, 4194303
    v_mfma_f32_16x16x32_bf16 v[200:203], a[204:207], a[248:251], v[200:203]
    v_accvgpr_write_b32 a48, 0
    v_accvgpr_write_b32 a49, 0
    v_mfma_f32_16x16x32_bf16 v[204:207], a[208:211], a[248:251], v[204:207]
    s_add_u32 m0, s48, 4096
    v_mfma_f32_16x16x32_bf16 v[224:227], a[196:199], a[252:255], v[224:227]
    v_accvgpr_write_b32 a50, 0
    v_accvgpr_write_b32 a51, 0
    v_mfma_f32_16x16x32_bf16 v[228:231], a[200:203], a[252:255], v[228:231]
    buffer_load_dwordx4 v1, s[12:15], s49 offen offset:0 lds
    v_mfma_f32_16x16x32_bf16 v[232:235], a[204:207], a[252:255], v[232:235]
    s_waitcnt lgkmcnt(0)
    v_mfma_f32_16x16x32_bf16 v[236:239], a[208:211], a[252:255], v[236:239]
    s_waitcnt vmcnt(14)
    s_barrier
    v_mfma_f32_16x16x32_bf16 v[48:51], a[212:215], a[228:231], v[48:51]
    s_add_u32 m0, s56, 0
    v_mfma_f32_16x16x32_bf16 v[52:55], a[216:219], a[228:231], v[52:55]
    buffer_load_dwordx4 v5, s[8:11], s50 offen offset:0 lds
    v_mfma_f32_16x16x32_bf16 v[56:59], a[220:223], a[228:231], v[56:59]
    v_accvgpr_write_b32 a52, 0
    v_accvgpr_write_b32 a53, 0
    v_mfma_f32_16x16x32_bf16 v[60:63], a[224:227], a[228:231], v[60:63]
    ds_read_b128 a[228:231], v13 offset:16384
    v_mfma_f32_16x16x32_bf16 v[80:83], a[212:215], a[232:235], v[80:83]
    s_add_u32 m0, s48, 4096
    s_waitcnt vmcnt(16)
    v_mfma_f32_16x16x32_bf16 v[84:87], a[216:219], a[232:235], v[84:87]
    buffer_load_dwordx4 v2, s[12:15], s49 offen offset:1024 lds
    v_mfma_f32_16x16x32_bf16 v[88:91], a[220:223], a[232:235], v[88:91]
    ds_read_b64_tr_b16 a[196:197], v9 offset:16384
    v_mfma_f32_16x16x32_bf16 v[92:95], a[224:227], a[232:235], v[92:95]
    ds_read_b128 a[232:235], v13 offset:18432
    v_mfma_f32_16x16x32_bf16 v[112:115], a[212:215], a[236:239], v[112:115]
    s_add_u32 m0, s56, 0
    ds_read_b64_tr_b16 a[198:199], v9 offset:17408
    v_mfma_f32_16x16x32_bf16 v[116:119], a[216:219], a[236:239], v[116:119]
    buffer_load_dwordx4 v6, s[8:11], s50 offen offset:1024 lds
    v_mfma_f32_16x16x32_bf16 v[120:123], a[220:223], a[236:239], v[120:123]
    ds_read_b64_tr_b16 a[200:201], v9 offset:16392
    v_mfma_f32_16x16x32_bf16 v[124:127], a[224:227], a[236:239], v[124:127]
    ds_read_b128 a[236:239], v13 offset:20480
    v_mfma_f32_16x16x32_bf16 v[144:147], a[212:215], a[240:243], v[144:147]
    s_add_u32 m0, s48, 4096
    ds_read_b64_tr_b16 a[202:203], v9 offset:17416
    v_mfma_f32_16x16x32_bf16 v[148:151], a[216:219], a[240:243], v[148:151]
    buffer_load_dwordx4 v3, s[12:15], s49 offen offset:2048 lds
    v_mfma_f32_16x16x32_bf16 v[152:155], a[220:223], a[240:243], v[152:155]
    ds_read_b64_tr_b16 a[204:205], v10 offset:16384
    v_mfma_f32_16x16x32_bf16 v[156:159], a[224:227], a[240:243], v[156:159]
    ds_read_b128 a[240:243], v13 offset:22528
    v_mfma_f32_16x16x32_bf16 v[176:179], a[212:215], a[244:247], v[176:179]
    s_add_u32 m0, s56, 0
    ds_read_b64_tr_b16 a[206:207], v10 offset:17408
    v_mfma_f32_16x16x32_bf16 v[180:183], a[216:219], a[244:247], v[180:183]
    buffer_load_dwordx4 v7, s[8:11], s50 offen offset:2048 lds
    v_mfma_f32_16x16x32_bf16 v[184:187], a[220:223], a[244:247], v[184:187]
    ds_read_b64_tr_b16 a[208:209], v10 offset:16392
    v_mfma_f32_16x16x32_bf16 v[188:191], a[224:227], a[244:247], v[188:191]
    ds_read_b128 a[244:247], v13 offset:24576
    v_mfma_f32_16x16x32_bf16 v[208:211], a[212:215], a[248:251], v[208:211]
    s_add_u32 m0, s48, 4096
    ds_read_b64_tr_b16 a[210:211], v10 offset:17416
    v_mfma_f32_16x16x32_bf16 v[212:215], a[216:219], a[248:251], v[212:215]
    buffer_load_dwordx4 v4, s[12:15], s49 offen offset:3072 lds
    v_mfma_f32_16x16x32_bf16 v[216:219], a[220:223], a[248:251], v[216:219]
    v_accvgpr_write_b32 a54, 0
    v_accvgpr_write_b32 a55, 0
    v_mfma_f32_16x16x32_bf16 v[220:223], a[224:227], a[248:251], v[220:223]
    s_add_u32 s49, s49, 131072
    s_and_b32 s49, s49, 4194303
    ds_read_b128 a[248:251], v13 offset:26624
    v_mfma_f32_16x16x32_bf16 v[240:243], a[212:215], a[252:255], v[240:243]
    s_add_u32 m0, s56, 0
    v_mfma_f32_16x16x32_bf16 v[244:247], a[216:219], a[252:255], v[244:247]
    buffer_load_dwordx4 v8, s[8:11], s50 offen offset:3072 lds
    v_mfma_f32_16x16x32_bf16 v[248:251], a[220:223], a[252:255], v[248:251]
    s_waitcnt lgkmcnt(1)
    v_mfma_f32_16x16x32_bf16 v[252:255], a[224:227], a[252:255], v[252:255]
    s_add_u32 s98, s98, 128
    s_and_b32 s98, s98, 1023
    s_add_u32 s50, s99, s98
    ds_read_b128 a[252:255], v13 offset:28672
    v_mfma_f32_16x16x32_bf16 v[32:35], a[196:199], a[228:231], v[32:35]
    s_add_u32 m0, s48, 8192
    v_mfma_f32_16x16x32_bf16 v[36:39], a[200:203], a[228:231], v[36:39]
    buffer_load_dwordx4 v1, s[12:15], s49 offen offset:0 lds
    v_mfma_f32_16x16x32_bf16 v[40:43], a[204:207], a[228:231], v[40:43]
    v_accvgpr_write_b32 a56, 0
    v_accvgpr_write_b32 a57, 0
    v_mfma_f32_16x16x32_bf16 v[44:47], a[208:211], a[228:231], v[44:47]
    v_accvgpr_write_b32 a58, 0
    v_accvgpr_write_b32 a59, 0
    v_mfma_f32_16x16x32_bf16 v[64:67], a[196:199], a[232:235], v[64:67]
    s_waitcnt vmcnt(23)
    v_mfma_f32_16x16x32_bf16 v[68:71], a[200:203], a[232:235], v[68:71]
    v_accvgpr_write_b32 a60, 0
    v_accvgpr_write_b32 a61, 0
    v_mfma_f32_16x16x32_bf16 v[72:75], a[204:207], a[232:235], v[72:75]
    ds_read_b64_tr_b16 a[212:213], v11 offset:16384
    v_mfma_f32_16x16x32_bf16 v[76:79], a[208:211], a[232:235], v[76:79]
    buffer_load_dwordx4 v2, s[12:15], s49 offen offset:1024 lds
    v_mfma_f32_16x16x32_bf16 v[96:99], a[196:199], a[236:239], v[96:99]
    s_waitcnt lgkmcnt(1)
    ds_read_b64_tr_b16 a[214:215], v11 offset:17408
    v_mfma_f32_16x16x32_bf16 v[100:103], a[200:203], a[236:239], v[100:103]
    v_accvgpr_write_b32 a62, 0
    v_accvgpr_write_b32 a63, 0
    v_mfma_f32_16x16x32_bf16 v[104:107], a[204:207], a[236:239], v[104:107]
    ds_read_b64_tr_b16 a[216:217], v11 offset:16392
    v_mfma_f32_16x16x32_bf16 v[108:111], a[208:211], a[236:239], v[108:111]
    v_accvgpr_write_b32 a64, 0
    v_accvgpr_write_b32 a65, 0
    v_mfma_f32_16x16x32_bf16 v[128:131], a[196:199], a[240:243], v[128:131]
    ds_read_b64_tr_b16 a[218:219], v11 offset:17416
    v_mfma_f32_16x16x32_bf16 v[132:135], a[200:203], a[240:243], v[132:135]
    buffer_load_dwordx4 v3, s[12:15], s49 offen offset:2048 lds
    v_mfma_f32_16x16x32_bf16 v[136:139], a[204:207], a[240:243], v[136:139]
    ds_read_b64_tr_b16 a[220:221], v12 offset:16384
    v_mfma_f32_16x16x32_bf16 v[140:143], a[208:211], a[240:243], v[140:143]
    v_accvgpr_write_b32 a66, 0
    v_accvgpr_write_b32 a67, 0
    v_mfma_f32_16x16x32_bf16 v[160:163], a[196:199], a[244:247], v[160:163]
    ds_read_b64_tr_b16 a[222:223], v12 offset:17408
    v_mfma_f32_16x16x32_bf16 v[164:167], a[200:203], a[244:247], v[164:167]
    v_accvgpr_write_b32 a68, 0
    v_accvgpr_write_b32 a69, 0
    v_mfma_f32_16x16x32_bf16 v[168:171], a[204:207], a[244:247], v[168:171]
    ds_read_b64_tr_b16 a[224:225], v12 offset:16392
    v_mfma_f32_16x16x32_bf16 v[172:175], a[208:211], a[244:247], v[172:175]
    buffer_load_dwordx4 v4, s[12:15], s49 offen offset:3072 lds
    v_mfma_f32_16x16x32_bf16 v[192:195], a[196:199], a[248:251], v[192:195]
    ds_read_b64_tr_b16 a[226:227], v12 offset:17416
    v_mfma_f32_16x16x32_bf16 v[196:199], a[200:203], a[248:251], v[196:199]
    s_add_u32 s49, s49, 131072
    s_and_b32 s49, s49, 4194303
    v_mfma_f32_16x16x32_bf16 v[200:203], a[204:207], a[248:251], v[200:203]
    v_accvgpr_write_b32 a70, 0
    v_accvgpr_write_b32 a71, 0
    v_mfma_f32_16x16x32_bf16 v[204:207], a[208:211], a[248:251], v[204:207]
    s_add_u32 m0, s48, 12288
    v_mfma_f32_16x16x32_bf16 v[224:227], a[196:199], a[252:255], v[224:227]
    v_accvgpr_write_b32 a72, 0
    v_accvgpr_write_b32 a73, 0
    v_mfma_f32_16x16x32_bf16 v[228:231], a[200:203], a[252:255], v[228:231]
    buffer_load_dwordx4 v1, s[12:15], s49 offen offset:0 lds
    v_mfma_f32_16x16x32_bf16 v[232:235], a[204:207], a[252:255], v[232:235]
    s_waitcnt lgkmcnt(0)
    v_mfma_f32_16x16x32_bf16 v[236:239], a[208:211], a[252:255], v[236:239]
    v_accvgpr_write_b32 a74, 0
    v_accvgpr_write_b32 a75, 0
    v_mfma_f32_16x16x32_bf16 v[48:51], a[212:215], a[228:231], v[48:51]
    v_accvgpr_write_b32 a76, 0
    v_accvgpr_write_b32 a77, 0
    v_mfma_f32_16x16x32_bf16 v[52:55], a[216:219], a[228:231], v[52:55]
    v_accvgpr_write_b32 a78, 0
    v_accvgpr_write_b32 a79, 0
    v_mfma_f32_16x16x32_bf16 v[56:59], a[220:223], a[228:231], v[56:59]
    v_accvgpr_write_b32 a80, 0
    v_accvgpr_write_b32 a81, 0
    v_mfma_f32_16x16x32_bf16 v[60:63], a[224:227], a[228:231], v[60:63]
    ds_read_b128 a[228:231], v14 offset:16384
    v_mfma_f32_16x16x32_bf16 v[80:83], a[212:215], a[232:235], v[80:83]
    s_waitcnt vmcnt(17)
    v_mfma_f32_16x16x32_bf16 v[84:87], a[216:219], a[232:235], v[84:87]
    buffer_load_dwordx4 v2, s[12:15], s49 offen offset:1024 lds
    v_mfma_f32_16x16x32_bf16 v[88:91], a[220:223], a[232:235], v[88:91]
    ds_read_b64_tr_b16 a[196:197], v9 offset:24576
    v_mfma_f32_16x16x32_bf16 v[92:95], a[224:227], a[232:235], v[92:95]
    ds_read_b128 a[232:235], v14 offset:18432
    v_mfma_f32_16x16x32_bf16 v[112:115], a[212:215], a[236:239], v[112:115]
    ds_read_b64_tr_b16 a[198:199], v9 offset:25600
    v_mfma_f32_16x16x32_bf16 v[116:119], a[216:219], a[236:239], v[116:119]
    v_accvgpr_write_b32 a82, 0
    v_accvgpr_write_b32 a83, 0
    v_mfma_f32_16x16x32_bf16 v[120:123], a[220:223], a[236:239], v[120:123]
    ds_read_b64_tr_b16 a[200:201], v9 offset:24584
    v_mfma_f32_16x16x32_bf16 v[124:127], a[224:227], a[236:239], v[124:127]
    ds_read_b128 a[236:239], v14 offset:20480
    v_mfma_f32_16x16x32_bf16 v[144:147], a[212:215], a[240:243], v[144:147]
    ds_read_b64_tr_b16 a[202:203], v9 offset:25608
    v_mfma_f32_16x16x32_bf16 v[148:151], a[216:219], a[240:243], v[148:151]
    buffer_load_dwordx4 v3, s[12:15], s49 offen offset:2048 lds
    v_mfma_f32_16x16x32_bf16 v[152:155], a[220:223], a[240:243], v[152:155]
    ds_read_b64_tr_b16 a[204:205], v10 offset:24576
    v_mfma_f32_16x16x32_bf16 v[156:159], a[224:227], a[240:243], v[156:159]
    ds_read_b128 a[240:243], v14 offset:22528
    v_mfma_f32_16x16x32_bf16 v[176:179], a[212:215], a[244:247], v[176:179]
    ds_read_b64_tr_b16 a[206:207], v10 offset:25600
    v_mfma_f32_16x16x32_bf16 v[180:183], a[216:219], a[244:247], v[180:183]
    v_accvgpr_write_b32 a84, 0
    v_accvgpr_write_b32 a85, 0
    v_mfma_f32_16x16x32_bf16 v[184:187], a[220:223], a[244:247], v[184:187]
    ds_read_b64_tr_b16 a[208:209], v10 offset:24584
    v_mfma_f32_16x16x32_bf16 v[188:191], a[224:227], a[244:247], v[188:191]
    ds_read_b128 a[244:247], v14 offset:24576
    v_mfma_f32_16x16x32_bf16 v[208:211], a[212:215], a[248:251], v[208:211]
    ds_read_b64_tr_b16 a[210:211], v10 offset:25608
    v_mfma_f32_16x16x32_bf16 v[212:215], a[216:219], a[248:251], v[212:215]
    buffer_load_dwordx4 v4, s[12:15], s49 offen offset:3072 lds
    v_mfma_f32_16x16x32_bf16 v[216:219], a[220:223], a[248:251], v[216:219]
    v_accvgpr_write_b32 a86, 0
    v_accvgpr_write_b32 a87, 0
    v_mfma_f32_16x16x32_bf16 v[220:223], a[224:227], a[248:251], v[220:223]
    s_add_u32 s49, s49, 131072
    s_and_b32 s49, s49, 4194303
    ds_read_b128 a[248:251], v14 offset:26624
    v_mfma_f32_16x16x32_bf16 v[240:243], a[212:215], a[252:255], v[240:243]
    v_accvgpr_write_b32 a88, 0
    v_accvgpr_write_b32 a89, 0
    v_mfma_f32_16x16x32_bf16 v[244:247], a[216:219], a[252:255], v[244:247]
    v_accvgpr_write_b32 a90, 0
    v_accvgpr_write_b32 a91, 0
    v_mfma_f32_16x16x32_bf16 v[248:251], a[220:223], a[252:255], v[248:251]
    s_waitcnt lgkmcnt(1)
    v_mfma_f32_16x16x32_bf16 v[252:255], a[224:227], a[252:255], v[252:255]
    ds_read_b128 a[252:255], v14 offset:28672
    v_mfma_f32_16x16x32_bf16 v[32:35], a[196:199], a[228:231], v[32:35]
    s_add_u32 m0, s48, 16384
    v_mfma_f32_16x16x32_bf16 v[36:39], a[200:203], a[228:231], v[36:39]
    buffer_load_dwordx4 v1, s[12:15], s49 offen offset:0 lds
    v_mfma_f32_16x16x32_bf16 v[40:43], a[204:207], a[228:231], v[40:43]
    v_accvgpr_write_b32 a92, 0
    v_accvgpr_write_b32 a93, 0
    v_mfma_f32_16x16x32_bf16 v[44:47], a[208:211], a[228:231], v[44:47]
    v_accvgpr_write_b32 a94, 0
    v_accvgpr_write_b32 a95, 0
    v_mfma_f32_16x16x32_bf16 v[64:67], a[196:199], a[232:235], v[64:67]
    s_waitcnt vmcnt(21)
    v_mfma_f32_16x16x32_bf16 v[68:71], a[200:203], a[232:235], v[68:71]
    v_accvgpr_write_b32 a96, 0
    v_accvgpr_write_b32 a97, 0
    v_mfma_f32_16x16x32_bf16 v[72:75], a[204:207], a[232:235], v[72:75]
    ds_read_b64_tr_b16 a[212:213], v11 offset:24576
    v_mfma_f32_16x16x32_bf16 v[76:79], a[208:211], a[232:235], v[76:79]
    buffer_load_dwordx4 v2, s[12:15], s49 offen offset:1024 lds
    v_mfma_f32_16x16x32_bf16 v[96:99], a[196:199], a[236:239], v[96:99]
    s_waitcnt lgkmcnt(1)
    ds_read_b64_tr_b16 a[214:215], v11 offset:25600
    v_mfma_f32_16x16x32_bf16 v[100:103], a[200:203], a[236:239], v[100:103]
    v_accvgpr_write_b32 a98, 0
    v_accvgpr_write_b32 a99, 0
    v_mfma_f32_16x16x32_bf16 v[104:107], a[204:207], a[236:239], v[104:107]
    ds_read_b64_tr_b16 a[216:217], v11 offset:24584
    v_mfma_f32_16x16x32_bf16 v[108:111], a[208:211], a[236:239], v[108:111]
    v_accvgpr_write_b32 a100, 0
    v_accvgpr_write_b32 a101, 0
    v_mfma_f32_16x16x32_bf16 v[128:131], a[196:199], a[240:243], v[128:131]
    ds_read_b64_tr_b16 a[218:219], v11 offset:25608
    v_mfma_f32_16x16x32_bf16 v[132:135], a[200:203], a[240:243], v[132:135]
    buffer_load_dwordx4 v3, s[12:15], s49 offen offset:2048 lds
    v_mfma_f32_16x16x32_bf16 v[136:139], a[204:207], a[240:243], v[136:139]
    ds_read_b64_tr_b16 a[220:221], v12 offset:24576
    v_mfma_f32_16x16x32_bf16 v[140:143], a[208:211], a[240:243], v[140:143]
    v_accvgpr_write_b32 a102, 0
    v_accvgpr_write_b32 a103, 0
    v_mfma_f32_16x16x32_bf16 v[160:163], a[196:199], a[244:247], v[160:163]
    ds_read_b64_tr_b16 a[222:223], v12 offset:25600
    v_mfma_f32_16x16x32_bf16 v[164:167], a[200:203], a[244:247], v[164:167]
    v_accvgpr_write_b32 a104, 0
    v_accvgpr_write_b32 a105, 0
    v_mfma_f32_16x16x32_bf16 v[168:171], a[204:207], a[244:247], v[168:171]
    ds_read_b64_tr_b16 a[224:225], v12 offset:24584
    v_mfma_f32_16x16x32_bf16 v[172:175], a[208:211], a[244:247], v[172:175]
    buffer_load_dwordx4 v4, s[12:15], s49 offen offset:3072 lds
    v_mfma_f32_16x16x32_bf16 v[192:195], a[196:199], a[248:251], v[192:195]
    ds_read_b64_tr_b16 a[226:227], v12 offset:25608
    v_mfma_f32_16x16x32_bf16 v[196:199], a[200:203], a[248:251], v[196:199]
    s_add_u32 s49, s49, 131072
    s_and_b32 s49, s49, 4194303
    v_mfma_f32_16x16x32_bf16 v[200:203], a[204:207], a[248:251], v[200:203]
    v_accvgpr_write_b32 a106, 0
    v_accvgpr_write_b32 a107, 0
    v_mfma_f32_16x16x32_bf16 v[204:207], a[208:211], a[248:251], v[204:207]
    s_add_u32 m0, s48, 20480
    v_mfma_f32_16x16x32_bf16 v[224:227], a[196:199], a[252:255], v[224:227]
    v_accvgpr_write_b32 a108, 0
    v_accvgpr_write_b32 a109, 0
    v_mfma_f32_16x16x32_bf16 v[228:231], a[200:203], a[252:255], v[228:231]
    buffer_load_dwordx4 v1, s[12:15], s49 offen offset:0 lds
    v_mfma_f32_16x16x32_bf16 v[232:235], a[204:207], a[252:255], v[232:235]
    s_waitcnt lgkmcnt(0)
    v_mfma_f32_16x16x32_bf16 v[236:239], a[208:211], a[252:255], v[236:239]
    s_waitcnt vmcnt(13)
    s_barrier
    v_mfma_f32_16x16x32_bf16 v[48:51], a[212:215], a[228:231], v[48:51]
    s_add_u32 m0, s56, 16384
    v_mfma_f32_16x16x32_bf16 v[52:55], a[216:219], a[228:231], v[52:55]
    buffer_load_dwordx4 v5, s[8:11], s50 offen offset:0 lds
    v_mfma_f32_16x16x32_bf16 v[56:59], a[220:223], a[228:231], v[56:59]
    v_accvgpr_write_b32 a110, 0
    v_accvgpr_write_b32 a111, 0
    v_mfma_f32_16x16x32_bf16 v[60:63], a[224:227], a[228:231], v[60:63]
    ds_read_b128 a[228:231], v13 offset:0
    v_mfma_f32_16x16x32_bf16 v[80:83], a[212:215], a[232:235], v[80:83]
    s_add_u32 m0, s48, 20480
    s_waitcnt vmcnt(15)
    v_mfma_f32_16x16x32_bf16 v[84:87], a[216:219], a[232:235], v[84:87]
    buffer_load_dwordx4 v2, s[12:15], s49 offen offset:1024 lds
    v_mfma_f32_16x16x32_bf16 v[88:91], a[220:223], a[232:235], v[88:91]
    ds_read_b64_tr_b16 a[196:197], v9 offset:0
    v_mfma_f32_16x16x32_bf16 v[92:95], a[224:227], a[232:235], v[92:95]
    ds_read_b128 a[232:235], v13 offset:2048
    v_mfma_f32_16x16x32_bf16 v[112:115], a[212:215], a[236:239], v[112:115]
    s_add_u32 m0, s56, 16384
    ds_read_b64_tr_b16 a[198:199], v9 offset:1024
    v_mfma_f32_16x16x32_bf16 v[116:119], a[216:219], a[236:239], v[116:119]
    buffer_load_dwordx4 v6, s[8:11], s50 offen offset:1024 lds
    v_mfma_f32_16x16x32_bf16 v[120:123], a[220:223], a[236:239], v[120:123]
    ds_read_b64_tr_b16 a[200:201], v9 offset:8
    v_mfma_f32_16x16x32_bf16 v[124:127], a[224:227], a[236:239], v[124:127]
    ds_read_b128 a[236:239], v13 offset:4096
    v_mfma_f32_16x16x32_bf16 v[144:147], a[212:215], a[240:243], v[144:147]
    s_add_u32 m0, s48, 20480
    ds_read_b64_tr_b16 a[202:203], v9 offset:1032
    v_mfma_f32_16x16x32_bf16 v[148:151], a[216:219], a[240:243], v[148:151]
    buffer_load_dwordx4 v3, s[12:15], s49 offen offset:2048 lds
    v_mfma_f32_16x16x32_bf16 v[152:155], a[220:223], a[240:243], v[152:155]
    ds_read_b64_tr_b16 a[204:205], v10 offset:0
    v_mfma_f32_16x16x32_bf16 v[156:159], a[224:227], a[240:243], v[156:159]
    ds_read_b128 a[240:243], v13 offset:6144
    v_mfma_f32_16x16x32_bf16 v[176:179], a[212:215], a[244:247], v[176:179]
    s_add_u32 m0, s56, 16384
    ds_read_b64_tr_b16 a[206:207], v10 offset:1024
    v_mfma_f32_16x16x32_bf16 v[180:183], a[216:219], a[244:247], v[180:183]
    buffer_load_dwordx4 v7, s[8:11], s50 offen offset:2048 lds
    v_mfma_f32_16x16x32_bf16 v[184:187], a[220:223], a[244:247], v[184:187]
    ds_read_b64_tr_b16 a[208:209], v10 offset:8
    v_mfma_f32_16x16x32_bf16 v[188:191], a[224:227], a[244:247], v[188:191]
    ds_read_b128 a[244:247], v13 offset:8192
    v_mfma_f32_16x16x32_bf16 v[208:211], a[212:215], a[248:251], v[208:211]
    s_add_u32 m0, s48, 20480
    ds_read_b64_tr_b16 a[210:211], v10 offset:1032
    v_mfma_f32_16x16x32_bf16 v[212:215], a[216:219], a[248:251], v[212:215]
    buffer_load_dwordx4 v4, s[12:15], s49 offen offset:3072 lds
    v_mfma_f32_16x16x32_bf16 v[216:219], a[220:223], a[248:251], v[216:219]
    v_accvgpr_write_b32 a112, 0
    v_accvgpr_write_b32 a113, 0
    v_mfma_f32_16x16x32_bf16 v[220:223], a[224:227], a[248:251], v[220:223]
    s_add_u32 s49, s49, 131072
    s_and_b32 s49, s49, 4194303
    ds_read_b128 a[248:251], v13 offset:10240
    v_mfma_f32_16x16x32_bf16 v[240:243], a[212:215], a[252:255], v[240:243]
    s_add_u32 m0, s56, 16384
    v_mfma_f32_16x16x32_bf16 v[244:247], a[216:219], a[252:255], v[244:247]
    buffer_load_dwordx4 v8, s[8:11], s50 offen offset:3072 lds
    v_mfma_f32_16x16x32_bf16 v[248:251], a[220:223], a[252:255], v[248:251]
    s_waitcnt lgkmcnt(1)
    v_mfma_f32_16x16x32_bf16 v[252:255], a[224:227], a[252:255], v[252:255]
    s_add_u32 s98, s98, 128
    s_and_b32 s98, s98, 1023
    s_add_u32 s50, s99, s98
    ds_read_b128 a[252:255], v13 offset:12288
    v_mfma_f32_16x16x32_bf16 v[32:35], a[196:199], a[228:231], v[32:35]
    s_add_u32 m0, s48, 24576
    v_mfma_f32_16x16x32_bf16 v[36:39], a[200:203], a[228:231], v[36:39]
    buffer_load_dwordx4 v1, s[12:15], s49 offen offset:0 lds
    v_mfma_f32_16x16x32_bf16 v[40:43], a[204:207], a[228:231], v[40:43]
    v_accvgpr_write_b32 a114, 0
    v_accvgpr_write_b32 a115, 0
    v_mfma_f32_16x16x32_bf16 v[44:47], a[208:211], a[228:231], v[44:47]
    v_accvgpr_write_b32 a116, 0
    v_accvgpr_write_b32 a117, 0
    v_mfma_f32_16x16x32_bf16 v[64:67], a[196:199], a[232:235], v[64:67]
    s_waitcnt vmcnt(22)
    v_mfma_f32_16x16x32_bf16 v[68:71], a[200:203], a[232:235], v[68:71]
    v_accvgpr_write_b32 a118, 0
    v_accvgpr_write_b32 a119, 0
    v_mfma_f32_16x16x32_bf16 v[72:75], a[204:207], a[232:235], v[72:75]
    ds_read_b64_tr_b16 a[212:213], v11 offset:0
    v_mfma_f32_16x16x32_bf16 v[76:79], a[208:211], a[232:235], v[76:79]
    buffer_load_dwordx4 v2, s[12:15], s49 offen offset:1024 lds
    v_mfma_f32_16x16x32_bf16 v[96:99], a[196:199], a[236:239], v[96:99]
    s_waitcnt lgkmcnt(1)
    ds_read_b64_tr_b16 a[214:215], v11 offset:1024
    v_mfma_f32_16x16x32_bf16 v[100:103], a[200:203], a[236:239], v[100:103]
    v_accvgpr_write_b32 a120, 0
    v_accvgpr_write_b32 a121, 0
    v_mfma_f32_16x16x32_bf16 v[104:107], a[204:207], a[236:239], v[104:107]
    ds_read_b64_tr_b16 a[216:217], v11 offset:8
    v_mfma_f32_16x16x32_bf16 v[108:111], a[208:211], a[236:239], v[108:111]
    v_accvgpr_write_b32 a122, 0
    v_accvgpr_write_b32 a123, 0
    v_mfma_f32_16x16x32_bf16 v[128:131], a[196:199], a[240:243], v[128:131]
    ds_read_b64_tr_b16 a[218:219], v11 offset:1032
    v_mfma_f32_16x16x32_bf16 v[132:135], a[200:203], a[240:243], v[132:135]
    buffer_load_dwordx4 v3, s[12:15], s49 offen offset:2048 lds
    v_mfma_f32_16x16x32_bf16 v[136:139], a[204:207], a[240:243], v[136:139]
    ds_read_b64_tr_b16 a[220:221], v12 offset:0
    v_mfma_f32_16x16x32_bf16 v[140:143], a[208:211], a[240:243], v[140:143]
    v_accvgpr_write_b32 a124, 0
    v_accvgpr_write_b32 a125, 0
    v_mfma_f32_16x16x32_bf16 v[160:163], a[196:199], a[244:247], v[160:163]
    ds_read_b64_tr_b16 a[222:223], v12 offset:1024
    v_mfma_f32_16x16x32_bf16 v[164:167], a[200:203], a[244:247], v[164:167]
    v_accvgpr_write_b32 a126, 0
    v_accvgpr_write_b32 a127, 0
    v_mfma_f32_16x16x32_bf16 v[168:171], a[204:207], a[244:247], v[168:171]
    ds_read_b64_tr_b16 a[224:225], v12 offset:8
    v_mfma_f32_16x16x32_bf16 v[172:175], a[208:211], a[244:247], v[172:175]
    buffer_load_dwordx4 v4, s[12:15], s49 offen offset:3072 lds
    v_mfma_f32_16x16x32_bf16 v[192:195], a[196:199], a[248:251], v[192:195]
    ds_read_b64_tr_b16 a[226:227], v12 offset:1032
    v_mfma_f32_16x16x32_bf16 v[196:199], a[200:203], a[248:251], v[196:199]
    s_add_u32 s49, s49, 131072
    s_and_b32 s49, s49, 4194303
    v_mfma_f32_16x16x32_bf16 v[200:203], a[204:207], a[248:251], v[200:203]
    v_accvgpr_write_b32 a128, 0
    v_accvgpr_write_b32 a129, 0
    v_mfma_f32_16x16x32_bf16 v[204:207], a[208:211], a[248:251], v[204:207]
    s_add_u32 m0, s48, 28672
    v_mfma_f32_16x16x32_bf16 v[224:227], a[196:199], a[252:255], v[224:227]
    v_accvgpr_write_b32 a130, 0
    v_accvgpr_write_b32 a131, 0
    v_mfma_f32_16x16x32_bf16 v[228:231], a[200:203], a[252:255], v[228:231]
    buffer_load_dwordx4 v1, s[12:15], s49 offen offset:0 lds
    v_mfma_f32_16x16x32_bf16 v[232:235], a[204:207], a[252:255], v[232:235]
    s_waitcnt lgkmcnt(0)
    v_mfma_f32_16x16x32_bf16 v[236:239], a[208:211], a[252:255], v[236:239]
    v_accvgpr_write_b32 a132, 0
    v_accvgpr_write_b32 a133, 0
    v_mfma_f32_16x16x32_bf16 v[48:51], a[212:215], a[228:231], v[48:51]
    v_accvgpr_write_b32 a134, 0
    v_accvgpr_write_b32 a135, 0
    v_mfma_f32_16x16x32_bf16 v[52:55], a[216:219], a[228:231], v[52:55]
    v_accvgpr_write_b32 a136, 0
    v_accvgpr_write_b32 a137, 0
    v_mfma_f32_16x16x32_bf16 v[56:59], a[220:223], a[228:231], v[56:59]
    v_accvgpr_write_b32 a138, 0
    v_accvgpr_write_b32 a139, 0
    v_mfma_f32_16x16x32_bf16 v[60:63], a[224:227], a[228:231], v[60:63]
    ds_read_b128 a[228:231], v14 offset:0
    v_mfma_f32_16x16x32_bf16 v[80:83], a[212:215], a[232:235], v[80:83]
    s_waitcnt vmcnt(17)
    v_mfma_f32_16x16x32_bf16 v[84:87], a[216:219], a[232:235], v[84:87]
    buffer_load_dwordx4 v2, s[12:15], s49 offen offset:1024 lds
    v_mfma_f32_16x16x32_bf16 v[88:91], a[220:223], a[232:235], v[88:91]
    ds_read_b64_tr_b16 a[196:197], v9 offset:8192
    v_mfma_f32_16x16x32_bf16 v[92:95], a[224:227], a[232:235], v[92:95]
    ds_read_b128 a[232:235], v14 offset:2048
    v_mfma_f32_16x16x32_bf16 v[112:115], a[212:215], a[236:239], v[112:115]
    ds_read_b64_tr_b16 a[198:199], v9 offset:9216
    v_mfma_f32_16x16x32_bf16 v[116:119], a[216:219], a[236:239], v[116:119]
    v_accvgpr_write_b32 a140, 0
    v_accvgpr_write_b32 a141, 0
    v_mfma_f32_16x16x32_bf16 v[120:123], a[220:223], a[236:239], v[120:123]
    ds_read_b64_tr_b16 a[200:201], v9 offset:8200
    v_mfma_f32_16x16x32_bf16 v[124:127], a[224:227], a[236:239], v[124:127]
    ds_read_b128 a[236:239], v14 offset:4096
    v_mfma_f32_16x16x32_bf16 v[144:147], a[212:215], a[240:243], v[144:147]
    ds_read_b64_tr_b16 a[202:203], v9 offset:9224
    v_mfma_f32_16x16x32_bf16 v[148:151], a[216:219], a[240:243], v[148:151]
    buffer_load_dwordx4 v3, s[12:15], s49 offen offset:2048 lds
    v_mfma_f32_16x16x32_bf16 v[152:155], a[220:223], a[240:243], v[152:155]
    ds_read_b64_tr_b16 a[204:205], v10 offset:8192
    v_mfma_f32_16x16x32_bf16 v[156:159], a[224:227], a[240:243], v[156:159]
    ds_read_b128 a[240:243], v14 offset:6144
    v_mfma_f32_16x16x32_bf16 v[176:179], a[212:215], a[244:247], v[176:179]
    ds_read_b64_tr_b16 a[206:207], v10 offset:9216
    v_mfma_f32_16x16x32_bf16 v[180:183], a[216:219], a[244:247], v[180:183]
    v_accvgpr_write_b32 a142, 0
    v_accvgpr_write_b32 a143, 0
    v_mfma_f32_16x16x32_bf16 v[184:187], a[220:223], a[244:247], v[184:187]
    ds_read_b64_tr_b16 a[208:209], v10 offset:8200
    v_mfma_f32_16x16x32_bf16 v[188:191], a[224:227], a[244:247], v[188:191]
    ds_read_b128 a[244:247], v14 offset:8192
    v_mfma_f32_16x16x32_bf16 v[208:211], a[212:215], a[248:251], v[208:211]
    ds_read_b64_tr_b16 a[210:211], v10 offset:9224
    v_mfma_f32_16x16x32_bf16 v[212:215], a[216:219], a[248:251], v[212:215]
    buffer_load_dwordx4 v4, s[12:15], s49 offen offset:3072 lds
    v_mfma_f32_16x16x32_bf16 v[216:219], a[220:223], a[248:251], v[216:219]
    v_accvgpr_write_b32 a144, 0
    v_accvgpr_write_b32 a145, 0
    v_mfma_f32_16x16x32_bf16 v[220:223], a[224:227], a[248:251], v[220:223]
    s_add_u32 s49, s49, 131072
    s_and_b32 s49, s49, 4194303
    ds_read_b128 a[248:251], v14 offset:10240
    v_mfma_f32_16x16x32_bf16 v[240:243], a[212:215], a[252:255], v[240:243]
    v_accvgpr_write_b32 a146, 0
    v_accvgpr_write_b32 a147, 0
    v_mfma_f32_16x16x32_bf16 v[244:247], a[216:219], a[252:255], v[244:247]
    v_accvgpr_write_b32 a148, 0
    v_accvgpr_write_b32 a149, 0
    v_mfma_f32_16x16x32_bf16 v[248:251], a[220:223], a[252:255], v[248:251]
    s_waitcnt lgkmcnt(1)
    v_mfma_f32_16x16x32_bf16 v[252:255], a[224:227], a[252:255], v[252:255]
    ds_read_b128 a[252:255], v14 offset:12288
    v_accvgpr_write_b32 a150, 0
    v_accvgpr_write_b32 a151, 0
    v_accvgpr_write_b32 a152, 0
    v_accvgpr_write_b32 a153, 0
    v_accvgpr_write_b32 a154, 0
    v_accvgpr_write_b32 a155, 0
    v_accvgpr_write_b32 a156, 0
    v_accvgpr_write_b32 a157, 0
    v_accvgpr_write_b32 a158, 0
    v_accvgpr_write_b32 a159, 0
    v_accvgpr_write_b32 a160, 0
    v_accvgpr_write_b32 a161, 0
    v_accvgpr_write_b32 a162, 0
    v_accvgpr_write_b32 a163, 0
    v_accvgpr_write_b32 a164, 0
    v_accvgpr_write_b32 a165, 0
    v_accvgpr_write_b32 a166, 0
    v_accvgpr_write_b32 a167, 0
    v_accvgpr_write_b32 a168, 0
    v_accvgpr_write_b32 a169, 0
    v_accvgpr_write_b32 a170, 0
    v_accvgpr_write_b32 a171, 0
    v_accvgpr_write_b32 a172, 0
    v_accvgpr_write_b32 a173, 0
    v_accvgpr_write_b32 a174, 0
    v_accvgpr_write_b32 a175, 0
    v_accvgpr_write_b32 a176, 0
    v_accvgpr_write_b32 a177, 0
    v_accvgpr_write_b32 a178, 0
    v_accvgpr_write_b32 a179, 0
    v_accvgpr_write_b32 a180, 0
    v_accvgpr_write_b32 a181, 0
    v_accvgpr_write_b32 a182, 0
    v_accvgpr_write_b32 a183, 0
    v_accvgpr_write_b32 a184, 0
    v_accvgpr_write_b32 a185, 0
    v_accvgpr_write_b32 a186, 0
    v_accvgpr_write_b32 a187, 0
    v_accvgpr_write_b32 a188, 0
    v_accvgpr_write_b32 a189, 0
    v_accvgpr_write_b32 a190, 0
    v_accvgpr_write_b32 a191, 0
    v_accvgpr_write_b32 a192, 0
    v_accvgpr_write_b32 a193, 0
    v_accvgpr_write_b32 a194, 0
    v_accvgpr_write_b32 a195, 0
    v_mfma_f32_16x16x32_bf16 v[32:35], a[196:199], a[228:231], v[32:35]
    s_add_u32 m0, s48, 0
    v_mfma_f32_16x16x32_bf16 v[36:39], a[200:203], a[228:231], v[36:39]
    buffer_load_dwordx4 v15, s[16:19], s51 offen offset:0 nt lds
    v_mfma_f32_16x16x32_bf16 v[40:43], a[204:207], a[228:231], v[40:43]
    v_mfma_f32_16x16x32_bf16 v[44:47], a[208:211], a[228:231], v[44:47]
    v_mfma_f32_16x16x32_bf16 v[64:67], a[196:199], a[232:235], v[64:67]
    s_waitcnt vmcnt(21)
    v_mfma_f32_16x16x32_bf16 v[68:71], a[200:203], a[232:235], v[68:71]
    v_mfma_f32_16x16x32_bf16 v[72:75], a[204:207], a[232:235], v[72:75]
    ds_read_b64_tr_b16 a[212:213], v11 offset:8192
    v_mfma_f32_16x16x32_bf16 v[76:79], a[208:211], a[232:235], v[76:79]
    buffer_load_dwordx4 v16, s[16:19], s51 offen offset:1024 nt lds
    v_mfma_f32_16x16x32_bf16 v[96:99], a[196:199], a[236:239], v[96:99]
    s_waitcnt lgkmcnt(1)
    ds_read_b64_tr_b16 a[214:215], v11 offset:9216
    v_mfma_f32_16x16x32_bf16 v[100:103], a[200:203], a[236:239], v[100:103]
    v_mfma_f32_16x16x32_bf16 v[104:107], a[204:207], a[236:239], v[104:107]
    ds_read_b64_tr_b16 a[216:217], v11 offset:8200
    v_mfma_f32_16x16x32_bf16 v[108:111], a[208:211], a[236:239], v[108:111]
    v_mfma_f32_16x16x32_bf16 v[128:131], a[196:199], a[240:243], v[128:131]
    ds_read_b64_tr_b16 a[218:219], v11 offset:9224
    v_mfma_f32_16x16x32_bf16 v[132:135], a[200:203], a[240:243], v[132:135]
    buffer_load_dwordx4 v17, s[16:19], s51 offen offset:2048 nt lds
    v_mfma_f32_16x16x32_bf16 v[136:139], a[204:207], a[240:243], v[136:139]
    ds_read_b64_tr_b16 a[220:221], v12 offset:8192
    v_mfma_f32_16x16x32_bf16 v[140:143], a[208:211], a[240:243], v[140:143]
    v_mfma_f32_16x16x32_bf16 v[160:163], a[196:199], a[244:247], v[160:163]
    ds_read_b64_tr_b16 a[222:223], v12 offset:9216
    v_mfma_f32_16x16x32_bf16 v[164:167], a[200:203], a[244:247], v[164:167]
    v_mfma_f32_16x16x32_bf16 v[168:171], a[204:207], a[244:247], v[168:171]
    ds_read_b64_tr_b16 a[224:225], v12 offset:8200
    v_mfma_f32_16x16x32_bf16 v[172:175], a[208:211], a[244:247], v[172:175]
    buffer_load_dwordx4 v18, s[16:19], s51 offen offset:3072 nt lds
    v_mfma_f32_16x16x32_bf16 v[192:195], a[196:199], a[248:251], v[192:195]
    ds_read_b64_tr_b16 a[226:227], v12 offset:9224
    v_mfma_f32_16x16x32_bf16 v[196:199], a[200:203], a[248:251], v[196:199]
    s_add_u32 s51, s51, 4096
    v_mfma_f32_16x16x32_bf16 v[200:203], a[204:207], a[248:251], v[200:203]
    v_mfma_f32_16x16x32_bf16 v[204:207], a[208:211], a[248:251], v[204:207]
    s_add_u32 m0, s48, 4096
    v_mfma_f32_16x16x32_bf16 v[224:227], a[196:199], a[252:255], v[224:227]
    v_mfma_f32_16x16x32_bf16 v[228:231], a[200:203], a[252:255], v[228:231]
    buffer_load_dwordx4 v15, s[16:19], s51 offen offset:0 nt lds
    v_mfma_f32_16x16x32_bf16 v[232:235], a[204:207], a[252:255], v[232:235]
    s_waitcnt lgkmcnt(0)
    v_mfma_f32_16x16x32_bf16 v[236:239], a[208:211], a[252:255], v[236:239]
    s_waitcnt vmcnt(13)
    s_barrier
    v_mfma_f32_16x16x32_bf16 v[48:51], a[212:215], a[228:231], v[48:51]
    v_mfma_f32_16x16x32_bf16 v[52:55], a[216:219], a[228:231], v[52:55]
    v_mfma_f32_16x16x32_bf16 v[56:59], a[220:223], a[228:231], v[56:59]
    v_mfma_f32_16x16x32_bf16 v[60:63], a[224:227], a[228:231], v[60:63]
    ds_read_b128 a[228:231], v13 offset:16384
    v_mfma_f32_16x16x32_bf16 v[80:83], a[212:215], a[232:235], v[80:83]
    s_waitcnt vmcnt(14)
    v_mfma_f32_16x16x32_bf16 v[84:87], a[216:219], a[232:235], v[84:87]
    buffer_load_dwordx4 v16, s[16:19], s51 offen offset:1024 nt lds
    v_mfma_f32_16x16x32_bf16 v[88:91], a[220:223], a[232:235], v[88:91]
    ds_read_b64_tr_b16 a[196:197], v9 offset:16384
    v_mfma_f32_16x16x32_bf16 v[92:95], a[224:227], a[232:235], v[92:95]
    ds_read_b128 a[232:235], v13 offset:18432
    v_mfma_f32_16x16x32_bf16 v[112:115], a[212:215], a[236:239], v[112:115]
    ds_read_b64_tr_b16 a[198:199], v9 offset:17408
    v_mfma_f32_16x16x32_bf16 v[116:119], a[216:219], a[236:239], v[116:119]
    v_mfma_f32_16x16x32_bf16 v[120:123], a[220:223], a[236:239], v[120:123]
    ds_read_b64_tr_b16 a[200:201], v9 offset:16392
    v_mfma_f32_16x16x32_bf16 v[124:127], a[224:227], a[236:239], v[124:127]
    ds_read_b128 a[236:239], v13 offset:20480
    v_mfma_f32_16x16x32_bf16 v[144:147], a[212:215], a[240:243], v[144:147]
    ds_read_b64_tr_b16 a[202:203], v9 offset:17416
    v_mfma_f32_16x16x32_bf16 v[148:151], a[216:219], a[240:243], v[148:151]
    buffer_load_dwordx4 v17, s[16:19], s51 offen offset:2048 nt lds
    v_mfma_f32_16x16x32_bf16 v[152:155], a[220:223], a[240:243], v[152:155]
    ds_read_b64_tr_b16 a[204:205], v10 offset:16384
    v_mfma_f32_16x16x32_bf16 v[156:159], a[224:227], a[240:243], v[156:159]
    ds_read_b128 a[240:243], v13 offset:22528
    v_mfma_f32_16x16x32_bf16 v[176:179], a[212:215], a[244:247], v[176:179]
    ds_read_b64_tr_b16 a[206:207], v10 offset:17408
    v_mfma_f32_16x16x32_bf16 v[180:183], a[216:219], a[244:247], v[180:183]
    v_mfma_f32_16x16x32_bf16 v[184:187], a[220:223], a[244:247], v[184:187]
    ds_read_b64_tr_b16 a[208:209], v10 offset:16392
    v_mfma_f32_16x16x32_bf16 v[188:191], a[224:227], a[244:247], v[188:191]
    ds_read_b128 a[244:247], v13 offset:24576
    v_mfma_f32_16x16x32_bf16 v[208:211], a[212:215], a[248:251], v[208:211]
    ds_read_b64_tr_b16 a[210:211], v10 offset:17416
    v_mfma_f32_16x16x32_bf16 v[212:215], a[216:219], a[248:251], v[212:215]
    buffer_load_dwordx4 v18, s[16:19], s51 offen offset:3072 nt lds
    v_mfma_f32_16x16x32_bf16 v[216:219], a[220:223], a[248:251], v[216:219]
    v_mfma_f32_16x16x32_bf16 v[220:223], a[224:227], a[248:251], v[220:223]
    s_add_u32 s51, s51, 4096
    ds_read_b128 a[248:251], v13 offset:26624
    v_mfma_f32_16x16x32_bf16 v[240:243], a[212:215], a[252:255], v[240:243]
    v_mfma_f32_16x16x32_bf16 v[244:247], a[216:219], a[252:255], v[244:247]
    v_mfma_f32_16x16x32_bf16 v[248:251], a[220:223], a[252:255], v[248:251]
    s_waitcnt lgkmcnt(1)
    v_mfma_f32_16x16x32_bf16 v[252:255], a[224:227], a[252:255], v[252:255]
    ds_read_b128 a[252:255], v13 offset:28672
    v_mfma_f32_16x16x32_bf16 v[32:35], a[196:199], a[228:231], v[32:35]
    s_add_u32 m0, s48, 8192
    v_mfma_f32_16x16x32_bf16 v[36:39], a[200:203], a[228:231], v[36:39]
    buffer_load_dwordx4 v19, s[20:23], s52 offen offset:0 nt lds
    v_mfma_f32_16x16x32_bf16 v[40:43], a[204:207], a[228:231], v[40:43]
    v_xor_b32 v24, v23, v31
    v_lshlrev_b32 v24, 4, v24
    v_mfma_f32_16x16x32_bf16 v[44:47], a[208:211], a[228:231], v[44:47]
    v_lshl_add_u32 v24, v31, 8, v24
    v_add_u32 v1, s48, v24
    v_mfma_f32_16x16x32_bf16 v[64:67], a[196:199], a[232:235], v[64:67]
    s_waitcnt vmcnt(18)
    v_mfma_f32_16x16x32_bf16 v[68:71], a[200:203], a[232:235], v[68:71]
    v_xor_b32 v2, 64, v1
    v_xor_b32 v3, 128, v1
    v_mfma_f32_16x16x32_bf16 v[72:75], a[204:207], a[232:235], v[72:75]
    ds_read_b64_tr_b16 a[212:213], v11 offset:16384
    v_mfma_f32_16x16x32_bf16 v[76:79], a[208:211], a[232:235], v[76:79]
    buffer_load_dwordx4 v20, s[20:23], s52 offen offset:1024 nt lds
    v_mfma_f32_16x16x32_bf16 v[96:99], a[196:199], a[236:239], v[96:99]
    s_waitcnt lgkmcnt(1)
    ds_read_b64_tr_b16 a[214:215], v11 offset:17408
    v_mfma_f32_16x16x32_bf16 v[100:103], a[200:203], a[236:239], v[100:103]
    v_xor_b32 v4, 192, v1
    v_lshrrev_b32 v24, 2, v0
    v_mfma_f32_16x16x32_bf16 v[104:107], a[204:207], a[236:239], v[104:107]
    ds_read_b64_tr_b16 a[216:217], v11 offset:16392
    v_mfma_f32_16x16x32_bf16 v[108:111], a[208:211], a[236:239], v[108:111]
    v_bfe_u32 v25, v0, 4, 1
    v_lshlrev_b32 v25, 1, v25
    v_mfma_f32_16x16x32_bf16 v[128:131], a[196:199], a[240:243], v[128:131]
    ds_read_b64_tr_b16 a[218:219], v11 offset:17416
    v_mfma_f32_16x16x32_bf16 v[132:135], a[200:203], a[240:243], v[132:135]
    buffer_load_dwordx4 v19, s[20:23], s52 offen offset:2048 nt lds
    v_mfma_f32_16x16x32_bf16 v[136:139], a[204:207], a[240:243], v[136:139]
    ds_read_b64_tr_b16 a[220:221], v12 offset:16384
    v_mfma_f32_16x16x32_bf16 v[140:143], a[208:211], a[240:243], v[140:143]
    v_and_b32 v26, 3, v0
    v_xor_b32 v25, v25, v26
    v_mfma_f32_16x16x32_bf16 v[160:163], a[196:199], a[244:247], v[160:163]
    ds_read_b64_tr_b16 a[222:223], v12 offset:17408
    v_mfma_f32_16x16x32_bf16 v[164:167], a[200:203], a[244:247], v[164:167]
    v_lshlrev_b32 v25, 4, v25
    v_lshl_add_u32 v5, v24, 10, v25
    v_mfma_f32_16x16x32_bf16 v[168:171], a[204:207], a[244:247], v[168:171]
    ds_read_b64_tr_b16 a[224:225], v12 offset:16392
    v_mfma_f32_16x16x32_bf16 v[172:175], a[208:211], a[244:247], v[172:175]
    buffer_load_dwordx4 v20, s[20:23], s52 offen offset:3072 nt lds
    v_mfma_f32_16x16x32_bf16 v[192:195], a[196:199], a[248:251], v[192:195]
    ds_read_b64_tr_b16 a[226:227], v12 offset:17416
    v_mfma_f32_16x16x32_bf16 v[196:199], a[200:203], a[248:251], v[196:199]
    s_add_u32 s52, s52, 4096
    v_mfma_f32_16x16x32_bf16 v[200:203], a[204:207], a[248:251], v[200:203]
    v_add_u32 v6, 15360, v5
    v_lshrrev_b32 v24, 1, v0
    v_mfma_f32_16x16x32_bf16 v[204:207], a[208:211], a[248:251], v[204:207]
    s_add_u32 m0, s48, 12288
    v_mfma_f32_16x16x32_bf16 v[224:227], a[196:199], a[252:255], v[224:227]
    v_lshlrev_b32 v24, 10, v24
    v_and_b32 v25, 1, v0
    v_mfma_f32_16x16x32_bf16 v[228:231], a[200:203], a[252:255], v[228:231]
    buffer_load_dwordx4 v19, s[20:23], s52 offen offset:0 nt lds
    v_mfma_f32_16x16x32_bf16 v[232:235], a[204:207], a[252:255], v[232:235]
    s_waitcnt lgkmcnt(0)
    v_mfma_f32_16x16x32_bf16 v[236:239], a[208:211], a[252:255], v[236:239]
    v_lshl_add_u32 v7, v25, 7, v24
    v_mfma_f32_16x16x32_bf16 v[48:51], a[212:215], a[228:231], v[48:51]
    v_mfma_f32_16x16x32_bf16 v[52:55], a[216:219], a[228:231], v[52:55]
    v_mfma_f32_16x16x32_bf16 v[56:59], a[220:223], a[228:231], v[56:59]
    v_mfma_f32_16x16x32_bf16 v[60:63], a[224:227], a[228:231], v[60:63]
    ds_read_b128 a[228:231], v14 offset:16384
    v_mfma_f32_16x16x32_bf16 v[80:83], a[212:215], a[232:235], v[80:83]
    s_waitcnt vmcnt(13)
    v_mfma_f32_16x16x32_bf16 v[84:87], a[216:219], a[232:235], v[84:87]
    buffer_load_dwordx4 v20, s[20:23], s52 offen offset:1024 nt lds
    v_mfma_f32_16x16x32_bf16 v[88:91], a[220:223], a[232:235], v[88:91]
    ds_read_b64_tr_b16 a[196:197], v9 offset:24576
    v_mfma_f32_16x16x32_bf16 v[92:95], a[224:227], a[232:235], v[92:95]
    ds_read_b128 a[232:235], v14 offset:18432
    v_mfma_f32_16x16x32_bf16 v[112:115], a[212:215], a[236:239], v[112:115]
    ds_read_b64_tr_b16 a[198:199], v9 offset:25600
    v_mfma_f32_16x16x32_bf16 v[116:119], a[216:219], a[236:239], v[116:119]
    v_mfma_f32_16x16x32_bf16 v[120:123], a[220:223], a[236:239], v[120:123]
    ds_read_b64_tr_b16 a[200:201], v9 offset:24584
    v_mfma_f32_16x16x32_bf16 v[124:127], a[224:227], a[236:239], v[124:127]
    ds_read_b128 a[236:239], v14 offset:20480
    v_mfma_f32_16x16x32_bf16 v[144:147], a[212:215], a[240:243], v[144:147]
    ds_read_b64_tr_b16 a[202:203], v9 offset:25608
    v_mfma_f32_16x16x32_bf16 v[148:151], a[216:219], a[240:243], v[148:151]
    buffer_load_dwordx4 v19, s[20:23], s52 offen offset:2048 nt lds
    v_mfma_f32_16x16x32_bf16 v[152:155], a[220:223], a[240:243], v[152:155]
    ds_read_b64_tr_b16 a[204:205], v10 offset:24576
    v_mfma_f32_16x16x32_bf16 v[156:159], a[224:227], a[240:243], v[156:159]
    ds_read_b128 a[240:243], v14 offset:22528
    v_mfma_f32_16x16x32_bf16 v[176:179], a[212:215], a[244:247], v[176:179]
    ds_read_b64_tr_b16 a[206:207], v10 offset:25600
    v_mfma_f32_16x16x32_bf16 v[180:183], a[216:219], a[244:247], v[180:183]
    v_mfma_f32_16x16x32_bf16 v[184:187], a[220:223], a[244:247], v[184:187]
    ds_read_b64_tr_b16 a[208:209], v10 offset:24584
    v_mfma_f32_16x16x32_bf16 v[188:191], a[224:227], a[244:247], v[188:191]
    ds_read_b128 a[244:247], v14 offset:24576
    v_mfma_f32_16x16x32_bf16 v[208:211], a[212:215], a[248:251], v[208:211]
    ds_read_b64_tr_b16 a[210:211], v10 offset:25608
    v_mfma_f32_16x16x32_bf16 v[212:215], a[216:219], a[248:251], v[212:215]
    buffer_load_dwordx4 v20, s[20:23], s52 offen offset:3072 nt lds
    v_mfma_f32_16x16x32_bf16 v[216:219], a[220:223], a[248:251], v[216:219]
    v_mfma_f32_16x16x32_bf16 v[220:223], a[224:227], a[248:251], v[220:223]
    s_add_u32 s52, s52, 4096
    ds_read_b128 a[248:251], v14 offset:26624
    v_mfma_f32_16x16x32_bf16 v[240:243], a[212:215], a[252:255], v[240:243]
    v_mfma_f32_16x16x32_bf16 v[244:247], a[216:219], a[252:255], v[244:247]
    v_mfma_f32_16x16x32_bf16 v[248:251], a[220:223], a[252:255], v[248:251]
    s_waitcnt lgkmcnt(1)
    v_mfma_f32_16x16x32_bf16 v[252:255], a[224:227], a[252:255], v[252:255]
    ds_read_b128 a[252:255], v14 offset:28672
    v_mfma_f32_16x16x32_bf16 v[32:35], a[196:199], a[228:231], v[32:35]
    s_add_u32 m0, s48, 16384
    v_mfma_f32_16x16x32_bf16 v[36:39], a[200:203], a[228:231], v[36:39]
    buffer_load_dwordx4 v15, s[16:19], s51 offen offset:0 nt lds
    v_mfma_f32_16x16x32_bf16 v[40:43], a[204:207], a[228:231], v[40:43]
    v_mfma_f32_16x16x32_bf16 v[44:47], a[208:211], a[228:231], v[44:47]
    buffer_load_dwordx4 v16, s[16:19], s51 offen offset:1024 nt lds
    v_mfma_f32_16x16x32_bf16 v[64:67], a[196:199], a[232:235], v[64:67]
    s_waitcnt vmcnt(18)
    v_mfma_f32_16x16x32_bf16 v[68:71], a[200:203], a[232:235], v[68:71]
    buffer_load_dwordx4 v17, s[16:19], s51 offen offset:2048 nt lds
    v_mfma_f32_16x16x32_bf16 v[72:75], a[204:207], a[232:235], v[72:75]
    ds_read_b64_tr_b16 a[212:213], v11 offset:24576
    v_mul_f32 v32, s54, v32
    v_mfma_f32_16x16x32_bf16 v[76:79], a[208:211], a[232:235], v[76:79]
    buffer_load_dwordx4 v18, s[16:19], s51 offen offset:3072 nt lds
    v_mfma_f32_16x16x32_bf16 v[96:99], a[196:199], a[236:239], v[96:99]
    s_waitcnt lgkmcnt(1)
    ds_read_b64_tr_b16 a[214:215], v11 offset:25600
    v_mfma_f32_16x16x32_bf16 v[100:103], a[200:203], a[236:239], v[100:103]
    s_add_u32 s51, s51, 4096
    s_add_u32 m0, s48, 20480
    v_mfma_f32_16x16x32_bf16 v[104:107], a[204:207], a[236:239], v[104:107]
    ds_read_b64_tr_b16 a[216:217], v11 offset:24584
    v_mul_f32 v33, s54, v33
    v_mfma_f32_16x16x32_bf16 v[108:111], a[208:211], a[236:239], v[108:111]
    buffer_load_dwordx4 v15, s[16:19], s51 offen offset:0 nt lds
    v_mfma_f32_16x16x32_bf16 v[128:131], a[196:199], a[240:243], v[128:131]
    ds_read_b64_tr_b16 a[218:219], v11 offset:25608
    v_mul_f32 v34, s54, v34
    v_mfma_f32_16x16x32_bf16 v[132:135], a[200:203], a[240:243], v[132:135]
    buffer_load_dwordx4 v16, s[16:19], s51 offen offset:1024 nt lds
    v_mfma_f32_16x16x32_bf16 v[136:139], a[204:207], a[240:243], v[136:139]
    ds_read_b64_tr_b16 a[220:221], v12 offset:24576
    v_mul_f32 v35, s54, v35
    v_mfma_f32_16x16x32_bf16 v[140:143], a[208:211], a[240:243], v[140:143]
    buffer_load_dwordx4 v17, s[16:19], s51 offen offset:2048 nt lds
    v_mfma_f32_16x16x32_bf16 v[160:163], a[196:199], a[244:247], v[160:163]
    ds_read_b64_tr_b16 a[222:223], v12 offset:25600
    v_mul_f32 v36, s54, v36
    v_mfma_f32_16x16x32_bf16 v[164:167], a[200:203], a[244:247], v[164:167]
    buffer_load_dwordx4 v18, s[16:19], s51 offen offset:3072 nt lds
    v_mfma_f32_16x16x32_bf16 v[168:171], a[204:207], a[244:247], v[168:171]
    ds_read_b64_tr_b16 a[224:225], v12 offset:24584
    v_mul_f32 v37, s54, v37
    v_mfma_f32_16x16x32_bf16 v[172:175], a[208:211], a[244:247], v[172:175]
    s_add_u32 s51, s51, 4096
    v_mfma_f32_16x16x32_bf16 v[192:195], a[196:199], a[248:251], v[192:195]
    ds_read_b64_tr_b16 a[226:227], v12 offset:25608
    v_mul_f32 v38, s54, v38
    v_mfma_f32_16x16x32_bf16 v[196:199], a[200:203], a[248:251], v[196:199]
    v_mul_f32 v39, s54, v39
    v_cvt_pk_bf16_f32 v32, v32, v33
    v_mfma_f32_16x16x32_bf16 v[200:203], a[204:207], a[248:251], v[200:203]
    v_cvt_pk_bf16_f32 v33, v34, v35
    v_cvt_pk_bf16_f32 v34, v36, v37
    v_mfma_f32_16x16x32_bf16 v[204:207], a[208:211], a[248:251], v[204:207]
    v_cvt_pk_bf16_f32 v35, v38, v39
    v_mul_f32 v40, s54, v40
    v_mfma_f32_16x16x32_bf16 v[224:227], a[196:199], a[252:255], v[224:227]
    v_mul_f32 v41, s54, v41
    v_mul_f32 v42, s54, v42
    v_mfma_f32_16x16x32_bf16 v[228:231], a[200:203], a[252:255], v[228:231]
    v_mul_f32 v43, s54, v43
    v_mul_f32 v44, s54, v44
    v_mfma_f32_16x16x32_bf16 v[232:235], a[204:207], a[252:255], v[232:235]
    s_waitcnt lgkmcnt(0)
    v_mul_f32 v45, s54, v45
    v_mul_f32 v46, s54, v46
    v_mfma_f32_16x16x32_bf16 v[236:239], a[208:211], a[252:255], v[236:239]
    s_barrier
    v_mfma_f32_16x16x32_bf16 v[48:51], a[212:215], a[228:231], v[48:51]
    v_lshrrev_b32 v24, 2, v31
    v_lshl_add_u32 v24, v23, 2, v24
    v_mfma_f32_16x16x32_bf16 v[52:55], a[216:219], a[228:231], v[52:55]
    v_and_b32 v25, 7, v24
    v_lshlrev_b32 v25, 1, v25
    v_mfma_f32_16x16x32_bf16 v[56:59], a[220:223], a[228:231], v[56:59]
    v_bfe_u32 v26, v31, 1, 1
    v_xor_b32 v25, v25, v26
    v_mfma_f32_16x16x32_bf16 v[60:63], a[224:227], a[228:231], v[60:63]
    v_lshlrev_b32 v25, 4, v25
    v_lshl_add_u32 v25, v24, 8, v25
    v_mfma_f32_16x16x32_bf16 v[80:83], a[212:215], a[232:235], v[80:83]
    v_and_b32 v26, 1, v31
    v_lshl_add_u32 v25, v26, 3, v25
    v_mfma_f32_16x16x32_bf16 v[84:87], a[216:219], a[232:235], v[84:87]
    v_add_u32 v9, s48, v25
    v_xor_b32 v10, 32, v9
    v_mfma_f32_16x16x32_bf16 v[88:91], a[220:223], a[232:235], v[88:91]
    v_xor_b32 v11, 64, v9
    v_xor_b32 v12, 96, v9
    v_mfma_f32_16x16x32_bf16 v[92:95], a[224:227], a[232:235], v[92:95]
    v_xor_b32 v13, 128, v9
    v_xor_b32 v14, 160, v9
    v_mfma_f32_16x16x32_bf16 v[112:115], a[212:215], a[236:239], v[112:115]
    v_xor_b32 v21, 192, v9
    v_xor_b32 v22, 224, v9
    v_mfma_f32_16x16x32_bf16 v[116:119], a[216:219], a[236:239], v[116:119]
    v_mul_f32 v47, s54, v47
    v_cvt_pk_bf16_f32 v36, v40, v41
    v_mfma_f32_16x16x32_bf16 v[120:123], a[220:223], a[236:239], v[120:123]
    v_cvt_pk_bf16_f32 v37, v42, v43
    v_cvt_pk_bf16_f32 v38, v44, v45
    v_mfma_f32_16x16x32_bf16 v[124:127], a[224:227], a[236:239], v[124:127]
    v_cvt_pk_bf16_f32 v39, v46, v47
    v_mul_f32 v64, s54, v64
    v_mfma_f32_16x16x32_bf16 v[144:147], a[212:215], a[240:243], v[144:147]
    v_mul_f32 v65, s54, v65
    v_mul_f32 v66, s54, v66
    v_mfma_f32_16x16x32_bf16 v[148:151], a[216:219], a[240:243], v[148:151]
    v_mul_f32 v67, s54, v67
    v_mul_f32 v68, s54, v68
    v_mfma_f32_16x16x32_bf16 v[152:155], a[220:223], a[240:243], v[152:155]
    v_mul_f32 v69, s54, v69
    v_mul_f32 v70, s54, v70
    v_mfma_f32_16x16x32_bf16 v[156:159], a[224:227], a[240:243], v[156:159]
    v_mul_f32 v71, s54, v71
    v_cvt_pk_bf16_f32 v64, v64, v65
    v_mfma_f32_16x16x32_bf16 v[176:179], a[212:215], a[244:247], v[176:179]
    v_cvt_pk_bf16_f32 v65, v66, v67
    v_cvt_pk_bf16_f32 v66, v68, v69
    v_mfma_f32_16x16x32_bf16 v[180:183], a[216:219], a[244:247], v[180:183]
    v_cvt_pk_bf16_f32 v67, v70, v71
    v_mul_f32 v72, s54, v72
    v_mfma_f32_16x16x32_bf16 v[184:187], a[220:223], a[244:247], v[184:187]
    v_mul_f32 v73, s54, v73
    v_mul_f32 v74, s54, v74
    v_mfma_f32_16x16x32_bf16 v[188:191], a[224:227], a[244:247], v[188:191]
    v_mul_f32 v75, s54, v75
    v_mul_f32 v76, s54, v76
    v_mfma_f32_16x16x32_bf16 v[208:211], a[212:215], a[248:251], v[208:211]
    v_mul_f32 v77, s54, v77
    v_mul_f32 v78, s54, v78
    v_mfma_f32_16x16x32_bf16 v[212:215], a[216:219], a[248:251], v[212:215]
    v_mul_f32 v79, s54, v79
    v_cvt_pk_bf16_f32 v68, v72, v73
    v_mfma_f32_16x16x32_bf16 v[216:219], a[220:223], a[248:251], v[216:219]
    v_cvt_pk_bf16_f32 v69, v74, v75
    v_cvt_pk_bf16_f32 v70, v76, v77
    v_mfma_f32_16x16x32_bf16 v[220:223], a[224:227], a[248:251], v[220:223]
    v_cvt_pk_bf16_f32 v71, v78, v79
    v_mul_f32 v96, s54, v96
    v_mfma_f32_16x16x32_bf16 v[240:243], a[212:215], a[252:255], v[240:243]
    v_mul_f32 v97, s54, v97
    v_mul_f32 v98, s54, v98
    v_mfma_f32_16x16x32_bf16 v[244:247], a[216:219], a[252:255], v[244:247]
    v_mul_f32 v99, s54, v99
    v_mul_f32 v100, s54, v100
    v_mfma_f32_16x16x32_bf16 v[248:251], a[220:223], a[252:255], v[248:251]
    v_mul_f32 v101, s54, v101
    v_mul_f32 v102, s54, v102
    v_mfma_f32_16x16x32_bf16 v[252:255], a[224:227], a[252:255], v[252:255]
    v_mul_f32 v103, s54, v103
    v_cvt_pk_bf16_f32 v96, v96, v97
    s_add_u32 s32, s48, 16384
    s_lshl_b32 s33, s4, 13
    s_add_u32 s33, s33, 131072
    s_mov_b32 s34, s48
    s_add_u32 m0, s48, 24576
    s_nop 0
    buffer_load_dwordx4 v19, s[20:23], s52 offen offset:0 nt lds
    buffer_load_dwordx4 v20, s[20:23], s52 offen offset:1024 nt lds
    buffer_load_dwordx4 v19, s[20:23], s52 offen offset:2048 nt lds
    buffer_load_dwordx4 v20, s[20:23], s52 offen offset:3072 nt lds
    s_add_u32 s52, s52, 4096
    s_add_u32 m0, s48, 28672
    s_nop 0
    buffer_load_dwordx4 v19, s[20:23], s52 offen offset:0 nt lds
    buffer_load_dwordx4 v20, s[20:23], s52 offen offset:1024 nt lds
    buffer_load_dwordx4 v19, s[20:23], s52 offen offset:2048 nt lds
    buffer_load_dwordx4 v20, s[20:23], s52 offen offset:3072 nt lds
    s_add_u32 s52, s52, 4096
    v_pk_mul_f32 v[48:49], v[48:49], s[54:55] op_sel_hi:[1,0]
    v_pk_mul_f32 v[50:51], v[50:51], s[54:55] op_sel_hi:[1,0]
    v_pk_mul_f32 v[52:53], v[52:53], s[54:55] op_sel_hi:[1,0]
    v_pk_mul_f32 v[54:55], v[54:55], s[54:55] op_sel_hi:[1,0]
    v_cvt_pk_bf16_f32 v40, v48, v49
    v_cvt_pk_bf16_f32 v41, v50, v51
    v_cvt_pk_bf16_f32 v42, v52, v53
    v_cvt_pk_bf16_f32 v43, v54, v55
    v_pk_mul_f32 v[56:57], v[56:57], s[54:55] op_sel_hi:[1,0]
    v_pk_mul_f32 v[58:59], v[58:59], s[54:55] op_sel_hi:[1,0]
    v_pk_mul_f32 v[60:61], v[60:61], s[54:55] op_sel_hi:[1,0]
    v_pk_mul_f32 v[62:63], v[62:63], s[54:55] op_sel_hi:[1,0]
    v_cvt_pk_bf16_f32 v44, v56, v57
    v_cvt_pk_bf16_f32 v45, v58, v59
    v_cvt_pk_bf16_f32 v46, v60, v61
    v_cvt_pk_bf16_f32 v47, v62, v63
    v_pk_mul_f32 v[80:81], v[80:81], s[54:55] op_sel_hi:[1,0]
    v_pk_mul_f32 v[82:83], v[82:83], s[54:55] op_sel_hi:[1,0]
    v_pk_mul_f32 v[84:85], v[84:85], s[54:55] op_sel_hi:[1,0]
    v_pk_mul_f32 v[86:87], v[86:87], s[54:55] op_sel_hi:[1,0]
    v_cvt_pk_bf16_f32 v72, v80, v81
    v_cvt_pk_bf16_f32 v73, v82, v83
    v_cvt_pk_bf16_f32 v74, v84, v85
    v_cvt_pk_bf16_f32 v75, v86, v87
    v_pk_mul_f32 v[88:89], v[88:89], s[54:55] op_sel_hi:[1,0]
    v_pk_mul_f32 v[90:91], v[90:91], s[54:55] op_sel_hi:[1,0]
    v_pk_mul_f32 v[92:93], v[92:93], s[54:55] op_sel_hi:[1,0]
    v_pk_mul_f32 v[94:95], v[94:95], s[54:55] op_sel_hi:[1,0]
    v_cvt_pk_bf16_f32 v76, v88, v89
    v_cvt_pk_bf16_f32 v77, v90, v91
    v_cvt_pk_bf16_f32 v78, v92, v93
    v_cvt_pk_bf16_f32 v79, v94, v95
    s_waitcnt vmcnt(24)
    ds_read_b128 v[48:51], v1 offset:0
    ds_read_b128 v[52:55], v2 offset:0
    ds_read_b128 v[56:59], v3 offset:0
    ds_read_b128 v[60:63], v4 offset:0
    ds_read_b128 v[80:83], v1 offset:4096
    ds_read_b128 v[84:87], v2 offset:4096
    ds_read_b128 v[88:91], v3 offset:4096
    ds_read_b128 v[92:95], v4 offset:4096
    v_cvt_pk_bf16_f32 v97, v98, v99
    v_cvt_pk_bf16_f32 v98, v100, v101
    v_cvt_pk_bf16_f32 v99, v102, v103
    v_pk_mul_f32 v[104:105], v[104:105], s[54:55] op_sel_hi:[1,0]
    v_pk_mul_f32 v[106:107], v[106:107], s[54:55] op_sel_hi:[1,0]
    v_pk_mul_f32 v[108:109], v[108:109], s[54:55] op_sel_hi:[1,0]
    v_pk_mul_f32 v[110:111], v[110:111], s[54:55] op_sel_hi:[1,0]
    v_cvt_pk_bf16_f32 v100, v104, v105
    v_cvt_pk_bf16_f32 v101, v106, v107
    v_cvt_pk_bf16_f32 v102, v108, v109
    v_cvt_pk_bf16_f32 v103, v110, v111
    v_pk_mul_f32 v[112:113], v[112:113], s[54:55] op_sel_hi:[1,0]
    v_pk_mul_f32 v[114:115], v[114:115], s[54:55] op_sel_hi:[1,0]
    v_pk_mul_f32 v[116:117], v[116:117], s[54:55] op_sel_hi:[1,0]
    v_pk_mul_f32 v[118:119], v[118:119], s[54:55] op_sel_hi:[1,0]
    v_cvt_pk_bf16_f32 v104, v112, v113
    v_cvt_pk_bf16_f32 v105, v114, v115
    v_cvt_pk_bf16_f32 v106, v116, v117
    v_cvt_pk_bf16_f32 v107, v118, v119
    v_pk_mul_f32 v[120:121], v[120:121], s[54:55] op_sel_hi:[1,0]
    v_pk_mul_f32 v[122:123], v[122:123], s[54:55] op_sel_hi:[1,0]
    v_pk_mul_f32 v[124:125], v[124:125], s[54:55] op_sel_hi:[1,0]
    v_pk_mul_f32 v[126:127], v[126:127], s[54:55] op_sel_hi:[1,0]
    v_cvt_pk_bf16_f32 v108, v120, v121
    v_cvt_pk_bf16_f32 v109, v122, v123
    v_cvt_pk_bf16_f32 v110, v124, v125
    v_cvt_pk_bf16_f32 v111, v126, v127
    v_pk_mul_f32 v[128:129], v[128:129], s[54:55] op_sel_hi:[1,0]
    v_pk_mul_f32 v[130:131], v[130:131], s[54:55] op_sel_hi:[1,0]
    v_pk_mul_f32 v[132:133], v[132:133], s[54:55] op_sel_hi:[1,0]
    v_pk_mul_f32 v[134:135], v[134:135], s[54:55] op_sel_hi:[1,0]
    v_cvt_pk_bf16_f32 v128, v128, v129
    v_cvt_pk_bf16_f32 v129, v130, v131
    v_cvt_pk_bf16_f32 v130, v132, v133
    v_cvt_pk_bf16_f32 v131, v134, v135
    v_pk_mul_f32 v[136:137], v[136:137], s[54:55] op_sel_hi:[1,0]
    v_pk_mul_f32 v[138:139], v[138:139], s[54:55] op_sel_hi:[1,0]
    v_pk_mul_f32 v[140:141], v[140:141], s[54:55] op_sel_hi:[1,0]
    v_pk_mul_f32 v[142:143], v[142:143], s[54:55] op_sel_hi:[1,0]
    v_cvt_pk_bf16_f32 v132, v136, v137
    v_cvt_pk_bf16_f32 v133, v138, v139
    v_cvt_pk_bf16_f32 v134, v140, v141
    v_cvt_pk_bf16_f32 v135, v142, v143
    v_pk_mul_f32 v[144:145], v[144:145], s[54:55] op_sel_hi:[1,0]
    v_pk_mul_f32 v[146:147], v[146:147], s[54:55] op_sel_hi:[1,0]
    v_pk_mul_f32 v[148:149], v[148:149], s[54:55] op_sel_hi:[1,0]
    v_pk_mul_f32 v[150:151], v[150:151], s[54:55] op_sel_hi:[1,0]
    v_cvt_pk_bf16_f32 v136, v144, v145
    v_cvt_pk_bf16_f32 v137, v146, v147
    v_cvt_pk_bf16_f32 v138, v148, v149
    v_cvt_pk_bf16_f32 v139, v150, v151
    v_pk_mul_f32 v[152:153], v[152:153], s[54:55] op_sel_hi:[1,0]
    v_pk_mul_f32 v[154:155], v[154:155], s[54:55] op_sel_hi:[1,0]
    v_pk_mul_f32 v[156:157], v[156:157], s[54:55] op_sel_hi:[1,0]
    v_pk_mul_f32 v[158:159], v[158:159], s[54:55] op_sel_hi:[1,0]
    v_cvt_pk_bf16_f32 v140, v152, v153
    v_cvt_pk_bf16_f32 v141, v154, v155
    v_cvt_pk_bf16_f32 v142, v156, v157
    v_cvt_pk_bf16_f32 v143, v158, v159
    v_pk_mul_f32 v[160:161], v[160:161], s[54:55] op_sel_hi:[1,0]
    v_pk_mul_f32 v[162:163], v[162:163], s[54:55] op_sel_hi:[1,0]
    v_pk_mul_f32 v[164:165], v[164:165], s[54:55] op_sel_hi:[1,0]
    v_pk_mul_f32 v[166:167], v[166:167], s[54:55] op_sel_hi:[1,0]
    v_cvt_pk_bf16_f32 v160, v160, v161
    v_cvt_pk_bf16_f32 v161, v162, v163
    v_cvt_pk_bf16_f32 v162, v164, v165
    v_cvt_pk_bf16_f32 v163, v166, v167
    v_pk_mul_f32 v[168:169], v[168:169], s[54:55] op_sel_hi:[1,0]
    v_pk_mul_f32 v[170:171], v[170:171], s[54:55] op_sel_hi:[1,0]
    v_pk_mul_f32 v[172:173], v[172:173], s[54:55] op_sel_hi:[1,0]
    v_pk_mul_f32 v[174:175], v[174:175], s[54:55] op_sel_hi:[1,0]
    v_cvt_pk_bf16_f32 v164, v168, v169
    v_cvt_pk_bf16_f32 v165, v170, v171
    v_cvt_pk_bf16_f32 v166, v172, v173
    v_cvt_pk_bf16_f32 v167, v174, v175
    v_pk_mul_f32 v[176:177], v[176:177], s[54:55] op_sel_hi:[1,0]
    v_pk_mul_f32 v[178:179], v[178:179], s[54:55] op_sel_hi:[1,0]
    v_pk_mul_f32 v[180:181], v[180:181], s[54:55] op_sel_hi:[1,0]
    v_pk_mul_f32 v[182:183], v[182:183], s[54:55] op_sel_hi:[1,0]
    v_cvt_pk_bf16_f32 v168, v176, v177
    v_cvt_pk_bf16_f32 v169, v178, v179
    v_cvt_pk_bf16_f32 v170, v180, v181
    v_cvt_pk_bf16_f32 v171, v182, v183
    v_pk_mul_f32 v[184:185], v[184:185], s[54:55] op_sel_hi:[1,0]
    v_pk_mul_f32 v[186:187], v[186:187], s[54:55] op_sel_hi:[1,0]
    v_pk_mul_f32 v[188:189], v[188:189], s[54:55] op_sel_hi:[1,0]
    v_pk_mul_f32 v[190:191], v[190:191], s[54:55] op_sel_hi:[1,0]
    v_cvt_pk_bf16_f32 v172, v184, v185
    v_cvt_pk_bf16_f32 v173, v186, v187
    v_cvt_pk_bf16_f32 v174, v188, v189
    v_cvt_pk_bf16_f32 v175, v190, v191
    s_waitcnt lgkmcnt(0)
    v_mfma_f32_16x16x32_bf16 v[144:147], v[48:51], v[32:35], 0
    v_mul_f32 v192, s54, v192
    v_mul_f32 v193, s54, v193
    v_mfma_f32_16x16x32_bf16 v[144:147], v[52:55], v[36:39], v[144:147]
    v_mul_f32 v194, s54, v194
    v_mul_f32 v195, s54, v195
    v_mfma_f32_16x16x32_bf16 v[144:147], v[56:59], v[40:43], v[144:147]
    v_mul_f32 v196, s54, v196
    v_mul_f32 v197, s54, v197
    v_mfma_f32_16x16x32_bf16 v[144:147], v[60:63], v[44:47], v[144:147]
    v_mul_f32 v198, s54, v198
    v_mul_f32 v199, s54, v199
    v_mfma_f32_16x16x32_bf16 v[148:151], v[48:51], v[64:67], 0
    v_cvt_pk_bf16_f32 v192, v192, v193
    v_cvt_pk_bf16_f32 v193, v194, v195
    v_mfma_f32_16x16x32_bf16 v[148:151], v[52:55], v[68:71], v[148:151]
    v_cvt_pk_bf16_f32 v194, v196, v197
    v_cvt_pk_bf16_f32 v195, v198, v199
    v_mfma_f32_16x16x32_bf16 v[148:151], v[56:59], v[72:75], v[148:151]
    v_mul_f32 v200, s54, v200
    v_mul_f32 v201, s54, v201
    v_mfma_f32_16x16x32_bf16 v[148:151], v[60:63], v[76:79], v[148:151]
    v_mul_f32 v202, s54, v202
    v_mul_f32 v203, s54, v203
    v_mfma_f32_16x16x32_bf16 v[152:155], v[48:51], v[96:99], 0
    v_mul_f32 v204, s54, v204
    v_mul_f32 v205, s54, v205
    v_mfma_f32_16x16x32_bf16 v[152:155], v[52:55], v[100:103], v[152:155]
    v_mul_f32 v206, s54, v206
    v_mul_f32 v207, s54, v207
    v_mfma_f32_16x16x32_bf16 v[152:155], v[56:59], v[104:107], v[152:155]
    v_cvt_pk_bf16_f32 v196, v200, v201
    v_cvt_pk_bf16_f32 v197, v202, v203
    v_mfma_f32_16x16x32_bf16 v[152:155], v[60:63], v[108:111], v[152:155]
    v_cvt_pk_bf16_f32 v198, v204, v205
    v_cvt_pk_bf16_f32 v199, v206, v207
    v_mfma_f32_16x16x32_bf16 v[156:159], v[48:51], v[128:131], 0
    v_mul_f32 v208, s54, v208
    v_mul_f32 v209, s54, v209
    v_mfma_f32_16x16x32_bf16 v[156:159], v[52:55], v[132:135], v[156:159]
    v_mul_f32 v210, s54, v210
    v_mul_f32 v211, s54, v211
    v_mfma_f32_16x16x32_bf16 v[156:159], v[56:59], v[136:139], v[156:159]
    v_mul_f32 v212, s54, v212
    v_mul_f32 v213, s54, v213
    v_mfma_f32_16x16x32_bf16 v[156:159], v[60:63], v[140:143], v[156:159]
    v_mul_f32 v214, s54, v214
    v_mul_f32 v215, s54, v215
    v_mfma_f32_16x16x32_bf16 v[176:179], v[48:51], v[160:163], 0
    v_cvt_pk_bf16_f32 v200, v208, v209
    v_cvt_pk_bf16_f32 v201, v210, v211
    v_mfma_f32_16x16x32_bf16 v[176:179], v[52:55], v[164:167], v[176:179]
    v_cvt_pk_bf16_f32 v202, v212, v213
    v_cvt_pk_bf16_f32 v203, v214, v215
    v_mfma_f32_16x16x32_bf16 v[176:179], v[56:59], v[168:171], v[176:179]
    v_mul_f32 v216, s54, v216
    v_mul_f32 v217, s54, v217
    v_mfma_f32_16x16x32_bf16 v[176:179], v[60:63], v[172:175], v[176:179]
    v_mul_f32 v218, s54, v218
    v_mul_f32 v219, s54, v219
    v_pk_mul_f32 v[220:221], v[220:221], s[54:55] op_sel_hi:[1,0]
    v_pk_mul_f32 v[222:223], v[222:223], s[54:55] op_sel_hi:[1,0]
    v_cvt_pk_bf16_f32 v204, v216, v217
    v_cvt_pk_bf16_f32 v205, v218, v219
    v_cvt_pk_bf16_f32 v206, v220, v221
    v_cvt_pk_bf16_f32 v207, v222, v223
    v_pk_mul_f32 v[224:225], v[224:225], s[54:55] op_sel_hi:[1,0]
    v_pk_mul_f32 v[226:227], v[226:227], s[54:55] op_sel_hi:[1,0]
    v_pk_mul_f32 v[228:229], v[228:229], s[54:55] op_sel_hi:[1,0]
    v_pk_mul_f32 v[230:231], v[230:231], s[54:55] op_sel_hi:[1,0]
    v_cvt_pk_bf16_f32 v224, v224, v225
    v_cvt_pk_bf16_f32 v225, v226, v227
    v_cvt_pk_bf16_f32 v226, v228, v229
    v_cvt_pk_bf16_f32 v227, v230, v231
    v_pk_mul_f32 v[232:233], v[232:233], s[54:55] op_sel_hi:[1,0]
    v_pk_mul_f32 v[234:235], v[234:235], s[54:55] op_sel_hi:[1,0]
    v_pk_mul_f32 v[236:237], v[236:237], s[54:55] op_sel_hi:[1,0]
    v_pk_mul_f32 v[238:239], v[238:239], s[54:55] op_sel_hi:[1,0]
    v_cvt_pk_bf16_f32 v228, v232, v233
    v_cvt_pk_bf16_f32 v229, v234, v235
    v_cvt_pk_bf16_f32 v230, v236, v237
    v_cvt_pk_bf16_f32 v231, v238, v239
    v_pk_mul_f32 v[240:241], v[240:241], s[54:55] op_sel_hi:[1,0]
    v_pk_mul_f32 v[242:243], v[242:243], s[54:55] op_sel_hi:[1,0]
    v_pk_mul_f32 v[244:245], v[244:245], s[54:55] op_sel_hi:[1,0]
    v_pk_mul_f32 v[246:247], v[246:247], s[54:55] op_sel_hi:[1,0]
    v_cvt_pk_bf16_f32 v232, v240, v241
    v_cvt_pk_bf16_f32 v233, v242, v243
    v_cvt_pk_bf16_f32 v234, v244, v245
    v_cvt_pk_bf16_f32 v235, v246, v247
    v_pk_mul_f32 v[248:249], v[248:249], s[54:55] op_sel_hi:[1,0]
    v_pk_mul_f32 v[250:251], v[250:251], s[54:55] op_sel_hi:[1,0]
    v_pk_mul_f32 v[252:253], v[252:253], s[54:55] op_sel_hi:[1,0]
    v_pk_mul_f32 v[254:255], v[254:255], s[54:55] op_sel_hi:[1,0]
    v_cvt_pk_bf16_f32 v236, v248, v249
    v_cvt_pk_bf16_f32 v237, v250, v251
    v_cvt_pk_bf16_f32 v238, v252, v253
    v_cvt_pk_bf16_f32 v239, v254, v255
    s_nop 1
    v_mfma_f32_16x16x32_bf16 v[180:183], v[48:51], v[192:195], 0
    v_accvgpr_write_b32 a196, 0
    v_accvgpr_write_b32 a197, 0
    v_mfma_f32_16x16x32_bf16 v[180:183], v[52:55], v[196:199], v[180:183]
    v_accvgpr_write_b32 a198, 0
    v_accvgpr_write_b32 a199, 0
    v_mfma_f32_16x16x32_bf16 v[180:183], v[56:59], v[200:203], v[180:183]
    v_accvgpr_write_b32 a200, 0
    v_accvgpr_write_b32 a201, 0
    v_mfma_f32_16x16x32_bf16 v[180:183], v[60:63], v[204:207], v[180:183]
    v_accvgpr_write_b32 a202, 0
    v_accvgpr_write_b32 a203, 0
    v_mfma_f32_16x16x32_bf16 v[184:187], v[48:51], v[224:227], 0
    v_accvgpr_write_b32 a204, 0
    v_accvgpr_write_b32 a205, 0
    v_mfma_f32_16x16x32_bf16 v[184:187], v[52:55], v[228:231], v[184:187]
    v_accvgpr_write_b32 a206, 0
    v_accvgpr_write_b32 a207, 0
    v_mfma_f32_16x16x32_bf16 v[184:187], v[56:59], v[232:235], v[184:187]
    v_accvgpr_write_b32 a208, 0
    v_accvgpr_write_b32 a209, 0
    v_mfma_f32_16x16x32_bf16 v[184:187], v[60:63], v[236:239], v[184:187]
    v_accvgpr_write_b32 a210, 0
    v_accvgpr_write_b32 a211, 0
    s_add_u32 m0, s48, 0
    s_nop 0
    buffer_load_dwordx4 v15, s[16:19], s51 offen offset:0 nt lds
    buffer_load_dwordx4 v16, s[16:19], s51 offen offset:1024 nt lds
    buffer_load_dwordx4 v17, s[16:19], s51 offen offset:2048 nt lds
    buffer_load_dwordx4 v18, s[16:19], s51 offen offset:3072 nt lds
    s_add_u32 s51, s51, 4096
    v_subrev_u32 v220, s48, v1
    v_subrev_u32 v221, s48, v2
    v_subrev_u32 v222, s48, v3
    v_subrev_u32 v223, s48, v4
    v_max3_f32 v240, v144, v145, v146
    v_max3_f32 v241, v148, v149, v150
    v_max3_f32 v242, v152, v153, v154
    v_max3_f32 v243, v156, v157, v158
    v_max3_f32 v244, v176, v177, v178
    v_max3_f32 v245, v180, v181, v182
    v_max3_f32 v246, v184, v185, v186
    v_max_f32 v240, v240, v147
    v_max_f32 v241, v241, v151
    v_max_f32 v242, v242, v155
    v_max_f32 v243, v243, v159
    v_max_f32 v244, v244, v179
    v_max_f32 v245, v245, v183
    v_max_f32 v246, v246, v187
    v_mov_b32 v247, v240
    v_mov_b32 v248, v241
    v_mov_b32 v249, v242
    v_mov_b32 v250, v243
    v_mov_b32 v251, v244
    v_mov_b32 v252, v245
    v_mov_b32 v253, v246
    v_accvgpr_write_b32 a212, 0
    v_accvgpr_write_b32 a213, 0
    v_permlane16_swap_b32 v240, v247
    v_permlane16_swap_b32 v241, v248
    v_permlane16_swap_b32 v242, v249
    v_permlane16_swap_b32 v243, v250
    v_permlane16_swap_b32 v244, v251
    v_permlane16_swap_b32 v245, v252
    v_permlane16_swap_b32 v246, v253
    v_accvgpr_write_b32 a214, 0
    v_max_f32 v240, v240, v247
    v_max_f32 v241, v241, v248
    v_max_f32 v242, v242, v249
    v_max_f32 v243, v243, v250
    v_max_f32 v244, v244, v251
    v_max_f32 v245, v245, v252
    v_max_f32 v246, v246, v253
    v_mov_b32 v247, v240
    v_mov_b32 v248, v241
    v_mov_b32 v249, v242
    v_mov_b32 v250, v243
    v_mov_b32 v251, v244
    v_mov_b32 v252, v245
    v_mov_b32 v253, v246
    v_accvgpr_write_b32 a215, 0
    v_accvgpr_write_b32 a216, 0
    v_permlane32_swap_b32 v240, v247
    v_permlane32_swap_b32 v241, v248
    v_permlane32_swap_b32 v242, v249
    v_permlane32_swap_b32 v243, v250
    v_permlane32_swap_b32 v244, v251
    v_permlane32_swap_b32 v245, v252
    v_permlane32_swap_b32 v246, v253
    v_accvgpr_write_b32 a217, 0
    v_max_f32 v240, v240, v247
    v_max_f32 v241, v241, v248
    v_max_f32 v242, v242, v249
    v_max_f32 v243, v243, v250
    v_max_f32 v244, v244, v251
    v_max_f32 v245, v245, v252
    v_max_f32 v246, v246, v253
    v_sub_f32 v144, 0, v240
    v_sub_f32 v145, 0, v240
    v_sub_f32 v146, 0, v240
    v_sub_f32 v147, 0, v240
    v_sub_f32 v148, 0, v241
    v_sub_f32 v149, 0, v241
    v_sub_f32 v150, 0, v241
    v_sub_f32 v151, 0, v241
    v_sub_f32 v152, 0, v242
    v_sub_f32 v153, 0, v242
    v_sub_f32 v154, 0, v242
    v_sub_f32 v155, 0, v242
    v_sub_f32 v156, 0, v243
    v_sub_f32 v157, 0, v243
    v_sub_f32 v158, 0, v243
    v_sub_f32 v159, 0, v243
    v_sub_f32 v176, 0, v244
    v_sub_f32 v177, 0, v244
    v_sub_f32 v178, 0, v244
    v_sub_f32 v179, 0, v244
    v_sub_f32 v180, 0, v245
    v_sub_f32 v181, 0, v245
    v_sub_f32 v182, 0, v245
    v_sub_f32 v183, 0, v245
    v_sub_f32 v184, 0, v246
    v_sub_f32 v185, 0, v246
    v_sub_f32 v186, 0, v246
    v_sub_f32 v187, 0, v246
    v_accvgpr_write_b32 a218, 0
    v_accvgpr_write_b32 a219, 0
    v_accvgpr_write_b32 a220, 0
    v_accvgpr_write_b32 a221, 0
    v_accvgpr_write_b32 a222, 0
    v_accvgpr_write_b32 a223, 0
    v_accvgpr_write_b32 a224, 0
    v_accvgpr_write_b32 a225, 0
    v_accvgpr_write_b32 a226, 0
    v_accvgpr_write_b32 a227, 0
    v_accvgpr_write_b32 a228, 0
    v_accvgpr_write_b32 a229, 0
    v_accvgpr_write_b32 a230, 0
    v_accvgpr_write_b32 a231, 0
    v_accvgpr_write_b32 a232, 0
    v_accvgpr_write_b32 a233, 0
    v_accvgpr_write_b32 a234, 0
    v_accvgpr_write_b32 a235, 0
    v_accvgpr_write_b32 a236, 0
    v_accvgpr_write_b32 a237, 0
    v_accvgpr_write_b32 a238, 0
    v_accvgpr_write_b32 a239, 0
    v_accvgpr_write_b32 a240, 0
    v_accvgpr_write_b32 a241, 0
    v_accvgpr_write_b32 a242, 0
    v_accvgpr_write_b32 a243, 0
    v_accvgpr_write_b32 a244, 0
    v_accvgpr_write_b32 a245, 0
    v_accvgpr_write_b32 a246, 0
    v_accvgpr_write_b32 a247, 0
    v_accvgpr_write_b32 a248, 0
    v_accvgpr_write_b32 a249, 0
    v_accvgpr_write_b32 a250, 0
    v_accvgpr_write_b32 a251, 0
    v_accvgpr_write_b32 a252, 0
    v_accvgpr_write_b32 a253, 0
    v_accvgpr_write_b32 a254, 0
    v_accvgpr_write_b32 a255, 0
L_attn_go:
    s_lshl_b32 s68, s44, 3
    s_add_u32 s35, s4, 2
    v_mov_b32 v27, 0
    v_mov_b32 v29, 0
    s_lshl_b32 s3, s4, 13
    s_add_u32 s58, s3, 131072
    s_add_u32 s59, s48, 28672
    s_lshl_b32 s46, s7, 19
    s_lshl_b32 s3, s4, 8
    s_add_u32 s46, s46, s3
    s_add_u32 m0, s58, 0
    s_add_u32 s53, s46, 0
    buffer_load_dwordx4 v5, s[24:27], s53 offen offset:0 lds
    buffer_load_dwordx4 v6, s[24:27], s53 offen offset:1024 lds
    s_add_u32 m0, s58, 2048
    s_add_u32 s53, s46, 64
    buffer_load_dwordx4 v5, s[24:27], s53 offen offset:0 lds
    buffer_load_dwordx4 v6, s[24:27], s53 offen offset:1024 lds
    s_add_u32 m0, s58, 4096
    s_add_u32 s53, s46, 128
    buffer_load_dwordx4 v5, s[24:27], s53 offen offset:0 lds
    buffer_load_dwordx4 v6, s[24:27], s53 offen offset:1024 lds
    s_add_u32 m0, s58, 6144
    s_add_u32 s53, s46, 192
    buffer_load_dwordx4 v5, s[24:27], s53 offen offset:0 lds
    buffer_load_dwordx4 v6, s[24:27], s53 offen offset:1024 lds
    v_mfma_f32_16x16x32_bf16 v[112:115], v[48:51], v[32:35], v[144:147]
    v_mov_b32 v208, 0
    v_mov_b32 v209, 0
    v_mfma_f32_16x16x32_bf16 v[112:115], v[52:55], v[36:39], v[112:115]
    v_mov_b32 v210, 0
    v_mov_b32 v211, 0
    v_mfma_f32_16x16x32_bf16 v[112:115], v[56:59], v[40:43], v[112:115]
    v_mov_b32 v212, 0
    v_mov_b32 v213, 0
    v_mfma_f32_16x16x32_bf16 v[112:115], v[60:63], v[44:47], v[112:115]
    v_mov_b32 v214, 0
    v_mov_b32 v215, 0
    v_mfma_f32_16x16x32_bf16 v[116:119], v[80:83], v[32:35], v[144:147]
    v_mov_b32 v216, 0
    v_mov_b32 v217, 0
    v_mfma_f32_16x16x32_bf16 v[116:119], v[84:87], v[36:39], v[116:119]
    v_mov_b32 v218, 0
    v_mfma_f32_16x16x32_bf16 v[116:119], v[88:91], v[40:43], v[116:119]
    v_mfma_f32_16x16x32_bf16 v[116:119], v[92:95], v[44:47], v[116:119]
    s_nop 5
    s_mov_b32 s55, 8
L_B:
    v_mfma_f32_16x16x32_bf16 v[120:123], v[48:51], v[64:67], v[148:151]
    s_add_u32 m0, s48, 4096
    v_exp_f32 v112, v112
    v_mfma_f32_16x16x32_bf16 v[120:123], v[52:55], v[68:71], v[120:123]
    buffer_load_dwordx4 v15, s[16:19], s51 offen offset:0 nt lds
    v_mfma_f32_16x16x32_bf16 v[120:123], v[56:59], v[72:75], v[120:123]
    v_exp_f32 v113, v113
    v_mfma_f32_16x16x32_bf16 v[120:123], v[60:63], v[76:79], v[120:123]
    v_add_f32 v212, v212, v112
    v_add_f32 v212, v212, v113
    v_mfma_f32_16x16x32_bf16 v[124:127], v[80:83], v[64:67], v[148:151]
    v_exp_f32 v114, v114
    v_mfma_f32_16x16x32_bf16 v[124:127], v[84:87], v[68:71], v[124:127]
    buffer_load_dwordx4 v16, s[16:19], s51 offen offset:1024 nt lds
    v_mfma_f32_16x16x32_bf16 v[124:127], v[88:91], v[72:75], v[124:127]
    s_waitcnt vmcnt(22)
    v_exp_f32 v115, v115
    v_mfma_f32_16x16x32_bf16 v[124:127], v[92:95], v[76:79], v[124:127]
    v_cvt_pk_bf16_f32 v188, v112, v113
    v_add_f32 v212, v212, v114
    v_mfma_f32_16x16x32_bf16 a[48:51], a[224:227], v[208:211], a[48:51]
    ds_read_b64_tr_b16 a[224:225], v9 offset:8192
    v_exp_f32 v116, v116
    v_mfma_f32_16x16x32_bf16 a[52:55], a[228:231], v[208:211], a[52:55]
    ds_read_b64_tr_b16 a[226:227], v9 offset:12288
    v_add_f32 v212, v212, v115
    v_mfma_f32_16x16x32_bf16 a[104:107], a[232:235], v[208:211], a[104:107]
    ds_read_b64_tr_b16 a[228:229], v10 offset:8192
    v_exp_f32 v117, v117
    v_mfma_f32_16x16x32_bf16 a[108:111], a[236:239], v[208:211], a[108:111]
    ds_read_b64_tr_b16 a[230:231], v10 offset:12288
    v_cvt_pk_bf16_f32 v189, v114, v115
    v_mfma_f32_16x16x32_bf16 a[160:163], a[240:243], v[208:211], a[160:163]
    ds_read_b64_tr_b16 a[232:233], v11 offset:8192
    v_exp_f32 v118, v118
    v_mfma_f32_16x16x32_bf16 a[164:167], a[244:247], v[208:211], a[164:167]
    ds_read_b64_tr_b16 a[234:235], v11 offset:12288
    v_add_f32 v212, v212, v116
    v_mfma_f32_16x16x32_bf16 a[216:219], a[248:251], v[208:211], a[216:219]
    ds_read_b64_tr_b16 a[236:237], v12 offset:8192
    v_exp_f32 v119, v119
    v_mfma_f32_16x16x32_bf16 a[220:223], a[252:255], v[208:211], a[220:223]
    ds_read_b64_tr_b16 a[238:239], v12 offset:12288
    v_add_f32 v212, v212, v117
    v_cvt_pk_bf16_f32 v190, v116, v117
    v_add_f32 v212, v212, v118
    v_add_f32 v212, v212, v119
    v_cvt_pk_bf16_f32 v191, v118, v119
    v_mfma_f32_16x16x32_bf16 v[112:115], v[48:51], v[96:99], v[152:155]
    ds_read_b64_tr_b16 a[240:241], v13 offset:8192
    v_exp_f32 v120, v120
    v_mfma_f32_16x16x32_bf16 v[112:115], v[52:55], v[100:103], v[112:115]
    ds_read_b64_tr_b16 a[242:243], v13 offset:12288
    v_add_f32 v213, v213, v120
    v_mfma_f32_16x16x32_bf16 v[112:115], v[56:59], v[104:107], v[112:115]
    ds_read_b64_tr_b16 a[244:245], v14 offset:8192
    v_exp_f32 v121, v121
    v_mfma_f32_16x16x32_bf16 v[112:115], v[60:63], v[108:111], v[112:115]
    ds_read_b64_tr_b16 a[246:247], v14 offset:12288
    v_add_f32 v213, v213, v121
    v_mfma_f32_16x16x32_bf16 v[116:119], v[80:83], v[96:99], v[152:155]
    ds_read_b64_tr_b16 a[248:249], v21 offset:8192
    v_exp_f32 v122, v122
    v_mfma_f32_16x16x32_bf16 v[116:119], v[84:87], v[100:103], v[116:119]
    ds_read_b64_tr_b16 a[250:251], v21 offset:12288
    v_cvt_pk_bf16_f32 v208, v120, v121
    v_mfma_f32_16x16x32_bf16 v[116:119], v[88:91], v[104:107], v[116:119]
    s_waitcnt lgkmcnt(8)
    v_exp_f32 v123, v123
    v_mfma_f32_16x16x32_bf16 v[116:119], v[92:95], v[108:111], v[116:119]
    ds_read_b64_tr_b16 a[252:253], v22 offset:8192
    v_add_f32 v213, v213, v122
    v_mfma_f32_16x16x32_bf16 a[0:3], a[224:227], v[188:191], a[0:3]
    ds_read_b64_tr_b16 a[254:255], v22 offset:12288
    v_exp_f32 v124, v124
    v_mfma_f32_16x16x32_bf16 a[4:7], a[228:231], v[188:191], a[4:7]
    buffer_load_dwordx4 v17, s[16:19], s51 offen offset:2048 nt lds
    v_mfma_f32_16x16x32_bf16 a[56:59], a[232:235], v[188:191], a[56:59]
    s_waitcnt lgkmcnt(2)
    v_exp_f32 v125, v125
    v_mfma_f32_16x16x32_bf16 a[60:63], a[236:239], v[188:191], a[60:63]
    v_add_f32 v213, v213, v123
    v_cvt_pk_bf16_f32 v209, v122, v123
    v_mfma_f32_16x16x32_bf16 a[112:115], a[240:243], v[188:191], a[112:115]
    v_exp_f32 v126, v126
    v_mfma_f32_16x16x32_bf16 a[116:119], a[244:247], v[188:191], a[116:119]
    buffer_load_dwordx4 v18, s[16:19], s51 offen offset:3072 nt lds
    v_mfma_f32_16x16x32_bf16 a[168:171], a[248:251], v[188:191], a[168:171]
    s_waitcnt lgkmcnt(0)
    s_add_u32 s51, s51, 4096
    v_exp_f32 v127, v127
    v_mfma_f32_16x16x32_bf16 a[172:175], a[252:255], v[188:191], a[172:175]
    v_add_f32 v213, v213, v124
    v_add_f32 v213, v213, v125
    v_cvt_pk_bf16_f32 v210, v124, v125
    v_add_f32 v213, v213, v126
    v_add_f32 v213, v213, v127
    v_cvt_pk_bf16_f32 v211, v126, v127
    v_mfma_f32_16x16x32_bf16 v[120:123], v[48:51], v[128:131], v[156:159]
    s_add_u32 m0, s48, 8192
    v_exp_f32 v112, v112
    v_mfma_f32_16x16x32_bf16 v[120:123], v[52:55], v[132:135], v[120:123]
    buffer_load_dwordx4 v19, s[20:23], s52 offen offset:0 nt lds
    v_mfma_f32_16x16x32_bf16 v[120:123], v[56:59], v[136:139], v[120:123]
    v_exp_f32 v113, v113
    v_mfma_f32_16x16x32_bf16 v[120:123], v[60:63], v[140:143], v[120:123]
    v_add_f32 v214, v214, v112
    v_add_f32 v214, v214, v113
    v_mfma_f32_16x16x32_bf16 v[124:127], v[80:83], v[128:131], v[156:159]
    v_exp_f32 v114, v114
    v_mfma_f32_16x16x32_bf16 v[124:127], v[84:87], v[132:135], v[124:127]
    buffer_load_dwordx4 v20, s[20:23], s52 offen offset:1024 nt lds
    v_mfma_f32_16x16x32_bf16 v[124:127], v[88:91], v[136:139], v[124:127]
    v_exp_f32 v115, v115
    v_mfma_f32_16x16x32_bf16 v[124:127], v[92:95], v[140:143], v[124:127]
    v_cvt_pk_bf16_f32 v188, v112, v113
    v_add_f32 v214, v214, v114
    v_mfma_f32_16x16x32_bf16 a[8:11], a[224:227], v[208:211], a[8:11]
    v_exp_f32 v116, v116
    v_mfma_f32_16x16x32_bf16 a[12:15], a[228:231], v[208:211], a[12:15]
    buffer_load_dwordx4 v19, s[20:23], s52 offen offset:2048 nt lds
    v_mfma_f32_16x16x32_bf16 a[64:67], a[232:235], v[208:211], a[64:67]
    v_exp_f32 v117, v117
    v_mfma_f32_16x16x32_bf16 a[68:71], a[236:239], v[208:211], a[68:71]
    v_add_f32 v214, v214, v115
    v_cvt_pk_bf16_f32 v189, v114, v115
    v_mfma_f32_16x16x32_bf16 a[120:123], a[240:243], v[208:211], a[120:123]
    v_exp_f32 v118, v118
    v_mfma_f32_16x16x32_bf16 a[124:127], a[244:247], v[208:211], a[124:127]
    buffer_load_dwordx4 v20, s[20:23], s52 offen offset:3072 nt lds
    v_mfma_f32_16x16x32_bf16 a[176:179], a[248:251], v[208:211], a[176:179]
    s_add_u32 s52, s52, 4096
    v_exp_f32 v119, v119
    v_mfma_f32_16x16x32_bf16 a[180:183], a[252:255], v[208:211], a[180:183]
    v_add_f32 v214, v214, v116
    v_add_f32 v214, v214, v117
    v_cvt_pk_bf16_f32 v190, v116, v117
    v_add_f32 v214, v214, v118
    v_add_f32 v214, v214, v119
    v_cvt_pk_bf16_f32 v191, v118, v119
    v_mfma_f32_16x16x32_bf16 v[112:115], v[48:51], v[160:163], v[176:179]
    s_add_u32 m0, s48, 12288
    v_exp_f32 v120, v120
    v_mfma_f32_16x16x32_bf16 v[112:115], v[52:55], v[164:167], v[112:115]
    buffer_load_dwordx4 v19, s[20:23], s52 offen offset:0 nt lds
    v_mfma_f32_16x16x32_bf16 v[112:115], v[56:59], v[168:171], v[112:115]
    v_exp_f32 v121, v121
    v_mfma_f32_16x16x32_bf16 v[112:115], v[60:63], v[172:175], v[112:115]
    v_or_b32 v27, v27, v29
    v_add_f32 v215, v215, v120
    v_mfma_f32_16x16x32_bf16 v[116:119], v[80:83], v[160:163], v[176:179]
    v_exp_f32 v122, v122
    v_mfma_f32_16x16x32_bf16 v[116:119], v[84:87], v[164:167], v[116:119]
    buffer_load_dwordx4 v20, s[20:23], s52 offen offset:1024 nt lds
    v_mfma_f32_16x16x32_bf16 v[116:119], v[88:91], v[168:171], v[116:119]
    v_exp_f32 v123, v123
    v_mfma_f32_16x16x32_bf16 v[116:119], v[92:95], v[172:175], v[116:119]
    v_add_f32 v215, v215, v121
    v_cvt_pk_bf16_f32 v208, v120, v121
    v_mfma_f32_16x16x32_bf16 a[16:19], a[224:227], v[188:191], a[16:19]
    v_exp_f32 v124, v124
    v_mfma_f32_16x16x32_bf16 a[20:23], a[228:231], v[188:191], a[20:23]
    buffer_load_dwordx4 v19, s[20:23], s52 offen offset:2048 nt lds
    v_mfma_f32_16x16x32_bf16 a[72:75], a[232:235], v[188:191], a[72:75]
    v_exp_f32 v125, v125
    v_mfma_f32_16x16x32_bf16 a[76:79], a[236:239], v[188:191], a[76:79]
    v_add_f32 v215, v215, v122
    v_add_f32 v215, v215, v123
    v_mfma_f32_16x16x32_bf16 a[128:131], a[240:243], v[188:191], a[128:131]
    v_exp_f32 v126, v126
    v_mfma_f32_16x16x32_bf16 a[132:135], a[244:247], v[188:191], a[132:135]
    buffer_load_dwordx4 v20, s[20:23], s52 offen offset:3072 nt lds
    v_mfma_f32_16x16x32_bf16 a[184:187], a[248:251], v[188:191], a[184:187]
    s_add_u32 s52, s52, 4096
    v_exp_f32 v127, v127
    v_mfma_f32_16x16x32_bf16 a[188:191], a[252:255], v[188:191], a[188:191]
    v_cvt_pk_bf16_f32 v209, v122, v123
    v_add_f32 v215, v215, v124
    v_add_f32 v215, v215, v125
    v_cvt_pk_bf16_f32 v210, v124, v125
    v_add_f32 v215, v215, v126
    v_add_f32 v215, v215, v127
    v_cvt_pk_bf16_f32 v211, v126, v127
    v_mfma_f32_16x16x32_bf16 v[120:123], v[48:51], v[192:195], v[180:183]
    s_cmp_eq_u32 s55, s35
    v_exp_f32 v112, v112
    v_mfma_f32_16x16x32_bf16 v[120:123], v[52:55], v[196:199], v[120:123]
    v_add_f32 v216, v216, v112
    v_mfma_f32_16x16x32_bf16 v[120:123], v[56:59], v[200:203], v[120:123]
    s_cselect_b32 s3, s68, 0x40000000
    v_exp_f32 v113, v113
    v_mfma_f32_16x16x32_bf16 v[120:123], v[60:63], v[204:207], v[120:123]
    v_add_f32 v216, v216, v113
    v_cvt_pk_bf16_f32 v188, v112, v113
    v_mfma_f32_16x16x32_bf16 v[124:127], v[80:83], v[192:195], v[180:183]
    v_exp_f32 v114, v114
    v_mfma_f32_16x16x32_bf16 v[124:127], v[84:87], v[196:199], v[124:127]
    buffer_load_dword v29, v28, s[40:43], s3 offen offset:0 sc1
    v_mfma_f32_16x16x32_bf16 v[124:127], v[88:91], v[200:203], v[124:127]
    v_exp_f32 v115, v115
    v_mfma_f32_16x16x32_bf16 v[124:127], v[92:95], v[204:207], v[124:127]
    v_add_f32 v216, v216, v114
    v_add_f32 v216, v216, v115
    v_mfma_f32_16x16x32_bf16 a[24:27], a[224:227], v[208:211], a[24:27]
    v_exp_f32 v116, v116
    v_mfma_f32_16x16x32_bf16 a[28:31], a[228:231], v[208:211], a[28:31]
    v_cvt_pk_bf16_f32 v189, v114, v115
    v_add_f32 v216, v216, v116
    v_mfma_f32_16x16x32_bf16 a[80:83], a[232:235], v[208:211], a[80:83]
    v_exp_f32 v117, v117
    v_mfma_f32_16x16x32_bf16 a[84:87], a[236:239], v[208:211], a[84:87]
    v_add_f32 v216, v216, v117
    v_cvt_pk_bf16_f32 v190, v116, v117
    v_mfma_f32_16x16x32_bf16 a[136:139], a[240:243], v[208:211], a[136:139]
    v_exp_f32 v118, v118
    v_mfma_f32_16x16x32_bf16 a[140:143], a[244:247], v[208:211], a[140:143]
    v_add_f32 v216, v216, v118
    v_mfma_f32_16x16x32_bf16 a[192:195], a[248:251], v[208:211], a[192:195]
    s_waitcnt vmcnt(25)
    v_exp_f32 v119, v119
    v_mfma_f32_16x16x32_bf16 a[196:199], a[252:255], v[208:211], a[196:199]
    v_add_f32 v216, v216, v119
    v_cvt_pk_bf16_f32 v191, v118, v119
    v_mfma_f32_16x16x32_bf16 v[112:115], v[48:51], v[224:227], v[184:187]
    v_exp_f32 v120, v120
    v_mfma_f32_16x16x32_bf16 v[112:115], v[52:55], v[228:231], v[112:115]
    ds_read_b128 v[48:51], v1 offset:16384
    v_add_f32 v217, v217, v120
    v_mfma_f32_16x16x32_bf16 v[112:115], v[56:59], v[232:235], v[112:115]
    ds_read_b128 v[52:55], v2 offset:16384
    v_exp_f32 v121, v121
    v_mfma_f32_16x16x32_bf16 v[112:115], v[60:63], v[236:239], v[112:115]
    ds_read_b128 v[56:59], v3 offset:16384
    v_add_f32 v217, v217, v121
    v_mfma_f32_16x16x32_bf16 v[116:119], v[80:83], v[224:227], v[184:187]
    ds_read_b128 v[60:63], v4 offset:16384
    v_exp_f32 v122, v122
    v_mfma_f32_16x16x32_bf16 v[116:119], v[84:87], v[228:231], v[116:119]
    ds_read_b128 v[80:83], v1 offset:20480
    v_cvt_pk_bf16_f32 v208, v120, v121
    v_mfma_f32_16x16x32_bf16 v[116:119], v[88:91], v[232:235], v[116:119]
    ds_read_b128 v[84:87], v2 offset:20480
    v_exp_f32 v123, v123
    v_mfma_f32_16x16x32_bf16 v[116:119], v[92:95], v[236:239], v[116:119]
    v_add_f32 v217, v217, v122
    v_add_f32 v217, v217, v123
    v_mfma_f32_16x16x32_bf16 a[32:35], a[224:227], v[188:191], a[32:35]
    v_exp_f32 v124, v124
    v_mfma_f32_16x16x32_bf16 a[36:39], a[228:231], v[188:191], a[36:39]
    ds_read_b128 v[88:91], v3 offset:20480
    v_cvt_pk_bf16_f32 v209, v122, v123
    v_mfma_f32_16x16x32_bf16 a[88:91], a[232:235], v[188:191], a[88:91]
    v_exp_f32 v125, v125
    v_mfma_f32_16x16x32_bf16 a[92:95], a[236:239], v[188:191], a[92:95]
    v_add_f32 v217, v217, v124
    v_add_f32 v217, v217, v125
    v_mfma_f32_16x16x32_bf16 a[144:147], a[240:243], v[188:191], a[144:147]
    v_exp_f32 v126, v126
    v_mfma_f32_16x16x32_bf16 a[148:151], a[244:247], v[188:191], a[148:151]
    ds_read_b128 v[92:95], v4 offset:20480
    v_cvt_pk_bf16_f32 v210, v124, v125
    v_mfma_f32_16x16x32_bf16 a[200:203], a[248:251], v[188:191], a[200:203]
    s_waitcnt lgkmcnt(3)
    v_exp_f32 v127, v127
    v_mfma_f32_16x16x32_bf16 a[204:207], a[252:255], v[188:191], a[204:207]
    v_add_f32 v217, v217, v126
    v_add_f32 v217, v217, v127
    v_cvt_pk_bf16_f32 v211, v126, v127
    v_mfma_f32_16x16x32_bf16 v[120:123], v[48:51], v[32:35], v[144:147]
    s_add_u32 m0, s48, 16384
    v_exp_f32 v112, v112
    v_mfma_f32_16x16x32_bf16 v[120:123], v[52:55], v[36:39], v[120:123]
    v_add_f32 v218, v218, v112
    v_mfma_f32_16x16x32_bf16 v[120:123], v[56:59], v[40:43], v[120:123]
    v_exp_f32 v113, v113
    v_mfma_f32_16x16x32_bf16 v[120:123], v[60:63], v[44:47], v[120:123]
    v_add_f32 v218, v218, v113
    v_cvt_pk_bf16_f32 v188, v112, v113
    v_mfma_f32_16x16x32_bf16 v[124:127], v[80:83], v[32:35], v[144:147]
    s_waitcnt lgkmcnt(0)
    v_exp_f32 v114, v114
    v_mfma_f32_16x16x32_bf16 v[124:127], v[84:87], v[36:39], v[124:127]
    buffer_load_dwordx4 v15, s[16:19], s51 offen offset:0 nt lds
    v_mfma_f32_16x16x32_bf16 v[124:127], v[88:91], v[40:43], v[124:127]
    v_exp_f32 v115, v115
    v_mfma_f32_16x16x32_bf16 v[124:127], v[92:95], v[44:47], v[124:127]
    buffer_load_dwordx4 v16, s[16:19], s51 offen offset:1024 nt lds
    v_mfma_f32_16x16x32_bf16 a[40:43], a[224:227], v[208:211], a[40:43]
    v_exp_f32 v116, v116
    v_mfma_f32_16x16x32_bf16 a[44:47], a[228:231], v[208:211], a[44:47]
    buffer_load_dwordx4 v17, s[16:19], s51 offen offset:2048 nt lds
    v_mfma_f32_16x16x32_bf16 a[96:99], a[232:235], v[208:211], a[96:99]
    v_exp_f32 v117, v117
    v_mfma_f32_16x16x32_bf16 a[100:103], a[236:239], v[208:211], a[100:103]
    v_add_f32 v218, v218, v114
    v_add_f32 v218, v218, v115
    v_mfma_f32_16x16x32_bf16 a[152:155], a[240:243], v[208:211], a[152:155]
    v_exp_f32 v118, v118
    v_mfma_f32_16x16x32_bf16 a[156:159], a[244:247], v[208:211], a[156:159]
    buffer_load_dwordx4 v18, s[16:19], s51 offen offset:3072 nt lds
    v_mfma_f32_16x16x32_bf16 a[208:211], a[248:251], v[208:211], a[208:211]
    s_add_u32 s51, s51, 4096
    v_exp_f32 v119, v119
    v_mfma_f32_16x16x32_bf16 a[212:215], a[252:255], v[208:211], a[212:215]
    v_cvt_pk_bf16_f32 v189, v114, v115
    v_add_f32 v218, v218, v116
    v_add_f32 v218, v218, v117
    v_cvt_pk_bf16_f32 v190, v116, v117
    v_add_f32 v218, v218, v118
    v_add_f32 v218, v218, v119
    v_cvt_pk_bf16_f32 v191, v118, v119
    v_mfma_f32_16x16x32_bf16 v[112:115], v[48:51], v[64:67], v[148:151]
    s_add_u32 m0, s48, 20480
    v_exp_f32 v120, v120
    v_mfma_f32_16x16x32_bf16 v[112:115], v[52:55], v[68:71], v[112:115]
    buffer_load_dwordx4 v15, s[16:19], s51 offen offset:0 nt lds
    v_mfma_f32_16x16x32_bf16 v[112:115], v[56:59], v[72:75], v[112:115]
    v_exp_f32 v121, v121
    v_mfma_f32_16x16x32_bf16 v[112:115], v[60:63], v[76:79], v[112:115]
    v_add_f32 v212, v212, v120
    v_add_f32 v212, v212, v121
    v_mfma_f32_16x16x32_bf16 v[116:119], v[80:83], v[64:67], v[148:151]
    v_exp_f32 v122, v122
    v_mfma_f32_16x16x32_bf16 v[116:119], v[84:87], v[68:71], v[116:119]
    buffer_load_dwordx4 v16, s[16:19], s51 offen offset:1024 nt lds
    v_mfma_f32_16x16x32_bf16 v[116:119], v[88:91], v[72:75], v[116:119]
    s_waitcnt vmcnt(23)
    v_exp_f32 v123, v123
    v_mfma_f32_16x16x32_bf16 v[116:119], v[92:95], v[76:79], v[116:119]
    v_cvt_pk_bf16_f32 v208, v120, v121
    v_add_f32 v212, v212, v122
    v_mfma_f32_16x16x32_bf16 a[48:51], a[224:227], v[188:191], a[48:51]
    ds_read_b64_tr_b16 a[224:225], v9 offset:24576
    v_exp_f32 v124, v124
    v_mfma_f32_16x16x32_bf16 a[52:55], a[228:231], v[188:191], a[52:55]
    ds_read_b64_tr_b16 a[226:227], v9 offset:28672
    v_add_f32 v212, v212, v123
    v_mfma_f32_16x16x32_bf16 a[104:107], a[232:235], v[188:191], a[104:107]
    ds_read_b64_tr_b16 a[228:229], v10 offset:24576
    v_exp_f32 v125, v125
    v_mfma_f32_16x16x32_bf16 a[108:111], a[236:239], v[188:191], a[108:111]
    ds_read_b64_tr_b16 a[230:231], v10 offset:28672
    v_cvt_pk_bf16_f32 v209, v122, v123
    v_mfma_f32_16x16x32_bf16 a[160:163], a[240:243], v[188:191], a[160:163]
    ds_read_b64_tr_b16 a[232:233], v11 offset:24576
    v_exp_f32 v126, v126
    v_mfma_f32_16x16x32_bf16 a[164:167], a[244:247], v[188:191], a[164:167]
    ds_read_b64_tr_b16 a[234:235], v11 offset:28672
    v_add_f32 v212, v212, v124
    v_mfma_f32_16x16x32_bf16 a[216:219], a[248:251], v[188:191], a[216:219]
    ds_read_b64_tr_b16 a[236:237], v12 offset:24576
    v_exp_f32 v127, v127
    v_mfma_f32_16x16x32_bf16 a[220:223], a[252:255], v[188:191], a[220:223]
    ds_read_b64_tr_b16 a[238:239], v12 offset:28672
    v_add_f32 v212, v212, v125
    v_cvt_pk_bf16_f32 v210, v124, v125
    v_add_f32 v212, v212, v126
    v_add_f32 v212, v212, v127
    v_cvt_pk_bf16_f32 v211, v126, v127
    v_mfma_f32_16x16x32_bf16 v[120:123], v[48:51], v[96:99], v[152:155]
    ds_read_b64_tr_b16 a[240:241], v13 offset:24576
    v_exp_f32 v112, v112
    v_mfma_f32_16x16x32_bf16 v[120:123], v[52:55], v[100:103], v[120:123]
    ds_read_b64_tr_b16 a[242:243], v13 offset:28672
    v_add_f32 v213, v213, v112
    v_mfma_f32_16x16x32_bf16 v[120:123], v[56:59], v[104:107], v[120:123]
    ds_read_b64_tr_b16 a[244:245], v14 offset:24576
    v_exp_f32 v113, v113
    v_mfma_f32_16x16x32_bf16 v[120:123], v[60:63], v[108:111], v[120:123]
    ds_read_b64_tr_b16 a[246:247], v14 offset:28672
    v_add_f32 v213, v213, v113
    v_mfma_f32_16x16x32_bf16 v[124:127], v[80:83], v[96:99], v[152:155]
    ds_read_b64_tr_b16 a[248:249], v21 offset:24576
    v_exp_f32 v114, v114
    v_mfma_f32_16x16x32_bf16 v[124:127], v[84:87], v[100:103], v[124:127]
    ds_read_b64_tr_b16 a[250:251], v21 offset:28672
    v_cvt_pk_bf16_f32 v188, v112, v113
    v_mfma_f32_16x16x32_bf16 v[124:127], v[88:91], v[104:107], v[124:127]
    s_waitcnt lgkmcnt(8)
    v_exp_f32 v115, v115
    v_mfma_f32_16x16x32_bf16 v[124:127], v[92:95], v[108:111], v[124:127]
    ds_read_b64_tr_b16 a[252:253], v22 offset:24576
    v_add_f32 v213, v213, v114
    v_mfma_f32_16x16x32_bf16 a[0:3], a[224:227], v[208:211], a[0:3]
    ds_read_b64_tr_b16 a[254:255], v22 offset:28672
    v_exp_f32 v116, v116
    v_mfma_f32_16x16x32_bf16 a[4:7], a[228:231], v[208:211], a[4:7]
    buffer_load_dwordx4 v17, s[16:19], s51 offen offset:2048 nt lds
    v_mfma_f32_16x16x32_bf16 a[56:59], a[232:235], v[208:211], a[56:59]
    s_waitcnt lgkmcnt(2)
    v_exp_f32 v117, v117
    v_mfma_f32_16x16x32_bf16 a[60:63], a[236:239], v[208:211], a[60:63]
    v_add_f32 v213, v213, v115
    v_cvt_pk_bf16_f32 v189, v114, v115
    v_mfma_f32_16x16x32_bf16 a[112:115], a[240:243], v[208:211], a[112:115]
    v_exp_f32 v118, v118
    v_mfma_f32_16x16x32_bf16 a[116:119], a[244:247], v[208:211], a[116:119]
    buffer_load_dwordx4 v18, s[16:19], s51 offen offset:3072 nt lds
    v_mfma_f32_16x16x32_bf16 a[168:171], a[248:251], v[208:211], a[168:171]
    s_waitcnt lgkmcnt(0)
    s_add_u32 s51, s51, 4096
    v_exp_f32 v119, v119
    v_mfma_f32_16x16x32_bf16 a[172:175], a[252:255], v[208:211], a[172:175]
    v_add_f32 v213, v213, v116
    v_add_f32 v213, v213, v117
    v_cvt_pk_bf16_f32 v190, v116, v117
    v_add_f32 v213, v213, v118
    v_add_f32 v213, v213, v119
    v_cvt_pk_bf16_f32 v191, v118, v119
    v_mfma_f32_16x16x32_bf16 v[112:115], v[48:51], v[128:131], v[156:159]
    s_add_u32 m0, s48, 24576
    v_exp_f32 v120, v120
    v_mfma_f32_16x16x32_bf16 v[112:115], v[52:55], v[132:135], v[112:115]
    buffer_load_dwordx4 v19, s[20:23], s52 offen offset:0 nt lds
    v_mfma_f32_16x16x32_bf16 v[112:115], v[56:59], v[136:139], v[112:115]
    v_exp_f32 v121, v121
    v_mfma_f32_16x16x32_bf16 v[112:115], v[60:63], v[140:143], v[112:115]
    v_add_f32 v214, v214, v120
    v_add_f32 v214, v214, v121
    v_mfma_f32_16x16x32_bf16 v[116:119], v[80:83], v[128:131], v[156:159]
    v_exp_f32 v122, v122
    v_mfma_f32_16x16x32_bf16 v[116:119], v[84:87], v[132:135], v[116:119]
    buffer_load_dwordx4 v20, s[20:23], s52 offen offset:1024 nt lds
    v_mfma_f32_16x16x32_bf16 v[116:119], v[88:91], v[136:139], v[116:119]
    v_exp_f32 v123, v123
    v_mfma_f32_16x16x32_bf16 v[116:119], v[92:95], v[140:143], v[116:119]
    v_cvt_pk_bf16_f32 v208, v120, v121
    v_add_f32 v214, v214, v122
    v_mfma_f32_16x16x32_bf16 a[8:11], a[224:227], v[188:191], a[8:11]
    v_exp_f32 v124, v124
    v_mfma_f32_16x16x32_bf16 a[12:15], a[228:231], v[188:191], a[12:15]
    buffer_load_dwordx4 v19, s[20:23], s52 offen offset:2048 nt lds
    v_mfma_f32_16x16x32_bf16 a[64:67], a[232:235], v[188:191], a[64:67]
    v_exp_f32 v125, v125
    v_mfma_f32_16x16x32_bf16 a[68:71], a[236:239], v[188:191], a[68:71]
    v_add_f32 v214, v214, v123
    v_cvt_pk_bf16_f32 v209, v122, v123
    v_mfma_f32_16x16x32_bf16 a[120:123], a[240:243], v[188:191], a[120:123]
    v_exp_f32 v126, v126
    v_mfma_f32_16x16x32_bf16 a[124:127], a[244:247], v[188:191], a[124:127]
    buffer_load_dwordx4 v20, s[20:23], s52 offen offset:3072 nt lds
    v_mfma_f32_16x16x32_bf16 a[176:179], a[248:251], v[188:191], a[176:179]
    s_add_u32 s52, s52, 4096
    v_exp_f32 v127, v127
    v_mfma_f32_16x16x32_bf16 a[180:183], a[252:255], v[188:191], a[180:183]
    v_add_f32 v214, v214, v124
    v_add_f32 v214, v214, v125
    v_cvt_pk_bf16_f32 v210, v124, v125
    v_add_f32 v214, v214, v126
    v_add_f32 v214, v214, v127
    v_cvt_pk_bf16_f32 v211, v126, v127
    v_mfma_f32_16x16x32_bf16 v[120:123], v[48:51], v[160:163], v[176:179]
    s_add_u32 m0, s48, 28672
    v_exp_f32 v112, v112
    v_mfma_f32_16x16x32_bf16 v[120:123], v[52:55], v[164:167], v[120:123]
    buffer_load_dwordx4 v19, s[20:23], s52 offen offset:0 nt lds
    v_mfma_f32_16x16x32_bf16 v[120:123], v[56:59], v[168:171], v[120:123]
    v_exp_f32 v113, v113
    v_mfma_f32_16x16x32_bf16 v[120:123], v[60:63], v[172:175], v[120:123]
    v_add_f32 v215, v215, v112
    v_add_f32 v215, v215, v113
    v_mfma_f32_16x16x32_bf16 v[124:127], v[80:83], v[160:163], v[176:179]
    v_exp_f32 v114, v114
    v_mfma_f32_16x16x32_bf16 v[124:127], v[84:87], v[164:167], v[124:127]
    buffer_load_dwordx4 v20, s[20:23], s52 offen offset:1024 nt lds
    v_mfma_f32_16x16x32_bf16 v[124:127], v[88:91], v[168:171], v[124:127]
    v_exp_f32 v115, v115
    v_mfma_f32_16x16x32_bf16 v[124:127], v[92:95], v[172:175], v[124:127]
    v_cvt_pk_bf16_f32 v188, v112, v113
    v_add_f32 v215, v215, v114
    v_mfma_f32_16x16x32_bf16 a[16:19], a[224:227], v[208:211], a[16:19]
    v_exp_f32 v116, v116
    v_mfma_f32_16x16x32_bf16 a[20:23], a[228:231], v[208:211], a[20:23]
    buffer_load_dwordx4 v19, s[20:23], s52 offen offset:2048 nt lds
    v_mfma_f32_16x16x32_bf16 a[72:75], a[232:235], v[208:211], a[72:75]
    v_exp_f32 v117, v117
    v_mfma_f32_16x16x32_bf16 a[76:79], a[236:239], v[208:211], a[76:79]
    v_add_f32 v215, v215, v115
    v_cvt_pk_bf16_f32 v189, v114, v115
    v_mfma_f32_16x16x32_bf16 a[128:131], a[240:243], v[208:211], a[128:131]
    v_exp_f32 v118, v118
    v_mfma_f32_16x16x32_bf16 a[132:135], a[244:247], v[208:211], a[132:135]
    buffer_load_dwordx4 v20, s[20:23], s52 offen offset:3072 nt lds
    v_mfma_f32_16x16x32_bf16 a[184:187], a[248:251], v[208:211], a[184:187]
    s_add_u32 s52, s52, 4096
    v_exp_f32 v119, v119
    v_mfma_f32_16x16x32_bf16 a[188:191], a[252:255], v[208:211], a[188:191]
    v_add_f32 v215, v215, v116
    v_add_f32 v215, v215, v117
    v_cvt_pk_bf16_f32 v190, v116, v117
    v_add_f32 v215, v215, v118
    v_add_f32 v215, v215, v119
    v_cvt_pk_bf16_f32 v191, v118, v119
    v_mfma_f32_16x16x32_bf16 v[112:115], v[48:51], v[192:195], v[180:183]
    v_exp_f32 v120, v120
    v_mfma_f32_16x16x32_bf16 v[112:115], v[52:55], v[196:199], v[112:115]
    v_add_f32 v216, v216, v120
    v_mfma_f32_16x16x32_bf16 v[112:115], v[56:59], v[200:203], v[112:115]
    v_exp_f32 v121, v121
    v_mfma_f32_16x16x32_bf16 v[112:115], v[60:63], v[204:207], v[112:115]
    v_add_f32 v216, v216, v121
    v_cvt_pk_bf16_f32 v208, v120, v121
    v_mfma_f32_16x16x32_bf16 v[116:119], v[80:83], v[192:195], v[180:183]
    v_exp_f32 v122, v122
    v_mfma_f32_16x16x32_bf16 v[116:119], v[84:87], v[196:199], v[116:119]
    v_add_f32 v216, v216, v122
    v_mfma_f32_16x16x32_bf16 v[116:119], v[88:91], v[200:203], v[116:119]
    v_exp_f32 v123, v123
    v_mfma_f32_16x16x32_bf16 v[116:119], v[92:95], v[204:207], v[116:119]
    v_add_f32 v216, v216, v123
    v_cvt_pk_bf16_f32 v209, v122, v123
    v_mfma_f32_16x16x32_bf16 a[24:27], a[224:227], v[188:191], a[24:27]
    v_exp_f32 v124, v124
    v_mfma_f32_16x16x32_bf16 a[28:31], a[228:231], v[188:191], a[28:31]
    v_add_f32 v216, v216, v124
    v_mfma_f32_16x16x32_bf16 a[80:83], a[232:235], v[188:191], a[80:83]
    v_exp_f32 v125, v125
    v_mfma_f32_16x16x32_bf16 a[84:87], a[236:239], v[188:191], a[84:87]
    v_add_f32 v216, v216, v125
    v_cvt_pk_bf16_f32 v210, v124, v125
    v_mfma_f32_16x16x32_bf16 a[136:139], a[240:243], v[188:191], a[136:139]
    v_exp_f32 v126, v126
    v_mfma_f32_16x16x32_bf16 a[140:143], a[244:247], v[188:191], a[140:143]
    v_add_f32 v216, v216, v126
    v_mfma_f32_16x16x32_bf16 a[192:195], a[248:251], v[188:191], a[192:195]
    s_waitcnt vmcnt(25)
    v_exp_f32 v127, v127
    v_mfma_f32_16x16x32_bf16 a[196:199], a[252:255], v[188:191], a[196:199]
    v_add_f32 v216, v216, v127
    v_cvt_pk_bf16_f32 v211, v126, v127
    v_mfma_f32_16x16x32_bf16 v[120:123], v[48:51], v[224:227], v[184:187]
    v_exp_f32 v112, v112
    v_mfma_f32_16x16x32_bf16 v[120:123], v[52:55], v[228:231], v[120:123]
    ds_read_b128 v[48:51], v1 offset:0
    v_add_f32 v217, v217, v112
    v_mfma_f32_16x16x32_bf16 v[120:123], v[56:59], v[232:235], v[120:123]
    ds_read_b128 v[52:55], v2 offset:0
    v_exp_f32 v113, v113
    v_mfma_f32_16x16x32_bf16 v[120:123], v[60:63], v[236:239], v[120:123]
    ds_read_b128 v[56:59], v3 offset:0
    v_add_f32 v217, v217, v113
    v_mfma_f32_16x16x32_bf16 v[124:127], v[80:83], v[224:227], v[184:187]
    ds_read_b128 v[60:63], v4 offset:0
    v_exp_f32 v114, v114
    v_mfma_f32_16x16x32_bf16 v[124:127], v[84:87], v[228:231], v[124:127]
    ds_read_b128 v[80:83], v1 offset:4096
    v_cvt_pk_bf16_f32 v188, v112, v113
    v_mfma_f32_16x16x32_bf16 v[124:127], v[88:91], v[232:235], v[124:127]
    ds_read_b128 v[84:87], v2 offset:4096
    v_exp_f32 v115, v115
    v_mfma_f32_16x16x32_bf16 v[124:127], v[92:95], v[236:239], v[124:127]
    v_add_f32 v217, v217, v114
    v_add_f32 v217, v217, v115
    v_mfma_f32_16x16x32_bf16 a[32:35], a[224:227], v[208:211], a[32:35]
    v_exp_f32 v116, v116
    v_mfma_f32_16x16x32_bf16 a[36:39], a[228:231], v[208:211], a[36:39]
    ds_read_b128 v[88:91], v3 offset:4096
    v_cvt_pk_bf16_f32 v189, v114, v115
    v_mfma_f32_16x16x32_bf16 a[88:91], a[232:235], v[208:211], a[88:91]
    v_exp_f32 v117, v117
    v_mfma_f32_16x16x32_bf16 a[92:95], a[236:239], v[208:211], a[92:95]
    v_add_f32 v217, v217, v116
    v_add_f32 v217, v217, v117
    v_mfma_f32_16x16x32_bf16 a[144:147], a[240:243], v[208:211], a[144:147]
    v_exp_f32 v118, v118
    v_mfma_f32_16x16x32_bf16 a[148:151], a[244:247], v[208:211], a[148:151]
    ds_read_b128 v[92:95], v4 offset:4096
    v_cvt_pk_bf16_f32 v190, v116, v117
    v_mfma_f32_16x16x32_bf16 a[200:203], a[248:251], v[208:211], a[200:203]
    s_waitcnt lgkmcnt(3)
    v_exp_f32 v119, v119
    v_mfma_f32_16x16x32_bf16 a[204:207], a[252:255], v[208:211], a[204:207]
    v_add_f32 v217, v217, v118
    v_add_f32 v217, v217, v119
    v_cvt_pk_bf16_f32 v191, v118, v119
    v_mfma_f32_16x16x32_bf16 v[112:115], v[48:51], v[32:35], v[144:147]
    s_add_u32 m0, s48, 0
    v_exp_f32 v120, v120
    v_mfma_f32_16x16x32_bf16 v[112:115], v[52:55], v[36:39], v[112:115]
    v_add_f32 v218, v218, v120
    v_mfma_f32_16x16x32_bf16 v[112:115], v[56:59], v[40:43], v[112:115]
    v_exp_f32 v121, v121
    v_mfma_f32_16x16x32_bf16 v[112:115], v[60:63], v[44:47], v[112:115]
    v_add_f32 v218, v218, v121
    v_cvt_pk_bf16_f32 v208, v120, v121
    v_mfma_f32_16x16x32_bf16 v[116:119], v[80:83], v[32:35], v[144:147]
    s_waitcnt lgkmcnt(0)
    v_exp_f32 v122, v122
    v_mfma_f32_16x16x32_bf16 v[116:119], v[84:87], v[36:39], v[116:119]
    buffer_load_dwordx4 v15, s[16:19], s51 offen offset:0 nt lds
    v_mfma_f32_16x16x32_bf16 v[116:119], v[88:91], v[40:43], v[116:119]
    v_exp_f32 v123, v123
    v_mfma_f32_16x16x32_bf16 v[116:119], v[92:95], v[44:47], v[116:119]
    buffer_load_dwordx4 v16, s[16:19], s51 offen offset:1024 nt lds
    v_mfma_f32_16x16x32_bf16 a[40:43], a[224:227], v[188:191], a[40:43]
    v_exp_f32 v124, v124
    v_mfma_f32_16x16x32_bf16 a[44:47], a[228:231], v[188:191], a[44:47]
    buffer_load_dwordx4 v17, s[16:19], s51 offen offset:2048 nt lds
    v_mfma_f32_16x16x32_bf16 a[96:99], a[232:235], v[188:191], a[96:99]
    v_exp_f32 v125, v125
    v_mfma_f32_16x16x32_bf16 a[100:103], a[236:239], v[188:191], a[100:103]
    v_add_f32 v218, v218, v122
    v_add_f32 v218, v218, v123
    v_mfma_f32_16x16x32_bf16 a[152:155], a[240:243], v[188:191], a[152:155]
    v_exp_f32 v126, v126
    v_mfma_f32_16x16x32_bf16 a[156:159], a[244:247], v[188:191], a[156:159]
    buffer_load_dwordx4 v18, s[16:19], s51 offen offset:3072 nt lds
    v_mfma_f32_16x16x32_bf16 a[208:211], a[248:251], v[188:191], a[208:211]
    s_add_u32 s51, s51, 4096
    v_exp_f32 v127, v127
    v_mfma_f32_16x16x32_bf16 a[212:215], a[252:255], v[188:191], a[212:215]
    v_cvt_pk_bf16_f32 v209, v122, v123
    v_add_f32 v218, v218, v124
    v_add_f32 v218, v218, v125
    v_cvt_pk_bf16_f32 v210, v124, v125
    v_add_f32 v218, v218, v126
    v_add_f32 v218, v218, v127
    v_cvt_pk_bf16_f32 v211, v126, v127
    s_sub_u32 s55, s55, 1
    s_cmp_lg_u32 s55, 0
    s_cbranch_scc1 L_B
    s_nop 1
    v_mfma_f32_16x16x32_bf16 a[48:51], a[224:227], v[208:211], a[48:51]
    v_mfma_f32_16x16x32_bf16 a[52:55], a[228:231], v[208:211], a[52:55]
    v_mfma_f32_16x16x32_bf16 a[104:107], a[232:235], v[208:211], a[104:107]
    v_mfma_f32_16x16x32_bf16 a[108:111], a[236:239], v[208:211], a[108:111]
    v_mfma_f32_16x16x32_bf16 a[160:163], a[240:243], v[208:211], a[160:163]
    v_mfma_f32_16x16x32_bf16 a[164:167], a[244:247], v[208:211], a[164:167]
    v_mfma_f32_16x16x32_bf16 a[216:219], a[248:251], v[208:211], a[216:219]
    v_mfma_f32_16x16x32_bf16 a[220:223], a[252:255], v[208:211], a[220:223]
    v_mov_b32 v240, v212
    v_mov_b32 v241, v213
    v_mov_b32 v242, v214
    v_mov_b32 v243, v215
    v_mov_b32 v244, v216
    v_mov_b32 v245, v217
    v_mov_b32 v246, v218
    s_nop 0
    s_nop 0
    v_permlane16_swap_b32 v212, v240
    v_permlane16_swap_b32 v213, v241
    v_permlane16_swap_b32 v214, v242
    v_permlane16_swap_b32 v215, v243
    v_permlane16_swap_b32 v216, v244
    v_permlane16_swap_b32 v217, v245
    v_permlane16_swap_b32 v218, v246
    s_nop 0
    v_add_f32 v212, v212, v240
    v_add_f32 v213, v213, v241
    v_add_f32 v214, v214, v242
    v_add_f32 v215, v215, v243
    v_add_f32 v216, v216, v244
    v_add_f32 v217, v217, v245
    v_add_f32 v218, v218, v246
    v_mov_b32 v240, v212
    v_mov_b32 v241, v213
    v_mov_b32 v242, v214
    v_mov_b32 v243, v215
    v_mov_b32 v244, v216
    v_mov_b32 v245, v217
    v_mov_b32 v246, v218
    s_nop 0
    s_nop 0
    v_permlane32_swap_b32 v212, v240
    v_permlane32_swap_b32 v213, v241
    v_permlane32_swap_b32 v214, v242
    v_permlane32_swap_b32 v215, v243
    v_permlane32_swap_b32 v216, v244
    v_permlane32_swap_b32 v217, v245
    v_permlane32_swap_b32 v218, v246
    s_nop 0
    v_add_f32 v212, v212, v240
    v_add_f32 v213, v213, v241
    v_add_f32 v214, v214, v242
    v_add_f32 v215, v215, v243
    v_add_f32 v216, v216, v244
    v_add_f32 v217, v217, v245
    v_add_f32 v218, v218, v246
    v_max3_f32 v248, v212, v213, v214
    v_max3_f32 v248, v248, v215, v216
    v_max3_f32 v248, v248, v217, v218
    v_cmp_nge_f32 vcc, s63, v248
    s_waitcnt vmcnt(0) lgkmcnt(0)
    s_cmp_lg_u32 s60, 0
    s_cbranch_scc1 L_nofb
    s_cbranch_vccnz L_fallback
L_nofb:
    v_readfirstlane_b32 s57, v27
    s_nop 1
    s_and_b32 s57, s57, 255
    s_cmp_lt_u32 s57, 8
    s_cselect_b32 s35, 1, 0
    s_add_u32 m0, s59, 0
    s_add_u32 s53, s46, 131072
    buffer_load_dwordx4 v5, s[24:27], s53 offen offset:0 lds
    buffer_load_dwordx4 v6, s[24:27], s53 offen offset:1024 lds
    s_add_u32 m0, s59, 2048
    s_add_u32 s53, s46, 131136
    buffer_load_dwordx4 v5, s[24:27], s53 offen offset:0 lds
    buffer_load_dwordx4 v6, s[24:27], s53 offen offset:1024 lds
    v_rcp_f32 v16, v212
    v_rcp_f32 v17, v213
    v_rcp_f32 v18, v214
    v_rcp_f32 v19, v215
    v_rcp_f32 v20, v216
    v_rcp_f32 v21, v217
    v_rcp_f32 v22, v218
    v_lshrrev_b32 v24, 2, v31
    v_lshl_add_u32 v24, v23, 2, v24
    v_and_b32 v25, 1, v23
    v_lshlrev_b32 v25, 1, v25
    v_bfe_u32 v26, v31, 1, 1
    v_xor_b32 v25, v25, v26
    v_lshlrev_b32 v25, 4, v25
    v_lshl_add_u32 v25, v24, 6, v25
    v_and_b32 v26, 1, v31
    v_lshl_add_u32 v25, v26, 3, v25
    v_xor_b32 v26, 32, v25
    v_add_u32 v1, s58, v25
    v_add_u32 v2, s58, v26
    v_add_u32 v3, s59, v25
    v_add_u32 v4, s59, v26
    v_lshlrev_b32 v13, 4, v0
    v_add_u32 v14, 65536, v13
    v_add_u32 v15, s48, v13
    v_accvgpr_read_b32 v56, a0
    v_accvgpr_read_b32 v57, a1
    v_accvgpr_read_b32 v58, a2
    v_accvgpr_read_b32 v59, a3
    v_accvgpr_read_b32 v60, a4
    v_accvgpr_read_b32 v61, a5
    v_accvgpr_read_b32 v62, a6
    v_accvgpr_read_b32 v63, a7
    v_pk_mul_f32 v[56:57], v[56:57], v[16:17] op_sel_hi:[1,0]
    v_pk_mul_f32 v[58:59], v[58:59], v[16:17] op_sel_hi:[1,0]
    v_pk_mul_f32 v[60:61], v[60:61], v[16:17] op_sel_hi:[1,0]
    v_pk_mul_f32 v[62:63], v[62:63], v[16:17] op_sel_hi:[1,0]
    v_cvt_pk_bf16_f32 v56, v56, v57
    v_cvt_pk_bf16_f32 v57, v58, v59
    v_cvt_pk_bf16_f32 v58, v60, v61
    v_cvt_pk_bf16_f32 v59, v62, v63
    ds_write_b128 v15, v[56:59] offset:0
    v_accvgpr_read_b32 v88, a8
    v_accvgpr_read_b32 v89, a9
    v_accvgpr_read_b32 v90, a10
    v_accvgpr_read_b32 v91, a11
    v_accvgpr_read_b32 v92, a12
    v_accvgpr_read_b32 v93, a13
    v_accvgpr_read_b32 v94, a14
    v_accvgpr_read_b32 v95, a15
    v_pk_mul_f32 v[88:89], v[88:89], v[16:17] op_sel:[0,1] op_sel_hi:[1,1]
    v_pk_mul_f32 v[90:91], v[90:91], v[16:17] op_sel:[0,1] op_sel_hi:[1,1]
    v_pk_mul_f32 v[92:93], v[92:93], v[16:17] op_sel:[0,1] op_sel_hi:[1,1]
    v_pk_mul_f32 v[94:95], v[94:95], v[16:17] op_sel:[0,1] op_sel_hi:[1,1]
    v_cvt_pk_bf16_f32 v88, v88, v89
    v_cvt_pk_bf16_f32 v89, v90, v91
    v_cvt_pk_bf16_f32 v90, v92, v93
    v_cvt_pk_bf16_f32 v91, v94, v95
    ds_write_b128 v15, v[88:91] offset:1024
    v_accvgpr_read_b32 v120, a16
    v_accvgpr_read_b32 v121, a17
    v_accvgpr_read_b32 v122, a18
    v_accvgpr_read_b32 v123, a19
    v_accvgpr_read_b32 v124, a20
    v_accvgpr_read_b32 v125, a21
    v_accvgpr_read_b32 v126, a22
    v_accvgpr_read_b32 v127, a23
    v_pk_mul_f32 v[120:121], v[120:121], v[18:19] op_sel_hi:[1,0]
    v_pk_mul_f32 v[122:123], v[122:123], v[18:19] op_sel_hi:[1,0]
    v_pk_mul_f32 v[124:125], v[124:125], v[18:19] op_sel_hi:[1,0]
    v_pk_mul_f32 v[126:127], v[126:127], v[18:19] op_sel_hi:[1,0]
    v_cvt_pk_bf16_f32 v120, v120, v121
    v_cvt_pk_bf16_f32 v121, v122, v123
    v_cvt_pk_bf16_f32 v122, v124, v125
    v_cvt_pk_bf16_f32 v123, v126, v127
    ds_write_b128 v15, v[120:123] offset:2048
    v_accvgpr_read_b32 v152, a24
    v_accvgpr_read_b32 v153, a25
    v_accvgpr_read_b32 v154, a26
    v_accvgpr_read_b32 v155, a27
    v_accvgpr_read_b32 v156, a28
    v_accvgpr_read_b32 v157, a29
    v_accvgpr_read_b32 v158, a30
    v_accvgpr_read_b32 v159, a31
    v_pk_mul_f32 v[152:153], v[152:153], v[18:19] op_sel:[0,1] op_sel_hi:[1,1]
    v_pk_mul_f32 v[154:155], v[154:155], v[18:19] op_sel:[0,1] op_sel_hi:[1,1]
    v_pk_mul_f32 v[156:157], v[156:157], v[18:19] op_sel:[0,1] op_sel_hi:[1,1]
    v_pk_mul_f32 v[158:159], v[158:159], v[18:19] op_sel:[0,1] op_sel_hi:[1,1]
    v_cvt_pk_bf16_f32 v152, v152, v153
    v_cvt_pk_bf16_f32 v153, v154, v155
    v_cvt_pk_bf16_f32 v154, v156, v157
    v_cvt_pk_bf16_f32 v155, v158, v159
    ds_write_b128 v15, v[152:155] offset:3072
    v_accvgpr_read_b32 v184, a32
    v_accvgpr_read_b32 v185, a33
    v_accvgpr_read_b32 v186, a34
    v_accvgpr_read_b32 v187, a35
    v_accvgpr_read_b32 v188, a36
    v_accvgpr_read_b32 v189, a37
    v_accvgpr_read_b32 v190, a38
    v_accvgpr_read_b32 v191, a39
    v_pk_mul_f32 v[184:185], v[184:185], v[20:21] op_sel_hi:[1,0]
    v_pk_mul_f32 v[186:187], v[186:187], v[20:21] op_sel_hi:[1,0]
    v_pk_mul_f32 v[188:189], v[188:189], v[20:21] op_sel_hi:[1,0]
    v_pk_mul_f32 v[190:191], v[190:191], v[20:21] op_sel_hi:[1,0]
    v_cvt_pk_bf16_f32 v184, v184, v185
    v_cvt_pk_bf16_f32 v185, v186, v187
    v_cvt_pk_bf16_f32 v186, v188, v189
    v_cvt_pk_bf16_f32 v187, v190, v191
    ds_write_b128 v15, v[184:187] offset:4096
    v_accvgpr_read_b32 v216, a40
    v_accvgpr_read_b32 v217, a41
    v_accvgpr_read_b32 v218, a42
    v_accvgpr_read_b32 v219, a43
    v_accvgpr_read_b32 v220, a44
    v_accvgpr_read_b32 v221, a45
    v_accvgpr_read_b32 v222, a46
    v_accvgpr_read_b32 v223, a47
    v_pk_mul_f32 v[216:217], v[216:217], v[20:21] op_sel:[0,1] op_sel_hi:[1,1]
    v_pk_mul_f32 v[218:219], v[218:219], v[20:21] op_sel:[0,1] op_sel_hi:[1,1]
    v_pk_mul_f32 v[220:221], v[220:221], v[20:21] op_sel:[0,1] op_sel_hi:[1,1]
    v_pk_mul_f32 v[222:223], v[222:223], v[20:21] op_sel:[0,1] op_sel_hi:[1,1]
    v_cvt_pk_bf16_f32 v216, v216, v217
    v_cvt_pk_bf16_f32 v217, v218, v219
    v_cvt_pk_bf16_f32 v218, v220, v221
    v_cvt_pk_bf16_f32 v219, v222, v223
    ds_write_b128 v15, v[216:219] offset:5120
    v_accvgpr_read_b32 v248, a48
    v_accvgpr_read_b32 v249, a49
    v_accvgpr_read_b32 v250, a50
    v_accvgpr_read_b32 v251, a51
    v_accvgpr_read_b32 v252, a52
    v_accvgpr_read_b32 v253, a53
    v_accvgpr_read_b32 v254, a54
    v_accvgpr_read_b32 v255, a55
    v_pk_mul_f32 v[248:249], v[248:249], v[22:23] op_sel_hi:[1,0]
    v_pk_mul_f32 v[250:251], v[250:251], v[22:23] op_sel_hi:[1,0]
    v_pk_mul_f32 v[252:253], v[252:253], v[22:23] op_sel_hi:[1,0]
    v_pk_mul_f32 v[254:255], v[254:255], v[22:23] op_sel_hi:[1,0]
    v_cvt_pk_bf16_f32 v248, v248, v249
    v_cvt_pk_bf16_f32 v249, v250, v251
    v_cvt_pk_bf16_f32 v250, v252, v253
    v_cvt_pk_bf16_f32 v251, v254, v255
    ds_write_b128 v15, v[248:251] offset:6144
    s_waitcnt lgkmcnt(0)
    s_barrier
    ds_read_b128 a[0:3], v13 offset:0
    ds_read_b128 a[4:7], v13 offset:1024
    ds_read_b128 a[8:11], v13 offset:2048
    ds_read_b128 a[12:15], v13 offset:3072
    ds_read_b128 a[16:19], v13 offset:4096
    ds_read_b128 a[20:23], v13 offset:5120
    ds_read_b128 a[24:27], v13 offset:6144
    ds_read_b64_tr_b16 a[224:225], v1 offset:0
    ds_read_b64_tr_b16 a[226:227], v1 offset:1024
    ds_read_b64_tr_b16 a[228:229], v2 offset:0
    ds_read_b64_tr_b16 a[230:231], v2 offset:1024
    s_waitcnt lgkmcnt(0)
    s_add_u32 s52, s46, 131200
    v_mfma_f32_16x16x32_bf16 v[32:35], a[224:227], a[0:3], 0
    ds_read_b64_tr_b16 a[232:233], v1 offset:2048
    v_mfma_f32_16x16x32_bf16 v[36:39], a[228:231], a[0:3], 0
    s_add_u32 m0, s58, 0
    ds_read_b64_tr_b16 a[234:235], v1 offset:3072
    v_mfma_f32_16x16x32_bf16 v[64:67], a[224:227], a[4:7], 0
    ds_read_b64_tr_b16 a[236:237], v2 offset:2048
    v_accvgpr_read_b32 v56, a56
    v_mfma_f32_16x16x32_bf16 v[68:71], a[228:231], a[4:7], 0
    ds_read_b64_tr_b16 a[238:239], v2 offset:3072
    v_accvgpr_read_b32 v57, a57
    v_mfma_f32_16x16x32_bf16 v[96:99], a[224:227], a[8:11], 0
    buffer_load_dwordx4 v5, s[24:27], s52 offen offset:0 lds
    v_mfma_f32_16x16x32_bf16 v[100:103], a[228:231], a[8:11], 0
    buffer_load_dwordx4 v6, s[24:27], s52 offen offset:1024 lds
    v_mfma_f32_16x16x32_bf16 v[128:131], a[224:227], a[12:15], 0
    s_add_u32 m0, s58, 2048
    s_add_u32 s53, s46, 131264
    v_accvgpr_read_b32 v58, a58
    v_mfma_f32_16x16x32_bf16 v[132:135], a[228:231], a[12:15], 0
    s_waitcnt lgkmcnt(10)
    v_accvgpr_read_b32 v59, a59
    v_accvgpr_read_b32 v60, a60
    v_mfma_f32_16x16x32_bf16 v[160:163], a[224:227], a[16:19], 0
    v_accvgpr_read_b32 v61, a61
    v_accvgpr_read_b32 v62, a62
    v_mfma_f32_16x16x32_bf16 v[164:167], a[228:231], a[16:19], 0
    s_waitcnt lgkmcnt(0)
    v_accvgpr_read_b32 v63, a63
    v_mul_f32 v56, v56, v16
    v_mfma_f32_16x16x32_bf16 v[192:195], a[224:227], a[20:23], 0
    buffer_load_dwordx4 v5, s[24:27], s53 offen offset:0 lds
    v_mfma_f32_16x16x32_bf16 v[196:199], a[228:231], a[20:23], 0
    ds_read_b64_tr_b16 a[240:241], v1 offset:4096
    v_mfma_f32_16x16x32_bf16 v[224:227], a[224:227], a[24:27], 0
    ds_read_b64_tr_b16 a[242:243], v1 offset:5120
    v_mul_f32 v57, v57, v16
    v_mfma_f32_16x16x32_bf16 v[228:231], a[228:231], a[24:27], 0
    ds_read_b64_tr_b16 a[244:245], v2 offset:4096
    v_mul_f32 v58, v58, v16
    v_mfma_f32_16x16x32_bf16 v[40:43], a[232:235], a[0:3], 0
    ds_read_b64_tr_b16 a[246:247], v2 offset:5120
    v_mul_f32 v59, v59, v16
    v_mfma_f32_16x16x32_bf16 v[44:47], a[236:239], a[0:3], 0
    buffer_load_dwordx4 v6, s[24:27], s53 offen offset:1024 lds
    v_mfma_f32_16x16x32_bf16 v[72:75], a[232:235], a[4:7], 0
    s_add_u32 m0, s58, 4096
    s_add_u32 s53, s46, 262144
    v_mul_f32 v60, v60, v16
    v_mfma_f32_16x16x32_bf16 v[76:79], a[236:239], a[4:7], 0
    v_mul_f32 v61, v61, v16
    v_mul_f32 v62, v62, v16
    v_mfma_f32_16x16x32_bf16 v[104:107], a[232:235], a[8:11], 0
    v_mul_f32 v63, v63, v16
    v_cvt_pk_bf16_f32 v56, v56, v57
    v_mfma_f32_16x16x32_bf16 v[108:111], a[236:239], a[8:11], 0
    s_waitcnt lgkmcnt(0)
    v_cvt_pk_bf16_f32 v57, v58, v59
    v_cvt_pk_bf16_f32 v58, v60, v61
    v_mfma_f32_16x16x32_bf16 v[136:139], a[232:235], a[12:15], 0
    buffer_load_dwordx4 v5, s[24:27], s53 offen offset:0 lds
    v_mfma_f32_16x16x32_bf16 v[140:143], a[236:239], a[12:15], 0
    ds_read_b64_tr_b16 a[248:249], v1 offset:6144
    v_mfma_f32_16x16x32_bf16 v[168:171], a[232:235], a[16:19], 0
    ds_read_b64_tr_b16 a[250:251], v1 offset:7168
    v_cvt_pk_bf16_f32 v59, v62, v63
    v_mfma_f32_16x16x32_bf16 v[172:175], a[236:239], a[16:19], 0
    ds_read_b64_tr_b16 a[252:253], v2 offset:6144
    v_accvgpr_read_b32 v88, a64
    v_mfma_f32_16x16x32_bf16 v[200:203], a[232:235], a[20:23], 0
    ds_read_b64_tr_b16 a[254:255], v2 offset:7168
    v_accvgpr_read_b32 v89, a65
    v_mfma_f32_16x16x32_bf16 v[204:207], a[236:239], a[20:23], 0
    buffer_load_dwordx4 v6, s[24:27], s53 offen offset:1024 lds
    v_mfma_f32_16x16x32_bf16 v[232:235], a[232:235], a[24:27], 0
    s_add_u32 m0, s58, 6144
    s_add_u32 s53, s46, 262208
    v_accvgpr_read_b32 v90, a66
    v_mfma_f32_16x16x32_bf16 v[236:239], a[236:239], a[24:27], 0
    ds_write_b128 v15, v[56:59] offset:7168
    v_mfma_f32_16x16x32_bf16 v[48:51], a[240:243], a[0:3], 0
    s_add_u32 s52, s46, 262272
    v_accvgpr_read_b32 v91, a67
    v_accvgpr_read_b32 v92, a68
    v_mfma_f32_16x16x32_bf16 v[52:55], a[244:247], a[0:3], 0
    ds_read_b128 a[0:3], v13 offset:32768
    v_accvgpr_read_b32 v93, a69
    v_mfma_f32_16x16x32_bf16 v[80:83], a[240:243], a[4:7], 0
    s_waitcnt vmcnt(8)
    ds_read_b64_tr_b16 a[224:225], v3 offset:0
    v_mfma_f32_16x16x32_bf16 v[84:87], a[244:247], a[4:7], 0
    s_waitcnt lgkmcnt(3)
    ds_read_b128 a[4:7], v13 offset:33792
    v_mfma_f32_16x16x32_bf16 v[112:115], a[240:243], a[8:11], 0
    ds_read_b64_tr_b16 a[226:227], v3 offset:1024
    v_accvgpr_read_b32 v94, a70
    v_mfma_f32_16x16x32_bf16 v[116:119], a[244:247], a[8:11], 0
    ds_read_b128 a[8:11], v13 offset:34816
    v_accvgpr_read_b32 v95, a71
    v_mfma_f32_16x16x32_bf16 v[144:147], a[240:243], a[12:15], 0
    ds_read_b64_tr_b16 a[228:229], v4 offset:0
    v_mul_f32 v88, v88, v17
    v_mfma_f32_16x16x32_bf16 v[148:151], a[244:247], a[12:15], 0
    ds_read_b128 a[12:15], v13 offset:35840
    v_mul_f32 v89, v89, v17
    v_mfma_f32_16x16x32_bf16 v[176:179], a[240:243], a[16:19], 0
    ds_read_b64_tr_b16 a[230:231], v4 offset:1024
    v_mul_f32 v90, v90, v17
    v_mfma_f32_16x16x32_bf16 v[180:183], a[244:247], a[16:19], 0
    ds_read_b128 a[16:19], v13 offset:36864
    v_mul_f32 v91, v91, v17
    v_mfma_f32_16x16x32_bf16 v[208:211], a[240:243], a[20:23], 0
    buffer_load_dwordx4 v5, s[24:27], s53 offen offset:0 lds
    v_mfma_f32_16x16x32_bf16 v[212:215], a[244:247], a[20:23], 0
    ds_read_b128 a[20:23], v13 offset:37888
    v_mul_f32 v92, v92, v17
    v_mfma_f32_16x16x32_bf16 v[240:243], a[240:243], a[24:27], 0
    buffer_load_dwordx4 v6, s[24:27], s53 offen offset:1024 lds
    v_mfma_f32_16x16x32_bf16 v[244:247], a[244:247], a[24:27], 0
    s_waitcnt lgkmcnt(2)
    ds_read_b128 a[24:27], v13 offset:38912
    v_mfma_f32_16x16x32_bf16 v[32:35], a[224:227], a[0:3], v[32:35]
    s_waitcnt vmcnt(8)
    ds_read_b64_tr_b16 a[232:233], v3 offset:2048
    v_mfma_f32_16x16x32_bf16 v[36:39], a[228:231], a[0:3], v[36:39]
    s_add_u32 m0, s59, 0
    ds_read_b64_tr_b16 a[234:235], v3 offset:3072
    v_mfma_f32_16x16x32_bf16 v[64:67], a[224:227], a[4:7], v[64:67]
    ds_read_b64_tr_b16 a[236:237], v4 offset:2048
    v_mul_f32 v93, v93, v17
    v_mfma_f32_16x16x32_bf16 v[68:71], a[228:231], a[4:7], v[68:71]
    ds_read_b64_tr_b16 a[238:239], v4 offset:3072
    v_mul_f32 v94, v94, v17
    v_mfma_f32_16x16x32_bf16 v[96:99], a[224:227], a[8:11], v[96:99]
    buffer_load_dwordx4 v5, s[24:27], s52 offen offset:0 lds
    v_mfma_f32_16x16x32_bf16 v[100:103], a[228:231], a[8:11], v[100:103]
    buffer_load_dwordx4 v6, s[24:27], s52 offen offset:1024 lds
    v_mfma_f32_16x16x32_bf16 v[128:131], a[224:227], a[12:15], v[128:131]
    s_add_u32 m0, s59, 2048
    s_add_u32 s53, s46, 262336
    v_mul_f32 v95, v95, v17
    v_mfma_f32_16x16x32_bf16 v[132:135], a[228:231], a[12:15], v[132:135]
    s_waitcnt lgkmcnt(6)
    v_cvt_pk_bf16_f32 v88, v88, v89
    v_cvt_pk_bf16_f32 v89, v90, v91
    v_mfma_f32_16x16x32_bf16 v[160:163], a[224:227], a[16:19], v[160:163]
    v_cvt_pk_bf16_f32 v90, v92, v93
    v_cvt_pk_bf16_f32 v91, v94, v95
    v_mfma_f32_16x16x32_bf16 v[164:167], a[228:231], a[16:19], v[164:167]
    s_waitcnt lgkmcnt(0)
    v_accvgpr_read_b32 v120, a72
    v_accvgpr_read_b32 v121, a73
    v_mfma_f32_16x16x32_bf16 v[192:195], a[224:227], a[20:23], v[192:195]
    buffer_load_dwordx4 v5, s[24:27], s53 offen offset:0 lds
    v_mfma_f32_16x16x32_bf16 v[196:199], a[228:231], a[20:23], v[196:199]
    s_waitcnt vmcnt(9)
    ds_read_b64_tr_b16 a[240:241], v1 offset:0
    v_mfma_f32_16x16x32_bf16 v[224:227], a[224:227], a[24:27], v[224:227]
    ds_read_b64_tr_b16 a[242:243], v1 offset:1024
    v_accvgpr_read_b32 v122, a74
    v_mfma_f32_16x16x32_bf16 v[228:231], a[228:231], a[24:27], v[228:231]
    ds_read_b64_tr_b16 a[244:245], v2 offset:0
    v_accvgpr_read_b32 v123, a75
    v_mfma_f32_16x16x32_bf16 v[40:43], a[232:235], a[0:3], v[40:43]
    ds_read_b64_tr_b16 a[246:247], v2 offset:1024
    v_accvgpr_read_b32 v124, a76
    v_mfma_f32_16x16x32_bf16 v[44:47], a[236:239], a[0:3], v[44:47]
    buffer_load_dwordx4 v6, s[24:27], s53 offen offset:1024 lds
    v_mfma_f32_16x16x32_bf16 v[72:75], a[232:235], a[4:7], v[72:75]
    s_add_u32 m0, s58, 0
    s_add_u32 s53, s46, 393216
    v_accvgpr_read_b32 v125, a77
    v_mfma_f32_16x16x32_bf16 v[76:79], a[236:239], a[4:7], v[76:79]
    ds_write_b128 v15, v[88:91] offset:8192
    v_mfma_f32_16x16x32_bf16 v[104:107], a[232:235], a[8:11], v[104:107]
    v_accvgpr_read_b32 v126, a78
    v_accvgpr_read_b32 v127, a79
    v_mfma_f32_16x16x32_bf16 v[108:111], a[236:239], a[8:11], v[108:111]
    s_waitcnt lgkmcnt(1)
    v_mul_f32 v120, v120, v18
    v_mul_f32 v121, v121, v18
    v_mfma_f32_16x16x32_bf16 v[136:139], a[232:235], a[12:15], v[136:139]
    buffer_load_dwordx4 v5, s[24:27], s53 offen offset:0 lds
    v_mfma_f32_16x16x32_bf16 v[140:143], a[236:239], a[12:15], v[140:143]
    s_waitcnt vmcnt(9)
    ds_read_b64_tr_b16 a[28:29], v1 offset:2048
    v_mfma_f32_16x16x32_bf16 v[168:171], a[232:235], a[16:19], v[168:171]
    ds_read_b64_tr_b16 a[30:31], v1 offset:3072
    v_mul_f32 v122, v122, v18
    v_mfma_f32_16x16x32_bf16 v[172:175], a[236:239], a[16:19], v[172:175]
    ds_read_b64_tr_b16 a[32:33], v2 offset:2048
    v_mul_f32 v123, v123, v18
    v_mfma_f32_16x16x32_bf16 v[200:203], a[232:235], a[20:23], v[200:203]
    ds_read_b64_tr_b16 a[34:35], v2 offset:3072
    v_mul_f32 v124, v124, v18
    v_mfma_f32_16x16x32_bf16 v[204:207], a[236:239], a[20:23], v[204:207]
    buffer_load_dwordx4 v6, s[24:27], s53 offen offset:1024 lds
    v_mfma_f32_16x16x32_bf16 v[232:235], a[232:235], a[24:27], v[232:235]
    s_add_u32 m0, s58, 2048
    s_add_u32 s53, s46, 393280
    v_mul_f32 v125, v125, v18
    v_mfma_f32_16x16x32_bf16 v[236:239], a[236:239], a[24:27], v[236:239]
    v_mul_f32 v126, v126, v18
    v_mul_f32 v127, v127, v18
    v_mfma_f32_16x16x32_bf16 v[48:51], a[240:243], a[0:3], v[48:51]
    s_add_u32 s52, s46, 393344
    v_cvt_pk_bf16_f32 v120, v120, v121
    v_cvt_pk_bf16_f32 v121, v122, v123
    v_mfma_f32_16x16x32_bf16 v[52:55], a[244:247], a[0:3], v[52:55]
    ds_read_b128 a[0:3], v14 offset:0
    v_cvt_pk_bf16_f32 v122, v124, v125
    v_mfma_f32_16x16x32_bf16 v[80:83], a[240:243], a[4:7], v[80:83]
    s_waitcnt vmcnt(8)
    ds_read_b64_tr_b16 a[224:225], v1 offset:4096
    v_mfma_f32_16x16x32_bf16 v[84:87], a[244:247], a[4:7], v[84:87]
    s_waitcnt lgkmcnt(2)
    ds_read_b128 a[4:7], v14 offset:1024
    v_mfma_f32_16x16x32_bf16 v[112:115], a[240:243], a[8:11], v[112:115]
    ds_read_b64_tr_b16 a[226:227], v1 offset:5120
    v_cvt_pk_bf16_f32 v123, v126, v127
    v_mfma_f32_16x16x32_bf16 v[116:119], a[244:247], a[8:11], v[116:119]
    ds_read_b128 a[8:11], v14 offset:2048
    v_accvgpr_read_b32 v152, a80
    v_mfma_f32_16x16x32_bf16 v[144:147], a[240:243], a[12:15], v[144:147]
    ds_read_b64_tr_b16 a[228:229], v2 offset:4096
    v_accvgpr_read_b32 v153, a81
    v_mfma_f32_16x16x32_bf16 v[148:151], a[244:247], a[12:15], v[148:151]
    ds_read_b128 a[12:15], v14 offset:3072
    v_accvgpr_read_b32 v154, a82
    v_mfma_f32_16x16x32_bf16 v[176:179], a[240:243], a[16:19], v[176:179]
    ds_read_b64_tr_b16 a[230:231], v2 offset:5120
    v_accvgpr_read_b32 v155, a83
    v_mfma_f32_16x16x32_bf16 v[180:183], a[244:247], a[16:19], v[180:183]
    ds_read_b128 a[16:19], v14 offset:4096
    v_accvgpr_read_b32 v156, a84
    v_mfma_f32_16x16x32_bf16 v[208:211], a[240:243], a[20:23], v[208:211]
    buffer_load_dwordx4 v5, s[24:27], s53 offen offset:0 lds
    v_mfma_f32_16x16x32_bf16 v[212:215], a[244:247], a[20:23], v[212:215]
    ds_read_b128 a[20:23], v14 offset:5120
    v_accvgpr_read_b32 v157, a85
    v_mfma_f32_16x16x32_bf16 v[240:243], a[240:243], a[24:27], v[240:243]
    buffer_load_dwordx4 v6, s[24:27], s53 offen offset:1024 lds
    v_mfma_f32_16x16x32_bf16 v[244:247], a[244:247], a[24:27], v[244:247]
    s_waitcnt lgkmcnt(2)
    ds_read_b128 a[24:27], v14 offset:6144
    v_mfma_f32_16x16x32_bf16 v[32:35], a[224:227], a[0:3], v[32:35]
    s_waitcnt vmcnt(8)
    ds_read_b64_tr_b16 a[232:233], v1 offset:6144
    v_mfma_f32_16x16x32_bf16 v[36:39], a[228:231], a[0:3], v[36:39]
    s_add_u32 m0, s58, 4096
    ds_read_b64_tr_b16 a[234:235], v1 offset:7168
    v_mfma_f32_16x16x32_bf16 v[64:67], a[224:227], a[4:7], v[64:67]
    ds_read_b64_tr_b16 a[236:237], v2 offset:6144
    v_accvgpr_read_b32 v158, a86
    v_mfma_f32_16x16x32_bf16 v[68:71], a[228:231], a[4:7], v[68:71]
    ds_read_b64_tr_b16 a[238:239], v2 offset:7168
    v_accvgpr_read_b32 v159, a87
    v_mfma_f32_16x16x32_bf16 v[96:99], a[224:227], a[8:11], v[96:99]
    buffer_load_dwordx4 v5, s[24:27], s52 offen offset:0 lds
    v_mfma_f32_16x16x32_bf16 v[100:103], a[228:231], a[8:11], v[100:103]
    buffer_load_dwordx4 v6, s[24:27], s52 offen offset:1024 lds
    v_mfma_f32_16x16x32_bf16 v[128:131], a[224:227], a[12:15], v[128:131]
    s_add_u32 m0, s58, 6144
    s_add_u32 s53, s46, 393408
    v_mul_f32 v152, v152, v19
    v_mfma_f32_16x16x32_bf16 v[132:135], a[228:231], a[12:15], v[132:135]
    s_waitcnt lgkmcnt(6)
    v_mul_f32 v153, v153, v19
    v_mul_f32 v154, v154, v19
    v_mfma_f32_16x16x32_bf16 v[160:163], a[224:227], a[16:19], v[160:163]
    ds_write_b128 v15, v[120:123] offset:9216
    v_mfma_f32_16x16x32_bf16 v[164:167], a[228:231], a[16:19], v[164:167]
    s_waitcnt lgkmcnt(1)
    v_mul_f32 v155, v155, v19
    v_mul_f32 v156, v156, v19
    v_mfma_f32_16x16x32_bf16 v[192:195], a[224:227], a[20:23], v[192:195]
    buffer_load_dwordx4 v5, s[24:27], s53 offen offset:0 lds
    v_mfma_f32_16x16x32_bf16 v[196:199], a[228:231], a[20:23], v[196:199]
    s_waitcnt vmcnt(9)
    ds_read_b64_tr_b16 a[240:241], v3 offset:0
    v_mfma_f32_16x16x32_bf16 v[224:227], a[224:227], a[24:27], v[224:227]
    ds_read_b64_tr_b16 a[242:243], v3 offset:1024
    v_mul_f32 v157, v157, v19
    v_mfma_f32_16x16x32_bf16 v[228:231], a[228:231], a[24:27], v[228:231]
    ds_read_b64_tr_b16 a[244:245], v4 offset:0
    v_mul_f32 v158, v158, v19
    v_mfma_f32_16x16x32_bf16 v[40:43], a[232:235], a[0:3], v[40:43]
    ds_read_b64_tr_b16 a[246:247], v4 offset:1024
    v_mul_f32 v159, v159, v19
    v_mfma_f32_16x16x32_bf16 v[44:47], a[236:239], a[0:3], v[44:47]
    buffer_load_dwordx4 v6, s[24:27], s53 offen offset:1024 lds
    v_mfma_f32_16x16x32_bf16 v[72:75], a[232:235], a[4:7], v[72:75]
    s_add_u32 m0, s59, 0
    s_add_u32 s53, s46, 32768
    v_cvt_pk_bf16_f32 v152, v152, v153
    v_mfma_f32_16x16x32_bf16 v[76:79], a[236:239], a[4:7], v[76:79]
    v_cvt_pk_bf16_f32 v153, v154, v155
    v_cvt_pk_bf16_f32 v154, v156, v157
    v_mfma_f32_16x16x32_bf16 v[104:107], a[232:235], a[8:11], v[104:107]
    v_cvt_pk_bf16_f32 v155, v158, v159
    v_accvgpr_read_b32 v184, a88
    v_mfma_f32_16x16x32_bf16 v[108:111], a[236:239], a[8:11], v[108:111]
    s_waitcnt lgkmcnt(0)
    v_accvgpr_read_b32 v185, a89
    v_accvgpr_read_b32 v186, a90
    v_mfma_f32_16x16x32_bf16 v[136:139], a[232:235], a[12:15], v[136:139]
    buffer_load_dwordx4 v5, s[24:27], s53 offen offset:0 lds
    v_mfma_f32_16x16x32_bf16 v[140:143], a[236:239], a[12:15], v[140:143]
    s_waitcnt vmcnt(9)
    ds_read_b64_tr_b16 a[36:37], v3 offset:2048
    v_mfma_f32_16x16x32_bf16 v[168:171], a[232:235], a[16:19], v[168:171]
    ds_read_b64_tr_b16 a[38:39], v3 offset:3072
    v_accvgpr_read_b32 v187, a91
    v_mfma_f32_16x16x32_bf16 v[172:175], a[236:239], a[16:19], v[172:175]
    ds_read_b64_tr_b16 a[40:41], v4 offset:2048
    v_accvgpr_read_b32 v188, a92
    v_mfma_f32_16x16x32_bf16 v[200:203], a[232:235], a[20:23], v[200:203]
    ds_read_b64_tr_b16 a[42:43], v4 offset:3072
    v_accvgpr_read_b32 v189, a93
    v_mfma_f32_16x16x32_bf16 v[204:207], a[236:239], a[20:23], v[204:207]
    buffer_load_dwordx4 v6, s[24:27], s53 offen offset:1024 lds
    v_mfma_f32_16x16x32_bf16 v[232:235], a[232:235], a[24:27], v[232:235]
    s_add_u32 m0, s59, 2048
    s_add_u32 s53, s46, 32832
    v_accvgpr_read_b32 v190, a94
    v_mfma_f32_16x16x32_bf16 v[236:239], a[236:239], a[24:27], v[236:239]
    ds_write_b128 v15, v[152:155] offset:10240
    v_mfma_f32_16x16x32_bf16 v[48:51], a[240:243], a[0:3], v[48:51]
    s_add_u32 s52, s46, 32896
    v_accvgpr_read_b32 v191, a95
    v_mul_f32 v184, v184, v20
    v_mfma_f32_16x16x32_bf16 v[52:55], a[244:247], a[0:3], v[52:55]
    ds_read_b128 a[0:3], v14 offset:32768
    v_mul_f32 v185, v185, v20
    v_mfma_f32_16x16x32_bf16 v[80:83], a[240:243], a[4:7], v[80:83]
    s_waitcnt vmcnt(8)
    ds_read_b64_tr_b16 a[224:225], v1 offset:0
    v_mfma_f32_16x16x32_bf16 v[84:87], a[244:247], a[4:7], v[84:87]
    s_waitcnt lgkmcnt(3)
    ds_read_b128 a[4:7], v14 offset:33792
    v_mfma_f32_16x16x32_bf16 v[112:115], a[240:243], a[8:11], v[112:115]
    ds_read_b64_tr_b16 a[226:227], v1 offset:1024
    v_mul_f32 v186, v186, v20
    v_mfma_f32_16x16x32_bf16 v[116:119], a[244:247], a[8:11], v[116:119]
    ds_read_b128 a[8:11], v14 offset:34816
    v_mul_f32 v187, v187, v20
    v_mfma_f32_16x16x32_bf16 v[144:147], a[240:243], a[12:15], v[144:147]
    ds_read_b64_tr_b16 a[228:229], v2 offset:0
    v_mul_f32 v188, v188, v20
    v_mfma_f32_16x16x32_bf16 v[148:151], a[244:247], a[12:15], v[148:151]
    ds_read_b128 a[12:15], v14 offset:35840
    v_mul_f32 v189, v189, v20
    v_mfma_f32_16x16x32_bf16 v[176:179], a[240:243], a[16:19], v[176:179]
    ds_read_b64_tr_b16 a[230:231], v2 offset:1024
    v_mul_f32 v190, v190, v20
    v_mfma_f32_16x16x32_bf16 v[180:183], a[244:247], a[16:19], v[180:183]
    ds_read_b128 a[16:19], v14 offset:36864
    v_mul_f32 v191, v191, v20
    v_mfma_f32_16x16x32_bf16 v[208:211], a[240:243], a[20:23], v[208:211]
    buffer_load_dwordx4 v5, s[24:27], s53 offen offset:0 lds
    v_mfma_f32_16x16x32_bf16 v[212:215], a[244:247], a[20:23], v[212:215]
    ds_read_b128 a[20:23], v14 offset:37888
    v_cvt_pk_bf16_f32 v184, v184, v185
    v_mfma_f32_16x16x32_bf16 v[240:243], a[240:243], a[24:27], v[240:243]
    buffer_load_dwordx4 v6, s[24:27], s53 offen offset:1024 lds
    v_mfma_f32_16x16x32_bf16 v[244:247], a[244:247], a[24:27], v[244:247]
    s_waitcnt lgkmcnt(2)
    ds_read_b128 a[24:27], v14 offset:38912
    v_mfma_f32_16x16x32_bf16 v[32:35], a[224:227], a[0:3], v[32:35]
    s_waitcnt vmcnt(8)
    ds_read_b64_tr_b16 a[232:233], v1 offset:2048
    v_mfma_f32_16x16x32_bf16 v[36:39], a[228:231], a[0:3], v[36:39]
    s_add_u32 m0, s58, 0
    ds_read_b64_tr_b16 a[234:235], v1 offset:3072
    v_mfma_f32_16x16x32_bf16 v[64:67], a[224:227], a[4:7], v[64:67]
    ds_read_b64_tr_b16 a[236:237], v2 offset:2048
    v_cvt_pk_bf16_f32 v185, v186, v187
    v_mfma_f32_16x16x32_bf16 v[68:71], a[228:231], a[4:7], v[68:71]
    ds_read_b64_tr_b16 a[238:239], v2 offset:3072
    v_cvt_pk_bf16_f32 v186, v188, v189
    v_mfma_f32_16x16x32_bf16 v[96:99], a[224:227], a[8:11], v[96:99]
    buffer_load_dwordx4 v5, s[24:27], s52 offen offset:0 lds
    v_mfma_f32_16x16x32_bf16 v[100:103], a[228:231], a[8:11], v[100:103]
    buffer_load_dwordx4 v6, s[24:27], s52 offen offset:1024 lds
    v_mfma_f32_16x16x32_bf16 v[128:131], a[224:227], a[12:15], v[128:131]
    s_add_u32 m0, s58, 2048
    s_add_u32 s53, s46, 32960
    v_cvt_pk_bf16_f32 v187, v190, v191
    v_mfma_f32_16x16x32_bf16 v[132:135], a[228:231], a[12:15], v[132:135]
    s_waitcnt lgkmcnt(6)
    v_accvgpr_read_b32 v216, a96
    v_accvgpr_read_b32 v217, a97
    v_mfma_f32_16x16x32_bf16 v[160:163], a[224:227], a[16:19], v[160:163]
    ds_write_b128 v15, v[184:187] offset:11264
    v_mfma_f32_16x16x32_bf16 v[164:167], a[228:231], a[16:19], v[164:167]
    s_waitcnt lgkmcnt(1)
    v_accvgpr_read_b32 v218, a98
    v_accvgpr_read_b32 v219, a99
    v_mfma_f32_16x16x32_bf16 v[192:195], a[224:227], a[20:23], v[192:195]
    buffer_load_dwordx4 v5, s[24:27], s53 offen offset:0 lds
    v_mfma_f32_16x16x32_bf16 v[196:199], a[228:231], a[20:23], v[196:199]
    s_waitcnt vmcnt(9)
    ds_read_b64_tr_b16 a[240:241], v1 offset:4096
    v_mfma_f32_16x16x32_bf16 v[224:227], a[224:227], a[24:27], v[224:227]
    ds_read_b64_tr_b16 a[242:243], v1 offset:5120
    v_accvgpr_read_b32 v220, a100
    v_mfma_f32_16x16x32_bf16 v[228:231], a[228:231], a[24:27], v[228:231]
    ds_read_b64_tr_b16 a[244:245], v2 offset:4096
    v_accvgpr_read_b32 v221, a101
    v_mfma_f32_16x16x32_bf16 v[40:43], a[232:235], a[0:3], v[40:43]
    ds_read_b64_tr_b16 a[246:247], v2 offset:5120
    v_accvgpr_read_b32 v222, a102
    v_mfma_f32_16x16x32_bf16 v[44:47], a[236:239], a[0:3], v[44:47]
    buffer_load_dwordx4 v6, s[24:27], s53 offen offset:1024 lds
    v_mfma_f32_16x16x32_bf16 v[72:75], a[232:235], a[4:7], v[72:75]
    s_add_u32 m0, s58, 4096
    s_add_u32 s53, s46, 163840
    v_accvgpr_read_b32 v223, a103
    v_mfma_f32_16x16x32_bf16 v[76:79], a[236:239], a[4:7], v[76:79]
    v_mul_f32 v216, v216, v21
    v_mul_f32 v217, v217, v21
    v_mfma_f32_16x16x32_bf16 v[104:107], a[232:235], a[8:11], v[104:107]
    v_mul_f32 v218, v218, v21
    v_mul_f32 v219, v219, v21
    v_mfma_f32_16x16x32_bf16 v[108:111], a[236:239], a[8:11], v[108:111]
    s_waitcnt lgkmcnt(0)
    v_mul_f32 v220, v220, v21
    v_mul_f32 v221, v221, v21
    v_mfma_f32_16x16x32_bf16 v[136:139], a[232:235], a[12:15], v[136:139]
    buffer_load_dwordx4 v5, s[24:27], s53 offen offset:0 lds
    v_mfma_f32_16x16x32_bf16 v[140:143], a[236:239], a[12:15], v[140:143]
    s_waitcnt vmcnt(9)
    ds_read_b64_tr_b16 a[44:45], v1 offset:6144
    v_mfma_f32_16x16x32_bf16 v[168:171], a[232:235], a[16:19], v[168:171]
    ds_read_b64_tr_b16 a[46:47], v1 offset:7168
    v_mul_f32 v222, v222, v21
    v_mfma_f32_16x16x32_bf16 v[172:175], a[236:239], a[16:19], v[172:175]
    ds_read_b64_tr_b16 a[48:49], v2 offset:6144
    v_mul_f32 v223, v223, v21
    v_mfma_f32_16x16x32_bf16 v[200:203], a[232:235], a[20:23], v[200:203]
    ds_read_b64_tr_b16 a[50:51], v2 offset:7168
    v_cvt_pk_bf16_f32 v216, v216, v217
    v_mfma_f32_16x16x32_bf16 v[204:207], a[236:239], a[20:23], v[204:207]
    buffer_load_dwordx4 v6, s[24:27], s53 offen offset:1024 lds
    v_mfma_f32_16x16x32_bf16 v[232:235], a[232:235], a[24:27], v[232:235]
    s_add_u32 m0, s58, 6144
    s_add_u32 s53, s46, 163904
    v_cvt_pk_bf16_f32 v217, v218, v219
    v_mfma_f32_16x16x32_bf16 v[236:239], a[236:239], a[24:27], v[236:239]
    v_cvt_pk_bf16_f32 v218, v220, v221
    v_cvt_pk_bf16_f32 v219, v222, v223
    ds_write_b128 v15, v[216:219] offset:12288
    v_accvgpr_read_b32 v248, a104
    v_accvgpr_read_b32 v249, a105
    v_accvgpr_read_b32 v250, a106
    v_accvgpr_read_b32 v251, a107
    v_accvgpr_read_b32 v252, a108
    v_accvgpr_read_b32 v253, a109
    v_accvgpr_read_b32 v254, a110
    v_accvgpr_read_b32 v255, a111
    v_mul_f32 v248, v248, v22
    v_mul_f32 v249, v249, v22
    v_mul_f32 v250, v250, v22
    v_mul_f32 v251, v251, v22
    v_mul_f32 v252, v252, v22
    v_mul_f32 v253, v253, v22
    v_mul_f32 v254, v254, v22
    v_mul_f32 v255, v255, v22
    v_cvt_pk_bf16_f32 v248, v248, v249
    v_cvt_pk_bf16_f32 v249, v250, v251
    v_cvt_pk_bf16_f32 v250, v252, v253
    v_cvt_pk_bf16_f32 v251, v254, v255
    ds_write_b128 v15, v[248:251] offset:13312
    s_waitcnt lgkmcnt(0)
    s_barrier
    v_mfma_f32_16x16x32_bf16 v[48:51], a[240:243], a[0:3], v[48:51]
    s_add_u32 s52, s46, 163968
    v_mfma_f32_16x16x32_bf16 v[52:55], a[244:247], a[0:3], v[52:55]
    ds_read_b128 a[0:3], v13 offset:7168
    v_mfma_f32_16x16x32_bf16 v[80:83], a[240:243], a[4:7], v[80:83]
    s_waitcnt vmcnt(8)
    ds_read_b64_tr_b16 a[224:225], v3 offset:0
    v_mfma_f32_16x16x32_bf16 v[84:87], a[244:247], a[4:7], v[84:87]
    s_waitcnt lgkmcnt(4)
    ds_read_b128 a[4:7], v13 offset:8192
    v_mfma_f32_16x16x32_bf16 v[112:115], a[240:243], a[8:11], v[112:115]
    ds_read_b64_tr_b16 a[226:227], v3 offset:1024
    v_mfma_f32_16x16x32_bf16 v[116:119], a[244:247], a[8:11], v[116:119]
    ds_read_b128 a[8:11], v13 offset:9216
    v_mfma_f32_16x16x32_bf16 v[144:147], a[240:243], a[12:15], v[144:147]
    ds_read_b64_tr_b16 a[228:229], v4 offset:0
    v_mfma_f32_16x16x32_bf16 v[148:151], a[244:247], a[12:15], v[148:151]
    ds_read_b128 a[12:15], v13 offset:10240
    v_mfma_f32_16x16x32_bf16 v[176:179], a[240:243], a[16:19], v[176:179]
    ds_read_b64_tr_b16 a[230:231], v4 offset:1024
    v_mfma_f32_16x16x32_bf16 v[180:183], a[244:247], a[16:19], v[180:183]
    ds_read_b128 a[16:19], v13 offset:11264
    v_mfma_f32_16x16x32_bf16 v[208:211], a[240:243], a[20:23], v[208:211]
    buffer_load_dwordx4 v5, s[24:27], s53 offen offset:0 lds
    v_mfma_f32_16x16x32_bf16 v[212:215], a[244:247], a[20:23], v[212:215]
    ds_read_b128 a[20:23], v13 offset:12288
    v_mfma_f32_16x16x32_bf16 v[240:243], a[240:243], a[24:27], v[240:243]
    buffer_load_dwordx4 v6, s[24:27], s53 offen offset:1024 lds
    v_mfma_f32_16x16x32_bf16 v[244:247], a[244:247], a[24:27], v[244:247]
    s_waitcnt lgkmcnt(2)
    ds_read_b128 a[24:27], v13 offset:13312
    v_mfma_f32_16x16x32_bf16 v[32:35], a[224:227], a[0:3], v[32:35]
    s_waitcnt vmcnt(8)
    ds_read_b64_tr_b16 a[232:233], v3 offset:2048
    v_mfma_f32_16x16x32_bf16 v[36:39], a[228:231], a[0:3], v[36:39]
    s_add_u32 m0, s59, 0
    ds_read_b64_tr_b16 a[234:235], v3 offset:3072
    v_mfma_f32_16x16x32_bf16 v[64:67], a[224:227], a[4:7], v[64:67]
    ds_read_b64_tr_b16 a[236:237], v4 offset:2048
    v_accvgpr_read_b32 v56, a112
    v_mfma_f32_16x16x32_bf16 v[68:71], a[228:231], a[4:7], v[68:71]
    ds_read_b64_tr_b16 a[238:239], v4 offset:3072
    v_accvgpr_read_b32 v57, a113
    v_mfma_f32_16x16x32_bf16 v[96:99], a[224:227], a[8:11], v[96:99]
    buffer_load_dwordx4 v5, s[24:27], s52 offen offset:0 lds
    v_mfma_f32_16x16x32_bf16 v[100:103], a[228:231], a[8:11], v[100:103]
    buffer_load_dwordx4 v6, s[24:27], s52 offen offset:1024 lds
    v_mfma_f32_16x16x32_bf16 v[128:131], a[224:227], a[12:15], v[128:131]
    s_add_u32 m0, s59, 2048
    s_add_u32 s53, s46, 164032
    v_accvgpr_read_b32 v58, a114
    v_mfma_f32_16x16x32_bf16 v[132:135], a[228:231], a[12:15], v[132:135]
    s_waitcnt lgkmcnt(6)
    v_accvgpr_read_b32 v59, a115
    v_accvgpr_read_b32 v60, a116
    v_mfma_f32_16x16x32_bf16 v[160:163], a[224:227], a[16:19], v[160:163]
    v_accvgpr_read_b32 v61, a117
    v_accvgpr_read_b32 v62, a118
    v_mfma_f32_16x16x32_bf16 v[164:167], a[228:231], a[16:19], v[164:167]
    s_waitcnt lgkmcnt(0)
    v_accvgpr_read_b32 v63, a119
    v_mul_f32 v56, v56, v16
    v_mfma_f32_16x16x32_bf16 v[192:195], a[224:227], a[20:23], v[192:195]
    buffer_load_dwordx4 v5, s[24:27], s53 offen offset:0 lds
    v_mfma_f32_16x16x32_bf16 v[196:199], a[228:231], a[20:23], v[196:199]
    s_waitcnt vmcnt(9)
    ds_read_b64_tr_b16 a[240:241], v1 offset:0
    v_mfma_f32_16x16x32_bf16 v[224:227], a[224:227], a[24:27], v[224:227]
    ds_read_b64_tr_b16 a[242:243], v1 offset:1024
    v_mul_f32 v57, v57, v16
    v_mfma_f32_16x16x32_bf16 v[228:231], a[228:231], a[24:27], v[228:231]
    ds_read_b64_tr_b16 a[244:245], v2 offset:0
    v_mul_f32 v58, v58, v16
    v_mfma_f32_16x16x32_bf16 v[40:43], a[232:235], a[0:3], v[40:43]
    ds_read_b64_tr_b16 a[246:247], v2 offset:1024
    v_mul_f32 v59, v59, v16
    v_mfma_f32_16x16x32_bf16 v[44:47], a[236:239], a[0:3], v[44:47]
    buffer_load_dwordx4 v6, s[24:27], s53 offen offset:1024 lds
    v_mfma_f32_16x16x32_bf16 v[72:75], a[232:235], a[4:7], v[72:75]
    s_add_u32 m0, s58, 0
    s_add_u32 s53, s46, 294912
    v_mul_f32 v60, v60, v16
    v_mfma_f32_16x16x32_bf16 v[76:79], a[236:239], a[4:7], v[76:79]
    v_mul_f32 v61, v61, v16
    v_mul_f32 v62, v62, v16
    v_mfma_f32_16x16x32_bf16 v[104:107], a[232:235], a[8:11], v[104:107]
    v_mul_f32 v63, v63, v16
    v_cvt_pk_bf16_f32 v56, v56, v57
    v_mfma_f32_16x16x32_bf16 v[108:111], a[236:239], a[8:11], v[108:111]
    s_waitcnt lgkmcnt(0)
    v_cvt_pk_bf16_f32 v57, v58, v59
    v_cvt_pk_bf16_f32 v58, v60, v61
    v_mfma_f32_16x16x32_bf16 v[136:139], a[232:235], a[12:15], v[136:139]
    buffer_load_dwordx4 v5, s[24:27], s53 offen offset:0 lds
    v_mfma_f32_16x16x32_bf16 v[140:143], a[236:239], a[12:15], v[140:143]
    s_waitcnt vmcnt(9)
    ds_read_b64_tr_b16 a[56:57], v1 offset:2048
    v_mfma_f32_16x16x32_bf16 v[168:171], a[232:235], a[16:19], v[168:171]
    ds_read_b64_tr_b16 a[58:59], v1 offset:3072
    v_cvt_pk_bf16_f32 v59, v62, v63
    v_mfma_f32_16x16x32_bf16 v[172:175], a[236:239], a[16:19], v[172:175]
    ds_read_b64_tr_b16 a[60:61], v2 offset:2048
    v_accvgpr_read_b32 v88, a120
    v_mfma_f32_16x16x32_bf16 v[200:203], a[232:235], a[20:23], v[200:203]
    ds_read_b64_tr_b16 a[62:63], v2 offset:3072
    v_accvgpr_read_b32 v89, a121
    v_mfma_f32_16x16x32_bf16 v[204:207], a[236:239], a[20:23], v[204:207]
    buffer_load_dwordx4 v6, s[24:27], s53 offen offset:1024 lds
    v_mfma_f32_16x16x32_bf16 v[232:235], a[232:235], a[24:27], v[232:235]
    s_add_u32 m0, s58, 2048
    s_add_u32 s53, s46, 294976
    v_accvgpr_read_b32 v90, a122
    v_mfma_f32_16x16x32_bf16 v[236:239], a[236:239], a[24:27], v[236:239]
    ds_write_b128 v15, v[56:59] offset:14336
    v_mfma_f32_16x16x32_bf16 v[48:51], a[240:243], a[0:3], v[48:51]
    s_add_u32 s52, s46, 295040
    v_accvgpr_read_b32 v91, a123
    v_accvgpr_read_b32 v92, a124
    v_mfma_f32_16x16x32_bf16 v[52:55], a[244:247], a[0:3], v[52:55]
    ds_read_b128 a[0:3], v13 offset:39936
    v_accvgpr_read_b32 v93, a125
    v_mfma_f32_16x16x32_bf16 v[80:83], a[240:243], a[4:7], v[80:83]
    s_waitcnt vmcnt(8)
    ds_read_b64_tr_b16 a[224:225], v1 offset:4096
    v_mfma_f32_16x16x32_bf16 v[84:87], a[244:247], a[4:7], v[84:87]
    s_waitcnt lgkmcnt(3)
    ds_read_b128 a[4:7], v13 offset:40960
    v_mfma_f32_16x16x32_bf16 v[112:115], a[240:243], a[8:11], v[112:115]
    ds_read_b64_tr_b16 a[226:227], v1 offset:5120
    v_accvgpr_read_b32 v94, a126
    v_mfma_f32_16x16x32_bf16 v[116:119], a[244:247], a[8:11], v[116:119]
    ds_read_b128 a[8:11], v13 offset:41984
    v_accvgpr_read_b32 v95, a127
    v_mfma_f32_16x16x32_bf16 v[144:147], a[240:243], a[12:15], v[144:147]
    ds_read_b64_tr_b16 a[228:229], v2 offset:4096
    v_mul_f32 v88, v88, v17
    v_mfma_f32_16x16x32_bf16 v[148:151], a[244:247], a[12:15], v[148:151]
    ds_read_b128 a[12:15], v13 offset:43008
    v_mul_f32 v89, v89, v17
    v_mfma_f32_16x16x32_bf16 v[176:179], a[240:243], a[16:19], v[176:179]
    ds_read_b64_tr_b16 a[230:231], v2 offset:5120
    v_mul_f32 v90, v90, v17
    v_mfma_f32_16x16x32_bf16 v[180:183], a[244:247], a[16:19], v[180:183]
    ds_read_b128 a[16:19], v13 offset:44032
    v_mul_f32 v91, v91, v17
    v_mfma_f32_16x16x32_bf16 v[208:211], a[240:243], a[20:23], v[208:211]
    buffer_load_dwordx4 v5, s[24:27], s53 offen offset:0 lds
    v_mfma_f32_16x16x32_bf16 v[212:215], a[244:247], a[20:23], v[212:215]
    ds_read_b128 a[20:23], v13 offset:45056
    v_mul_f32 v92, v92, v17
    v_mfma_f32_16x16x32_bf16 v[240:243], a[240:243], a[24:27], v[240:243]
    buffer_load_dwordx4 v6, s[24:27], s53 offen offset:1024 lds
    v_mfma_f32_16x16x32_bf16 v[244:247], a[244:247], a[24:27], v[244:247]
    s_waitcnt lgkmcnt(2)
    ds_read_b128 a[24:27], v13 offset:46080
    v_mfma_f32_16x16x32_bf16 v[32:35], a[224:227], a[0:3], v[32:35]
    s_waitcnt vmcnt(8)
    ds_read_b64_tr_b16 a[232:233], v1 offset:6144
    v_mfma_f32_16x16x32_bf16 v[36:39], a[228:231], a[0:3], v[36:39]
    s_add_u32 m0, s58, 4096
    ds_read_b64_tr_b16 a[234:235], v1 offset:7168
    v_mfma_f32_16x16x32_bf16 v[64:67], a[224:227], a[4:7], v[64:67]
    ds_read_b64_tr_b16 a[236:237], v2 offset:6144
    v_mul_f32 v93, v93, v17
    v_mfma_f32_16x16x32_bf16 v[68:71], a[228:231], a[4:7], v[68:71]
    ds_read_b64_tr_b16 a[238:239], v2 offset:7168
    v_mul_f32 v94, v94, v17
    v_mfma_f32_16x16x32_bf16 v[96:99], a[224:227], a[8:11], v[96:99]
    buffer_load_dwordx4 v5, s[24:27], s52 offen offset:0 lds
    v_mfma_f32_16x16x32_bf16 v[100:103], a[228:231], a[8:11], v[100:103]
    buffer_load_dwordx4 v6, s[24:27], s52 offen offset:1024 lds
    v_mfma_f32_16x16x32_bf16 v[128:131], a[224:227], a[12:15], v[128:131]
    s_add_u32 m0, s58, 6144
    s_add_u32 s53, s46, 295104
    v_mul_f32 v95, v95, v17
    v_mfma_f32_16x16x32_bf16 v[132:135], a[228:231], a[12:15], v[132:135]
    s_waitcnt lgkmcnt(6)
    v_cvt_pk_bf16_f32 v88, v88, v89
    v_cvt_pk_bf16_f32 v89, v90, v91
    v_mfma_f32_16x16x32_bf16 v[160:163], a[224:227], a[16:19], v[160:163]
    v_cvt_pk_bf16_f32 v90, v92, v93
    v_cvt_pk_bf16_f32 v91, v94, v95
    v_mfma_f32_16x16x32_bf16 v[164:167], a[228:231], a[16:19], v[164:167]
    s_waitcnt lgkmcnt(0)
    v_accvgpr_read_b32 v120, a128
    v_accvgpr_read_b32 v121, a129
    v_mfma_f32_16x16x32_bf16 v[192:195], a[224:227], a[20:23], v[192:195]
    buffer_load_dwordx4 v5, s[24:27], s53 offen offset:0 lds
    v_mfma_f32_16x16x32_bf16 v[196:199], a[228:231], a[20:23], v[196:199]
    s_waitcnt vmcnt(9)
    ds_read_b64_tr_b16 a[240:241], v3 offset:0
    v_mfma_f32_16x16x32_bf16 v[224:227], a[224:227], a[24:27], v[224:227]
    ds_read_b64_tr_b16 a[242:243], v3 offset:1024
    v_accvgpr_read_b32 v122, a130
    v_mfma_f32_16x16x32_bf16 v[228:231], a[228:231], a[24:27], v[228:231]
    ds_read_b64_tr_b16 a[244:245], v4 offset:0
    v_accvgpr_read_b32 v123, a131
    v_mfma_f32_16x16x32_bf16 v[40:43], a[232:235], a[0:3], v[40:43]
    ds_read_b64_tr_b16 a[246:247], v4 offset:1024
    v_accvgpr_read_b32 v124, a132
    v_mfma_f32_16x16x32_bf16 v[44:47], a[236:239], a[0:3], v[44:47]
    buffer_load_dwordx4 v6, s[24:27], s53 offen offset:1024 lds
    v_mfma_f32_16x16x32_bf16 v[72:75], a[232:235], a[4:7], v[72:75]
    s_add_u32 m0, s59, 0
    s_add_u32 s53, s46, 425984
    v_accvgpr_read_b32 v125, a133
    v_mfma_f32_16x16x32_bf16 v[76:79], a[236:239], a[4:7], v[76:79]
    ds_write_b128 v15, v[88:91] offset:15360
    v_mfma_f32_16x16x32_bf16 v[104:107], a[232:235], a[8:11], v[104:107]
    v_accvgpr_read_b32 v126, a134
    v_accvgpr_read_b32 v127, a135
    v_mfma_f32_16x16x32_bf16 v[108:111], a[236:239], a[8:11], v[108:111]
    s_waitcnt lgkmcnt(1)
    v_mul_f32 v120, v120, v18
    v_mul_f32 v121, v121, v18
    v_mfma_f32_16x16x32_bf16 v[136:139], a[232:235], a[12:15], v[136:139]
    buffer_load_dwordx4 v5, s[24:27], s53 offen offset:0 lds
    v_mfma_f32_16x16x32_bf16 v[140:143], a[236:239], a[12:15], v[140:143]
    s_waitcnt vmcnt(9)
    ds_read_b64_tr_b16 a[64:65], v3 offset:2048
    v_mfma_f32_16x16x32_bf16 v[168:171], a[232:235], a[16:19], v[168:171]
    ds_read_b64_tr_b16 a[66:67], v3 offset:3072
    v_mul_f32 v122, v122, v18
    v_mfma_f32_16x16x32_bf16 v[172:175], a[236:239], a[16:19], v[172:175]
    ds_read_b64_tr_b16 a[68:69], v4 offset:2048
    v_mul_f32 v123, v123, v18
    v_mfma_f32_16x16x32_bf16 v[200:203], a[232:235], a[20:23], v[200:203]
    ds_read_b64_tr_b16 a[70:71], v4 offset:3072
    v_mul_f32 v124, v124, v18
    v_mfma_f32_16x16x32_bf16 v[204:207], a[236:239], a[20:23], v[204:207]
    buffer_load_dwordx4 v6, s[24:27], s53 offen offset:1024 lds
    v_mfma_f32_16x16x32_bf16 v[232:235], a[232:235], a[24:27], v[232:235]
    s_add_u32 m0, s59, 2048
    s_add_u32 s53, s46, 426048
    v_mul_f32 v125, v125, v18
    v_mfma_f32_16x16x32_bf16 v[236:239], a[236:239], a[24:27], v[236:239]
    v_mul_f32 v126, v126, v18
    v_mul_f32 v127, v127, v18
    v_mfma_f32_16x16x32_bf16 v[48:51], a[240:243], a[0:3], v[48:51]
    s_add_u32 s52, s46, 426112
    v_cvt_pk_bf16_f32 v120, v120, v121
    v_cvt_pk_bf16_f32 v121, v122, v123
    v_mfma_f32_16x16x32_bf16 v[52:55], a[244:247], a[0:3], v[52:55]
    ds_read_b128 a[0:3], v14 offset:7168
    v_cvt_pk_bf16_f32 v122, v124, v125
    v_mfma_f32_16x16x32_bf16 v[80:83], a[240:243], a[4:7], v[80:83]
    s_waitcnt vmcnt(8)
    ds_read_b64_tr_b16 a[224:225], v1 offset:0
    v_mfma_f32_16x16x32_bf16 v[84:87], a[244:247], a[4:7], v[84:87]
    s_waitcnt lgkmcnt(2)
    ds_read_b128 a[4:7], v14 offset:8192
    v_mfma_f32_16x16x32_bf16 v[112:115], a[240:243], a[8:11], v[112:115]
    ds_read_b64_tr_b16 a[226:227], v1 offset:1024
    v_cvt_pk_bf16_f32 v123, v126, v127
    v_mfma_f32_16x16x32_bf16 v[116:119], a[244:247], a[8:11], v[116:119]
    ds_read_b128 a[8:11], v14 offset:9216
    v_accvgpr_read_b32 v152, a136
    v_mfma_f32_16x16x32_bf16 v[144:147], a[240:243], a[12:15], v[144:147]
    ds_read_b64_tr_b16 a[228:229], v2 offset:0
    v_accvgpr_read_b32 v153, a137
    v_mfma_f32_16x16x32_bf16 v[148:151], a[244:247], a[12:15], v[148:151]
    ds_read_b128 a[12:15], v14 offset:10240
    v_accvgpr_read_b32 v154, a138
    v_mfma_f32_16x16x32_bf16 v[176:179], a[240:243], a[16:19], v[176:179]
    ds_read_b64_tr_b16 a[230:231], v2 offset:1024
    v_accvgpr_read_b32 v155, a139
    v_mfma_f32_16x16x32_bf16 v[180:183], a[244:247], a[16:19], v[180:183]
    ds_read_b128 a[16:19], v14 offset:11264
    v_accvgpr_read_b32 v156, a140
    v_mfma_f32_16x16x32_bf16 v[208:211], a[240:243], a[20:23], v[208:211]
    buffer_load_dwordx4 v5, s[24:27], s53 offen offset:0 lds
    v_mfma_f32_16x16x32_bf16 v[212:215], a[244:247], a[20:23], v[212:215]
    ds_read_b128 a[20:23], v14 offset:12288
    v_accvgpr_read_b32 v157, a141
    v_mfma_f32_16x16x32_bf16 v[240:243], a[240:243], a[24:27], v[240:243]
    buffer_load_dwordx4 v6, s[24:27], s53 offen offset:1024 lds
    v_mfma_f32_16x16x32_bf16 v[244:247], a[244:247], a[24:27], v[244:247]
    s_waitcnt lgkmcnt(2)
    ds_read_b128 a[24:27], v14 offset:13312
    v_mfma_f32_16x16x32_bf16 v[32:35], a[224:227], a[0:3], v[32:35]
    s_waitcnt vmcnt(8)
    ds_read_b64_tr_b16 a[232:233], v1 offset:2048
    v_mfma_f32_16x16x32_bf16 v[36:39], a[228:231], a[0:3], v[36:39]
    s_add_u32 m0, s58, 0
    ds_read_b64_tr_b16 a[234:235], v1 offset:3072
    v_mfma_f32_16x16x32_bf16 v[64:67], a[224:227], a[4:7], v[64:67]
    ds_read_b64_tr_b16 a[236:237], v2 offset:2048
    v_accvgpr_read_b32 v158, a142
    v_mfma_f32_16x16x32_bf16 v[68:71], a[228:231], a[4:7], v[68:71]
    ds_read_b64_tr_b16 a[238:239], v2 offset:3072
    v_accvgpr_read_b32 v159, a143
    v_mfma_f32_16x16x32_bf16 v[96:99], a[224:227], a[8:11], v[96:99]
    buffer_load_dwordx4 v5, s[24:27], s52 offen offset:0 lds
    v_mfma_f32_16x16x32_bf16 v[100:103], a[228:231], a[8:11], v[100:103]
    buffer_load_dwordx4 v6, s[24:27], s52 offen offset:1024 lds
    v_mfma_f32_16x16x32_bf16 v[128:131], a[224:227], a[12:15], v[128:131]
    s_add_u32 m0, s58, 2048
    s_add_u32 s53, s46, 426176
    v_mul_f32 v152, v152, v19
    v_mfma_f32_16x16x32_bf16 v[132:135], a[228:231], a[12:15], v[132:135]
    s_waitcnt lgkmcnt(6)
    v_mul_f32 v153, v153, v19
    v_mul_f32 v154, v154, v19
    v_mfma_f32_16x16x32_bf16 v[160:163], a[224:227], a[16:19], v[160:163]
    ds_write_b128 v15, v[120:123] offset:16384
    v_mfma_f32_16x16x32_bf16 v[164:167], a[228:231], a[16:19], v[164:167]
    s_waitcnt lgkmcnt(1)
    v_mul_f32 v155, v155, v19
    v_mul_f32 v156, v156, v19
    v_mfma_f32_16x16x32_bf16 v[192:195], a[224:227], a[20:23], v[192:195]
    buffer_load_dwordx4 v5, s[24:27], s53 offen offset:0 lds
    v_mfma_f32_16x16x32_bf16 v[196:199], a[228:231], a[20:23], v[196:199]
    s_waitcnt vmcnt(9)
    ds_read_b64_tr_b16 a[240:241], v1 offset:4096
    v_mfma_f32_16x16x32_bf16 v[224:227], a[224:227], a[24:27], v[224:227]
    ds_read_b64_tr_b16 a[242:243], v1 offset:5120
    v_mul_f32 v157, v157, v19
    v_mfma_f32_16x16x32_bf16 v[228:231], a[228:231], a[24:27], v[228:231]
    ds_read_b64_tr_b16 a[244:245], v2 offset:4096
    v_mul_f32 v158, v158, v19
    v_mfma_f32_16x16x32_bf16 v[40:43], a[232:235], a[0:3], v[40:43]
    ds_read_b64_tr_b16 a[246:247], v2 offset:5120
    v_mul_f32 v159, v159, v19
    v_mfma_f32_16x16x32_bf16 v[44:47], a[236:239], a[0:3], v[44:47]
    buffer_load_dwordx4 v6, s[24:27], s53 offen offset:1024 lds
    v_mfma_f32_16x16x32_bf16 v[72:75], a[232:235], a[4:7], v[72:75]
    s_add_u32 m0, s58, 4096
    s_add_u32 s53, s46, 65536
    v_cvt_pk_bf16_f32 v152, v152, v153
    v_mfma_f32_16x16x32_bf16 v[76:79], a[236:239], a[4:7], v[76:79]
    v_cvt_pk_bf16_f32 v153, v154, v155
    v_cvt_pk_bf16_f32 v154, v156, v157
    v_mfma_f32_16x16x32_bf16 v[104:107], a[232:235], a[8:11], v[104:107]
    v_cvt_pk_bf16_f32 v155, v158, v159
    v_accvgpr_read_b32 v184, a144
    v_mfma_f32_16x16x32_bf16 v[108:111], a[236:239], a[8:11], v[108:111]
    s_waitcnt lgkmcnt(0)
    v_accvgpr_read_b32 v185, a145
    v_accvgpr_read_b32 v186, a146
    v_mfma_f32_16x16x32_bf16 v[136:139], a[232:235], a[12:15], v[136:139]
    buffer_load_dwordx4 v5, s[24:27], s53 offen offset:0 lds
    v_mfma_f32_16x16x32_bf16 v[140:143], a[236:239], a[12:15], v[140:143]
    s_waitcnt vmcnt(9)
    ds_read_b64_tr_b16 a[72:73], v1 offset:6144
    v_mfma_f32_16x16x32_bf16 v[168:171], a[232:235], a[16:19], v[168:171]
    ds_read_b64_tr_b16 a[74:75], v1 offset:7168
    v_accvgpr_read_b32 v187, a147
    v_mfma_f32_16x16x32_bf16 v[172:175], a[236:239], a[16:19], v[172:175]
    ds_read_b64_tr_b16 a[76:77], v2 offset:6144
    v_accvgpr_read_b32 v188, a148
    v_mfma_f32_16x16x32_bf16 v[200:203], a[232:235], a[20:23], v[200:203]
    ds_read_b64_tr_b16 a[78:79], v2 offset:7168
    v_accvgpr_read_b32 v189, a149
    v_mfma_f32_16x16x32_bf16 v[204:207], a[236:239], a[20:23], v[204:207]
    buffer_load_dwordx4 v6, s[24:27], s53 offen offset:1024 lds
    v_mfma_f32_16x16x32_bf16 v[232:235], a[232:235], a[24:27], v[232:235]
    s_add_u32 m0, s58, 6144
    s_add_u32 s53, s46, 65600
    v_accvgpr_read_b32 v190, a150
    v_mfma_f32_16x16x32_bf16 v[236:239], a[236:239], a[24:27], v[236:239]
    ds_write_b128 v15, v[152:155] offset:17408
    v_mfma_f32_16x16x32_bf16 v[48:51], a[240:243], a[0:3], v[48:51]
    s_add_u32 s52, s46, 65664
    v_accvgpr_read_b32 v191, a151
    v_mul_f32 v184, v184, v20
    v_mfma_f32_16x16x32_bf16 v[52:55], a[244:247], a[0:3], v[52:55]
    ds_read_b128 a[0:3], v14 offset:39936
    v_mul_f32 v185, v185, v20
    v_mfma_f32_16x16x32_bf16 v[80:83], a[240:243], a[4:7], v[80:83]
    s_waitcnt vmcnt(8)
    ds_read_b64_tr_b16 a[224:225], v3 offset:0
    v_mfma_f32_16x16x32_bf16 v[84:87], a[244:247], a[4:7], v[84:87]
    s_waitcnt lgkmcnt(3)
    ds_read_b128 a[4:7], v14 offset:40960
    v_mfma_f32_16x16x32_bf16 v[112:115], a[240:243], a[8:11], v[112:115]
    ds_read_b64_tr_b16 a[226:227], v3 offset:1024
    v_mul_f32 v186, v186, v20
    v_mfma_f32_16x16x32_bf16 v[116:119], a[244:247], a[8:11], v[116:119]
    ds_read_b128 a[8:11], v14 offset:41984
    v_mul_f32 v187, v187, v20
    v_mfma_f32_16x16x32_bf16 v[144:147], a[240:243], a[12:15], v[144:147]
    ds_read_b64_tr_b16 a[228:229], v4 offset:0
    v_mul_f32 v188, v188, v20
    v_mfma_f32_16x16x32_bf16 v[148:151], a[244:247], a[12:15], v[148:151]
    ds_read_b128 a[12:15], v14 offset:43008
    v_mul_f32 v189, v189, v20
    v_mfma_f32_16x16x32_bf16 v[176:179], a[240:243], a[16:19], v[176:179]
    ds_read_b64_tr_b16 a[230:231], v4 offset:1024
    v_mul_f32 v190, v190, v20
    v_mfma_f32_16x16x32_bf16 v[180:183], a[244:247], a[16:19], v[180:183]
    ds_read_b128 a[16:19], v14 offset:44032
    v_mul_f32 v191, v191, v20
    v_mfma_f32_16x16x32_bf16 v[208:211], a[240:243], a[20:23], v[208:211]
    buffer_load_dwordx4 v5, s[24:27], s53 offen offset:0 lds
    v_mfma_f32_16x16x32_bf16 v[212:215], a[244:247], a[20:23], v[212:215]
    ds_read_b128 a[20:23], v14 offset:45056
    v_cvt_pk_bf16_f32 v184, v184, v185
    v_mfma_f32_16x16x32_bf16 v[240:243], a[240:243], a[24:27], v[240:243]
    buffer_load_dwordx4 v6, s[24:27], s53 offen offset:1024 lds
    v_mfma_f32_16x16x32_bf16 v[244:247], a[244:247], a[24:27], v[244:247]
    s_waitcnt lgkmcnt(2)
    ds_read_b128 a[24:27], v14 offset:46080
    v_mfma_f32_16x16x32_bf16 v[32:35], a[224:227], a[0:3], v[32:35]
    s_waitcnt vmcnt(8)
    ds_read_b64_tr_b16 a[232:233], v3 offset:2048
    v_mfma_f32_16x16x32_bf16 v[36:39], a[228:231], a[0:3], v[36:39]
    s_add_u32 m0, s59, 0
    ds_read_b64_tr_b16 a[234:235], v3 offset:3072
    v_mfma_f32_16x16x32_bf16 v[64:67], a[224:227], a[4:7], v[64:67]
    ds_read_b64_tr_b16 a[236:237], v4 offset:2048
    v_cvt_pk_bf16_f32 v185, v186, v187
    v_mfma_f32_16x16x32_bf16 v[68:71], a[228:231], a[4:7], v[68:71]
    ds_read_b64_tr_b16 a[238:239], v4 offset:3072
    v_cvt_pk_bf16_f32 v186, v188, v189
    v_mfma_f32_16x16x32_bf16 v[96:99], a[224:227], a[8:11], v[96:99]
    buffer_load_dwordx4 v5, s[24:27], s52 offen offset:0 lds
    v_mfma_f32_16x16x32_bf16 v[100:103], a[228:231], a[8:11], v[100:103]
    buffer_load_dwordx4 v6, s[24:27], s52 offen offset:1024 lds
    v_mfma_f32_16x16x32_bf16 v[128:131], a[224:227], a[12:15], v[128:131]
    s_add_u32 m0, s59, 2048
    s_add_u32 s53, s46, 65728
    v_cvt_pk_bf16_f32 v187, v190, v191
    v_mfma_f32_16x16x32_bf16 v[132:135], a[228:231], a[12:15], v[132:135]
    s_waitcnt lgkmcnt(6)
    v_accvgpr_read_b32 v216, a152
    v_accvgpr_read_b32 v217, a153
    v_mfma_f32_16x16x32_bf16 v[160:163], a[224:227], a[16:19], v[160:163]
    ds_write_b128 v15, v[184:187] offset:18432
    v_mfma_f32_16x16x32_bf16 v[164:167], a[228:231], a[16:19], v[164:167]
    s_waitcnt lgkmcnt(1)
    v_accvgpr_read_b32 v218, a154
    v_accvgpr_read_b32 v219, a155
    v_mfma_f32_16x16x32_bf16 v[192:195], a[224:227], a[20:23], v[192:195]
    buffer_load_dwordx4 v5, s[24:27], s53 offen offset:0 lds
    v_mfma_f32_16x16x32_bf16 v[196:199], a[228:231], a[20:23], v[196:199]
    s_waitcnt vmcnt(9)
    ds_read_b64_tr_b16 a[240:241], v1 offset:0
    v_mfma_f32_16x16x32_bf16 v[224:227], a[224:227], a[24:27], v[224:227]
    ds_read_b64_tr_b16 a[242:243], v1 offset:1024
    v_accvgpr_read_b32 v220, a156
    v_mfma_f32_16x16x32_bf16 v[228:231], a[228:231], a[24:27], v[228:231]
    ds_read_b64_tr_b16 a[244:245], v2 offset:0
    v_accvgpr_read_b32 v221, a157
    v_mfma_f32_16x16x32_bf16 v[40:43], a[232:235], a[0:3], v[40:43]
    ds_read_b64_tr_b16 a[246:247], v2 offset:1024
    v_accvgpr_read_b32 v222, a158
    v_mfma_f32_16x16x32_bf16 v[44:47], a[236:239], a[0:3], v[44:47]
    buffer_load_dwordx4 v6, s[24:27], s53 offen offset:1024 lds
    v_mfma_f32_16x16x32_bf16 v[72:75], a[232:235], a[4:7], v[72:75]
    s_add_u32 m0, s58, 0
    s_add_u32 s53, s46, 196608
    v_accvgpr_read_b32 v223, a159
    v_mfma_f32_16x16x32_bf16 v[76:79], a[236:239], a[4:7], v[76:79]
    v_mul_f32 v216, v216, v21
    v_mul_f32 v217, v217, v21
    v_mfma_f32_16x16x32_bf16 v[104:107], a[232:235], a[8:11], v[104:107]
    v_mul_f32 v218, v218, v21
    v_mul_f32 v219, v219, v21
    v_mfma_f32_16x16x32_bf16 v[108:111], a[236:239], a[8:11], v[108:111]
    s_waitcnt lgkmcnt(0)
    v_mul_f32 v220, v220, v21
    v_mul_f32 v221, v221, v21
    v_mfma_f32_16x16x32_bf16 v[136:139], a[232:235], a[12:15], v[136:139]
    buffer_load_dwordx4 v5, s[24:27], s53 offen offset:0 lds
    v_mfma_f32_16x16x32_bf16 v[140:143], a[236:239], a[12:15], v[140:143]
    s_waitcnt vmcnt(9)
    ds_read_b64_tr_b16 a[80:81], v1 offset:2048
    v_mfma_f32_16x16x32_bf16 v[168:171], a[232:235], a[16:19], v[168:171]
    ds_read_b64_tr_b16 a[82:83], v1 offset:3072
    v_mul_f32 v222, v222, v21
    v_mfma_f32_16x16x32_bf16 v[172:175], a[236:239], a[16:19], v[172:175]
    ds_read_b64_tr_b16 a[84:85], v2 offset:2048
    v_mul_f32 v223, v223, v21
    v_mfma_f32_16x16x32_bf16 v[200:203], a[232:235], a[20:23], v[200:203]
    ds_read_b64_tr_b16 a[86:87], v2 offset:3072
    v_cvt_pk_bf16_f32 v216, v216, v217
    v_mfma_f32_16x16x32_bf16 v[204:207], a[236:239], a[20:23], v[204:207]
    buffer_load_dwordx4 v6, s[24:27], s53 offen offset:1024 lds
    v_mfma_f32_16x16x32_bf16 v[232:235], a[232:235], a[24:27], v[232:235]
    s_add_u32 m0, s58, 2048
    s_add_u32 s53, s46, 196672
    v_cvt_pk_bf16_f32 v217, v218, v219
    v_mfma_f32_16x16x32_bf16 v[236:239], a[236:239], a[24:27], v[236:239]
    v_cvt_pk_bf16_f32 v218, v220, v221
    v_cvt_pk_bf16_f32 v219, v222, v223
    ds_write_b128 v15, v[216:219] offset:19456
    v_accvgpr_read_b32 v248, a160
    v_accvgpr_read_b32 v249, a161
    v_accvgpr_read_b32 v250, a162
    v_accvgpr_read_b32 v251, a163
    v_accvgpr_read_b32 v252, a164
    v_accvgpr_read_b32 v253, a165
    v_accvgpr_read_b32 v254, a166
    v_accvgpr_read_b32 v255, a167
    v_mul_f32 v248, v248, v22
    v_mul_f32 v249, v249, v22
    v_mul_f32 v250, v250, v22
    v_mul_f32 v251, v251, v22
    v_mul_f32 v252, v252, v22
    v_mul_f32 v253, v253, v22
    v_mul_f32 v254, v254, v22
    v_mul_f32 v255, v255, v22
    v_cvt_pk_bf16_f32 v248, v248, v249
    v_cvt_pk_bf16_f32 v249, v250, v251
    v_cvt_pk_bf16_f32 v250, v252, v253
    v_cvt_pk_bf16_f32 v251, v254, v255
    ds_write_b128 v15, v[248:251] offset:20480
    s_waitcnt lgkmcnt(0)
    s_barrier
    v_mfma_f32_16x16x32_bf16 v[48:51], a[240:243], a[0:3], v[48:51]
    s_add_u32 s52, s46, 196736
    v_mfma_f32_16x16x32_bf16 v[52:55], a[244:247], a[0:3], v[52:55]
    ds_read_b128 a[0:3], v13 offset:14336
    v_mfma_f32_16x16x32_bf16 v[80:83], a[240:243], a[4:7], v[80:83]
    s_waitcnt vmcnt(8)
    ds_read_b64_tr_b16 a[224:225], v1 offset:4096
    v_mfma_f32_16x16x32_bf16 v[84:87], a[244:247], a[4:7], v[84:87]
    s_waitcnt lgkmcnt(4)
    ds_read_b128 a[4:7], v13 offset:15360
    v_mfma_f32_16x16x32_bf16 v[112:115], a[240:243], a[8:11], v[112:115]
    ds_read_b64_tr_b16 a[226:227], v1 offset:5120
    v_mfma_f32_16x16x32_bf16 v[116:119], a[244:247], a[8:11], v[116:119]
    ds_read_b128 a[8:11], v13 offset:16384
    v_mfma_f32_16x16x32_bf16 v[144:147], a[240:243], a[12:15], v[144:147]
    ds_read_b64_tr_b16 a[228:229], v2 offset:4096
    v_mfma_f32_16x16x32_bf16 v[148:151], a[244:247], a[12:15], v[148:151]
    ds_read_b128 a[12:15], v13 offset:17408
    v_mfma_f32_16x16x32_bf16 v[176:179], a[240:243], a[16:19], v[176:179]
    ds_read_b64_tr_b16 a[230:231], v2 offset:5120
    v_mfma_f32_16x16x32_bf16 v[180:183], a[244:247], a[16:19], v[180:183]
    ds_read_b128 a[16:19], v13 offset:18432
    v_mfma_f32_16x16x32_bf16 v[208:211], a[240:243], a[20:23], v[208:211]
    buffer_load_dwordx4 v5, s[24:27], s53 offen offset:0 lds
    v_mfma_f32_16x16x32_bf16 v[212:215], a[244:247], a[20:23], v[212:215]
    ds_read_b128 a[20:23], v13 offset:19456
    v_mfma_f32_16x16x32_bf16 v[240:243], a[240:243], a[24:27], v[240:243]
    buffer_load_dwordx4 v6, s[24:27], s53 offen offset:1024 lds
    v_mfma_f32_16x16x32_bf16 v[244:247], a[244:247], a[24:27], v[244:247]
    s_waitcnt lgkmcnt(2)
    ds_read_b128 a[24:27], v13 offset:20480
    v_mfma_f32_16x16x32_bf16 v[32:35], a[224:227], a[0:3], v[32:35]
    s_waitcnt vmcnt(8)
    ds_read_b64_tr_b16 a[232:233], v1 offset:6144
    v_mfma_f32_16x16x32_bf16 v[36:39], a[228:231], a[0:3], v[36:39]
    s_add_u32 m0, s58, 4096
    ds_read_b64_tr_b16 a[234:235], v1 offset:7168
    v_mfma_f32_16x16x32_bf16 v[64:67], a[224:227], a[4:7], v[64:67]
    ds_read_b64_tr_b16 a[236:237], v2 offset:6144
    v_accvgpr_read_b32 v56, a168
    v_mfma_f32_16x16x32_bf16 v[68:71], a[228:231], a[4:7], v[68:71]
    ds_read_b64_tr_b16 a[238:239], v2 offset:7168
    v_accvgpr_read_b32 v57, a169
    v_mfma_f32_16x16x32_bf16 v[96:99], a[224:227], a[8:11], v[96:99]
    buffer_load_dwordx4 v5, s[24:27], s52 offen offset:0 lds
    v_mfma_f32_16x16x32_bf16 v[100:103], a[228:231], a[8:11], v[100:103]
    buffer_load_dwordx4 v6, s[24:27], s52 offen offset:1024 lds
    v_mfma_f32_16x16x32_bf16 v[128:131], a[224:227], a[12:15], v[128:131]
    s_add_u32 m0, s58, 6144
    s_add_u32 s53, s46, 196800
    v_accvgpr_read_b32 v58, a170
    v_mfma_f32_16x16x32_bf16 v[132:135], a[228:231], a[12:15], v[132:135]
    s_waitcnt lgkmcnt(6)
    v_accvgpr_read_b32 v59, a171
    v_accvgpr_read_b32 v60, a172
    v_mfma_f32_16x16x32_bf16 v[160:163], a[224:227], a[16:19], v[160:163]
    v_accvgpr_read_b32 v61, a173
    v_accvgpr_read_b32 v62, a174
    v_mfma_f32_16x16x32_bf16 v[164:167], a[228:231], a[16:19], v[164:167]
    s_waitcnt lgkmcnt(0)
    v_accvgpr_read_b32 v63, a175
    v_mul_f32 v56, v56, v16
    v_mfma_f32_16x16x32_bf16 v[192:195], a[224:227], a[20:23], v[192:195]
    buffer_load_dwordx4 v5, s[24:27], s53 offen offset:0 lds
    v_mfma_f32_16x16x32_bf16 v[196:199], a[228:231], a[20:23], v[196:199]
    s_waitcnt vmcnt(9)
    ds_read_b64_tr_b16 a[240:241], v3 offset:0
    v_mfma_f32_16x16x32_bf16 v[224:227], a[224:227], a[24:27], v[224:227]
    ds_read_b64_tr_b16 a[242:243], v3 offset:1024
    v_mul_f32 v57, v57, v16
    v_mfma_f32_16x16x32_bf16 v[228:231], a[228:231], a[24:27], v[228:231]
    ds_read_b64_tr_b16 a[244:245], v4 offset:0
    v_mul_f32 v58, v58, v16
    v_mfma_f32_16x16x32_bf16 v[40:43], a[232:235], a[0:3], v[40:43]
    ds_read_b64_tr_b16 a[246:247], v4 offset:1024
    v_mul_f32 v59, v59, v16
    v_mfma_f32_16x16x32_bf16 v[44:47], a[236:239], a[0:3], v[44:47]
    buffer_load_dwordx4 v6, s[24:27], s53 offen offset:1024 lds
    v_mfma_f32_16x16x32_bf16 v[72:75], a[232:235], a[4:7], v[72:75]
    s_add_u32 m0, s59, 0
    s_add_u32 s53, s46, 327680
    v_mul_f32 v60, v60, v16
    v_mfma_f32_16x16x32_bf16 v[76:79], a[236:239], a[4:7], v[76:79]
    v_mul_f32 v61, v61, v16
    v_mul_f32 v62, v62, v16
    v_mfma_f32_16x16x32_bf16 v[104:107], a[232:235], a[8:11], v[104:107]
    v_mul_f32 v63, v63, v16
    v_cvt_pk_bf16_f32 v56, v56, v57
    v_mfma_f32_16x16x32_bf16 v[108:111], a[236:239], a[8:11], v[108:111]
    s_waitcnt lgkmcnt(0)
    v_cvt_pk_bf16_f32 v57, v58, v59
    v_cvt_pk_bf16_f32 v58, v60, v61
    v_mfma_f32_16x16x32_bf16 v[136:139], a[232:235], a[12:15], v[136:139]
    buffer_load_dwordx4 v5, s[24:27], s53 offen offset:0 lds
    v_mfma_f32_16x16x32_bf16 v[140:143], a[236:239], a[12:15], v[140:143]
    s_waitcnt vmcnt(9)
    ds_read_b64_tr_b16 a[88:89], v3 offset:2048
    v_mfma_f32_16x16x32_bf16 v[168:171], a[232:235], a[16:19], v[168:171]
    ds_read_b64_tr_b16 a[90:91], v3 offset:3072
    v_cvt_pk_bf16_f32 v59, v62, v63
    v_mfma_f32_16x16x32_bf16 v[172:175], a[236:239], a[16:19], v[172:175]
    ds_read_b64_tr_b16 a[92:93], v4 offset:2048
    v_accvgpr_read_b32 v88, a176
    v_mfma_f32_16x16x32_bf16 v[200:203], a[232:235], a[20:23], v[200:203]
    ds_read_b64_tr_b16 a[94:95], v4 offset:3072
    v_accvgpr_read_b32 v89, a177
    v_mfma_f32_16x16x32_bf16 v[204:207], a[236:239], a[20:23], v[204:207]
    buffer_load_dwordx4 v6, s[24:27], s53 offen offset:1024 lds
    v_mfma_f32_16x16x32_bf16 v[232:235], a[232:235], a[24:27], v[232:235]
    s_add_u32 m0, s59, 2048
    s_add_u32 s53, s46, 327744
    v_accvgpr_read_b32 v90, a178
    v_mfma_f32_16x16x32_bf16 v[236:239], a[236:239], a[24:27], v[236:239]
    ds_write_b128 v15, v[56:59] offset:21504
    v_mfma_f32_16x16x32_bf16 v[48:51], a[240:243], a[0:3], v[48:51]
    s_add_u32 s52, s46, 327808
    v_accvgpr_read_b32 v91, a179
    v_accvgpr_read_b32 v92, a180
    v_mfma_f32_16x16x32_bf16 v[52:55], a[244:247], a[0:3], v[52:55]
    ds_read_b128 a[0:3], v13 offset:47104
    v_accvgpr_read_b32 v93, a181
    v_mfma_f32_16x16x32_bf16 v[80:83], a[240:243], a[4:7], v[80:83]
    s_waitcnt vmcnt(8)
    ds_read_b64_tr_b16 a[224:225], v1 offset:0
    v_mfma_f32_16x16x32_bf16 v[84:87], a[244:247], a[4:7], v[84:87]
    s_waitcnt lgkmcnt(3)
    ds_read_b128 a[4:7], v13 offset:48128
    v_mfma_f32_16x16x32_bf16 v[112:115], a[240:243], a[8:11], v[112:115]
    ds_read_b64_tr_b16 a[226:227], v1 offset:1024
    v_accvgpr_read_b32 v94, a182
    v_mfma_f32_16x16x32_bf16 v[116:119], a[244:247], a[8:11], v[116:119]
    ds_read_b128 a[8:11], v13 offset:49152
    v_accvgpr_read_b32 v95, a183
    v_mfma_f32_16x16x32_bf16 v[144:147], a[240:243], a[12:15], v[144:147]
    ds_read_b64_tr_b16 a[228:229], v2 offset:0
    v_mul_f32 v88, v88, v17
    v_mfma_f32_16x16x32_bf16 v[148:151], a[244:247], a[12:15], v[148:151]
    ds_read_b128 a[12:15], v13 offset:50176
    v_mul_f32 v89, v89, v17
    v_mfma_f32_16x16x32_bf16 v[176:179], a[240:243], a[16:19], v[176:179]
    ds_read_b64_tr_b16 a[230:231], v2 offset:1024
    v_mul_f32 v90, v90, v17
    v_mfma_f32_16x16x32_bf16 v[180:183], a[244:247], a[16:19], v[180:183]
    ds_read_b128 a[16:19], v13 offset:51200
    v_mul_f32 v91, v91, v17
    v_mfma_f32_16x16x32_bf16 v[208:211], a[240:243], a[20:23], v[208:211]
    buffer_load_dwordx4 v5, s[24:27], s53 offen offset:0 lds
    v_mfma_f32_16x16x32_bf16 v[212:215], a[244:247], a[20:23], v[212:215]
    ds_read_b128 a[20:23], v13 offset:52224
    v_mul_f32 v92, v92, v17
    v_mfma_f32_16x16x32_bf16 v[240:243], a[240:243], a[24:27], v[240:243]
    buffer_load_dwordx4 v6, s[24:27], s53 offen offset:1024 lds
    v_mfma_f32_16x16x32_bf16 v[244:247], a[244:247], a[24:27], v[244:247]
    s_waitcnt lgkmcnt(2)
    ds_read_b128 a[24:27], v13 offset:53248
    v_mfma_f32_16x16x32_bf16 v[32:35], a[224:227], a[0:3], v[32:35]
    s_waitcnt vmcnt(8)
    ds_read_b64_tr_b16 a[232:233], v1 offset:2048
    v_mfma_f32_16x16x32_bf16 v[36:39], a[228:231], a[0:3], v[36:39]
    s_add_u32 m0, s58, 0
    ds_read_b64_tr_b16 a[234:235], v1 offset:3072
    v_mfma_f32_16x16x32_bf16 v[64:67], a[224:227], a[4:7], v[64:67]
    ds_read_b64_tr_b16 a[236:237], v2 offset:2048
    v_mul_f32 v93, v93, v17
    v_mfma_f32_16x16x32_bf16 v[68:71], a[228:231], a[4:7], v[68:71]
    ds_read_b64_tr_b16 a[238:239], v2 offset:3072
    v_mul_f32 v94, v94, v17
    v_mfma_f32_16x16x32_bf16 v[96:99], a[224:227], a[8:11], v[96:99]
    buffer_load_dwordx4 v5, s[24:27], s52 offen offset:0 lds
    v_mfma_f32_16x16x32_bf16 v[100:103], a[228:231], a[8:11], v[100:103]
    buffer_load_dwordx4 v6, s[24:27], s52 offen offset:1024 lds
    v_mfma_f32_16x16x32_bf16 v[128:131], a[224:227], a[12:15], v[128:131]
    s_add_u32 m0, s58, 2048
    s_add_u32 s53, s46, 327872
    v_mul_f32 v95, v95, v17
    v_mfma_f32_16x16x32_bf16 v[132:135], a[228:231], a[12:15], v[132:135]
    s_waitcnt lgkmcnt(6)
    v_cvt_pk_bf16_f32 v88, v88, v89
    v_cvt_pk_bf16_f32 v89, v90, v91
    v_mfma_f32_16x16x32_bf16 v[160:163], a[224:227], a[16:19], v[160:163]
    v_cvt_pk_bf16_f32 v90, v92, v93
    v_cvt_pk_bf16_f32 v91, v94, v95
    v_mfma_f32_16x16x32_bf16 v[164:167], a[228:231], a[16:19], v[164:167]
    s_waitcnt lgkmcnt(0)
    v_accvgpr_read_b32 v120, a184
    v_accvgpr_read_b32 v121, a185
    v_mfma_f32_16x16x32_bf16 v[192:195], a[224:227], a[20:23], v[192:195]
    buffer_load_dwordx4 v5, s[24:27], s53 offen offset:0 lds
    v_mfma_f32_16x16x32_bf16 v[196:199], a[228:231], a[20:23], v[196:199]
    s_waitcnt vmcnt(9)
    ds_read_b64_tr_b16 a[240:241], v1 offset:4096
    v_mfma_f32_16x16x32_bf16 v[224:227], a[224:227], a[24:27], v[224:227]
    ds_read_b64_tr_b16 a[242:243], v1 offset:5120
    v_accvgpr_read_b32 v122, a186
    v_mfma_f32_16x16x32_bf16 v[228:231], a[228:231], a[24:27], v[228:231]
    ds_read_b64_tr_b16 a[244:245], v2 offset:4096
    v_accvgpr_read_b32 v123, a187
    v_mfma_f32_16x16x32_bf16 v[40:43], a[232:235], a[0:3], v[40:43]
    ds_read_b64_tr_b16 a[246:247], v2 offset:5120
    v_accvgpr_read_b32 v124, a188
    v_mfma_f32_16x16x32_bf16 v[44:47], a[236:239], a[0:3], v[44:47]
    buffer_load_dwordx4 v6, s[24:27], s53 offen offset:1024 lds
    v_mfma_f32_16x16x32_bf16 v[72:75], a[232:235], a[4:7], v[72:75]
    s_add_u32 m0, s58, 4096
    s_add_u32 s53, s46, 458752
    v_accvgpr_read_b32 v125, a189
    v_mfma_f32_16x16x32_bf16 v[76:79], a[236:239], a[4:7], v[76:79]
    ds_write_b128 v15, v[88:91] offset:22528
    v_mfma_f32_16x16x32_bf16 v[104:107], a[232:235], a[8:11], v[104:107]
    v_accvgpr_read_b32 v126, a190
    v_accvgpr_read_b32 v127, a191
    v_mfma_f32_16x16x32_bf16 v[108:111], a[236:239], a[8:11], v[108:111]
    s_waitcnt lgkmcnt(1)
    v_mul_f32 v120, v120, v18
    v_mul_f32 v121, v121, v18
    v_mfma_f32_16x16x32_bf16 v[136:139], a[232:235], a[12:15], v[136:139]
    buffer_load_dwordx4 v5, s[24:27], s53 offen offset:0 lds
    v_mfma_f32_16x16x32_bf16 v[140:143], a[236:239], a[12:15], v[140:143]
    s_waitcnt vmcnt(9)
    ds_read_b64_tr_b16 a[96:97], v1 offset:6144
    v_mfma_f32_16x16x32_bf16 v[168:171], a[232:235], a[16:19], v[168:171]
    ds_read_b64_tr_b16 a[98:99], v1 offset:7168
    v_mul_f32 v122, v122, v18
    v_mfma_f32_16x16x32_bf16 v[172:175], a[236:239], a[16:19], v[172:175]
    ds_read_b64_tr_b16 a[100:101], v2 offset:6144
    v_mul_f32 v123, v123, v18
    v_mfma_f32_16x16x32_bf16 v[200:203], a[232:235], a[20:23], v[200:203]
    ds_read_b64_tr_b16 a[102:103], v2 offset:7168
    v_mul_f32 v124, v124, v18
    v_mfma_f32_16x16x32_bf16 v[204:207], a[236:239], a[20:23], v[204:207]
    buffer_load_dwordx4 v6, s[24:27], s53 offen offset:1024 lds
    v_mfma_f32_16x16x32_bf16 v[232:235], a[232:235], a[24:27], v[232:235]
    s_add_u32 m0, s58, 6144
    s_add_u32 s53, s46, 458816
    v_mul_f32 v125, v125, v18
    v_mfma_f32_16x16x32_bf16 v[236:239], a[236:239], a[24:27], v[236:239]
    v_mul_f32 v126, v126, v18
    v_mul_f32 v127, v127, v18
    v_mfma_f32_16x16x32_bf16 v[48:51], a[240:243], a[0:3], v[48:51]
    s_add_u32 s52, s46, 458880
    v_cvt_pk_bf16_f32 v120, v120, v121
    v_cvt_pk_bf16_f32 v121, v122, v123
    v_mfma_f32_16x16x32_bf16 v[52:55], a[244:247], a[0:3], v[52:55]
    ds_read_b128 a[0:3], v14 offset:14336
    v_cvt_pk_bf16_f32 v122, v124, v125
    v_mfma_f32_16x16x32_bf16 v[80:83], a[240:243], a[4:7], v[80:83]
    s_waitcnt vmcnt(8)
    ds_read_b64_tr_b16 a[224:225], v3 offset:0
    v_mfma_f32_16x16x32_bf16 v[84:87], a[244:247], a[4:7], v[84:87]
    s_waitcnt lgkmcnt(2)
    ds_read_b128 a[4:7], v14 offset:15360
    v_mfma_f32_16x16x32_bf16 v[112:115], a[240:243], a[8:11], v[112:115]
    ds_read_b64_tr_b16 a[226:227], v3 offset:1024
    v_cvt_pk_bf16_f32 v123, v126, v127
    v_mfma_f32_16x16x32_bf16 v[116:119], a[244:247], a[8:11], v[116:119]
    ds_read_b128 a[8:11], v14 offset:16384
    v_accvgpr_read_b32 v152, a192
    v_mfma_f32_16x16x32_bf16 v[144:147], a[240:243], a[12:15], v[144:147]
    ds_read_b64_tr_b16 a[228:229], v4 offset:0
    v_accvgpr_read_b32 v153, a193
    v_mfma_f32_16x16x32_bf16 v[148:151], a[244:247], a[12:15], v[148:151]
    ds_read_b128 a[12:15], v14 offset:17408
    v_accvgpr_read_b32 v154, a194
    v_mfma_f32_16x16x32_bf16 v[176:179], a[240:243], a[16:19], v[176:179]
    ds_read_b64_tr_b16 a[230:231], v4 offset:1024
    v_accvgpr_read_b32 v155, a195
    v_mfma_f32_16x16x32_bf16 v[180:183], a[244:247], a[16:19], v[180:183]
    ds_read_b128 a[16:19], v14 offset:18432
    v_accvgpr_read_b32 v156, a196
    v_mfma_f32_16x16x32_bf16 v[208:211], a[240:243], a[20:23], v[208:211]
    buffer_load_dwordx4 v5, s[24:27], s53 offen offset:0 lds
    v_mfma_f32_16x16x32_bf16 v[212:215], a[244:247], a[20:23], v[212:215]
    ds_read_b128 a[20:23], v14 offset:19456
    v_accvgpr_read_b32 v157, a197
    v_mfma_f32_16x16x32_bf16 v[240:243], a[240:243], a[24:27], v[240:243]
    buffer_load_dwordx4 v6, s[24:27], s53 offen offset:1024 lds
    v_mfma_f32_16x16x32_bf16 v[244:247], a[244:247], a[24:27], v[244:247]
    s_waitcnt lgkmcnt(2)
    ds_read_b128 a[24:27], v14 offset:20480
    v_mfma_f32_16x16x32_bf16 v[32:35], a[224:227], a[0:3], v[32:35]
    s_waitcnt vmcnt(8)
    ds_read_b64_tr_b16 a[232:233], v3 offset:2048
    v_mfma_f32_16x16x32_bf16 v[36:39], a[228:231], a[0:3], v[36:39]
    s_add_u32 m0, s59, 0
    ds_read_b64_tr_b16 a[234:235], v3 offset:3072
    v_mfma_f32_16x16x32_bf16 v[64:67], a[224:227], a[4:7], v[64:67]
    ds_read_b64_tr_b16 a[236:237], v4 offset:2048
    v_accvgpr_read_b32 v158, a198
    v_mfma_f32_16x16x32_bf16 v[68:71], a[228:231], a[4:7], v[68:71]
    ds_read_b64_tr_b16 a[238:239], v4 offset:3072
    v_accvgpr_read_b32 v159, a199
    v_mfma_f32_16x16x32_bf16 v[96:99], a[224:227], a[8:11], v[96:99]
    buffer_load_dwordx4 v5, s[24:27], s52 offen offset:0 lds
    v_mfma_f32_16x16x32_bf16 v[100:103], a[228:231], a[8:11], v[100:103]
    buffer_load_dwordx4 v6, s[24:27], s52 offen offset:1024 lds
    v_mfma_f32_16x16x32_bf16 v[128:131], a[224:227], a[12:15], v[128:131]
    s_add_u32 m0, s59, 2048
    s_add_u32 s53, s46, 458944
    v_mul_f32 v152, v152, v19
    v_mfma_f32_16x16x32_bf16 v[132:135], a[228:231], a[12:15], v[132:135]
    s_waitcnt lgkmcnt(6)
    v_mul_f32 v153, v153, v19
    v_mul_f32 v154, v154, v19
    v_mfma_f32_16x16x32_bf16 v[160:163], a[224:227], a[16:19], v[160:163]
    ds_write_b128 v15, v[120:123] offset:23552
    v_mfma_f32_16x16x32_bf16 v[164:167], a[228:231], a[16:19], v[164:167]
    s_waitcnt lgkmcnt(1)
    v_mul_f32 v155, v155, v19
    v_mul_f32 v156, v156, v19
    v_mfma_f32_16x16x32_bf16 v[192:195], a[224:227], a[20:23], v[192:195]
    buffer_load_dwordx4 v5, s[24:27], s53 offen offset:0 lds
    v_mfma_f32_16x16x32_bf16 v[196:199], a[228:231], a[20:23], v[196:199]
    s_waitcnt vmcnt(9)
    ds_read_b64_tr_b16 a[240:241], v1 offset:0
    v_mfma_f32_16x16x32_bf16 v[224:227], a[224:227], a[24:27], v[224:227]
    ds_read_b64_tr_b16 a[242:243], v1 offset:1024
    v_mul_f32 v157, v157, v19
    v_mfma_f32_16x16x32_bf16 v[228:231], a[228:231], a[24:27], v[228:231]
    ds_read_b64_tr_b16 a[244:245], v2 offset:0
    v_mul_f32 v158, v158, v19
    v_mfma_f32_16x16x32_bf16 v[40:43], a[232:235], a[0:3], v[40:43]
    ds_read_b64_tr_b16 a[246:247], v2 offset:1024
    v_mul_f32 v159, v159, v19
    v_mfma_f32_16x16x32_bf16 v[44:47], a[236:239], a[0:3], v[44:47]
    buffer_load_dwordx4 v6, s[24:27], s53 offen offset:1024 lds
    v_mfma_f32_16x16x32_bf16 v[72:75], a[232:235], a[4:7], v[72:75]
    s_add_u32 m0, s58, 0
    s_add_u32 s53, s46, 98304
    v_cvt_pk_bf16_f32 v152, v152, v153
    v_mfma_f32_16x16x32_bf16 v[76:79], a[236:239], a[4:7], v[76:79]
    v_cvt_pk_bf16_f32 v153, v154, v155
    v_cvt_pk_bf16_f32 v154, v156, v157
    v_mfma_f32_16x16x32_bf16 v[104:107], a[232:235], a[8:11], v[104:107]
    v_cvt_pk_bf16_f32 v155, v158, v159
    v_accvgpr_read_b32 v184, a200
    v_mfma_f32_16x16x32_bf16 v[108:111], a[236:239], a[8:11], v[108:111]
    s_waitcnt lgkmcnt(0)
    v_accvgpr_read_b32 v185, a201
    v_accvgpr_read_b32 v186, a202
    v_mfma_f32_16x16x32_bf16 v[136:139], a[232:235], a[12:15], v[136:139]
    buffer_load_dwordx4 v5, s[24:27], s53 offen offset:0 lds
    v_mfma_f32_16x16x32_bf16 v[140:143], a[236:239], a[12:15], v[140:143]
    s_waitcnt vmcnt(9)
    ds_read_b64_tr_b16 a[104:105], v1 offset:2048
    v_mfma_f32_16x16x32_bf16 v[168:171], a[232:235], a[16:19], v[168:171]
    ds_read_b64_tr_b16 a[106:107], v1 offset:3072
    v_accvgpr_read_b32 v187, a203
    v_mfma_f32_16x16x32_bf16 v[172:175], a[236:239], a[16:19], v[172:175]
    ds_read_b64_tr_b16 a[108:109], v2 offset:2048
    v_accvgpr_read_b32 v188, a204
    v_mfma_f32_16x16x32_bf16 v[200:203], a[232:235], a[20:23], v[200:203]
    ds_read_b64_tr_b16 a[110:111], v2 offset:3072
    v_accvgpr_read_b32 v189, a205
    v_mfma_f32_16x16x32_bf16 v[204:207], a[236:239], a[20:23], v[204:207]
    buffer_load_dwordx4 v6, s[24:27], s53 offen offset:1024 lds
    v_mfma_f32_16x16x32_bf16 v[232:235], a[232:235], a[24:27], v[232:235]
    s_add_u32 m0, s58, 2048
    s_add_u32 s53, s46, 98368
    v_accvgpr_read_b32 v190, a206
    v_mfma_f32_16x16x32_bf16 v[236:239], a[236:239], a[24:27], v[236:239]
    ds_write_b128 v15, v[152:155] offset:24576
    v_mfma_f32_16x16x32_bf16 v[48:51], a[240:243], a[0:3], v[48:51]
    s_add_u32 s52, s46, 98432
    v_accvgpr_read_b32 v191, a207
    v_mul_f32 v184, v184, v20
    v_mfma_f32_16x16x32_bf16 v[52:55], a[244:247], a[0:3], v[52:55]
    ds_read_b128 a[0:3], v14 offset:47104
    v_mul_f32 v185, v185, v20
    v_mfma_f32_16x16x32_bf16 v[80:83], a[240:243], a[4:7], v[80:83]
    s_waitcnt vmcnt(8)
    ds_read_b64_tr_b16 a[224:225], v1 offset:4096
    v_mfma_f32_16x16x32_bf16 v[84:87], a[244:247], a[4:7], v[84:87]
    s_waitcnt lgkmcnt(3)
    ds_read_b128 a[4:7], v14 offset:48128
    v_mfma_f32_16x16x32_bf16 v[112:115], a[240:243], a[8:11], v[112:115]
    ds_read_b64_tr_b16 a[226:227], v1 offset:5120
    v_mul_f32 v186, v186, v20
    v_mfma_f32_16x16x32_bf16 v[116:119], a[244:247], a[8:11], v[116:119]
    ds_read_b128 a[8:11], v14 offset:49152
    v_mul_f32 v187, v187, v20
    v_mfma_f32_16x16x32_bf16 v[144:147], a[240:243], a[12:15], v[144:147]
    ds_read_b64_tr_b16 a[228:229], v2 offset:4096
    v_mul_f32 v188, v188, v20
    v_mfma_f32_16x16x32_bf16 v[148:151], a[244:247], a[12:15], v[148:151]
    ds_read_b128 a[12:15], v14 offset:50176
    v_mul_f32 v189, v189, v20
    v_mfma_f32_16x16x32_bf16 v[176:179], a[240:243], a[16:19], v[176:179]
    ds_read_b64_tr_b16 a[230:231], v2 offset:5120
    v_mul_f32 v190, v190, v20
    v_mfma_f32_16x16x32_bf16 v[180:183], a[244:247], a[16:19], v[180:183]
    ds_read_b128 a[16:19], v14 offset:51200
    v_mul_f32 v191, v191, v20
    v_mfma_f32_16x16x32_bf16 v[208:211], a[240:243], a[20:23], v[208:211]
    buffer_load_dwordx4 v5, s[24:27], s53 offen offset:0 lds
    v_mfma_f32_16x16x32_bf16 v[212:215], a[244:247], a[20:23], v[212:215]
    ds_read_b128 a[20:23], v14 offset:52224
    v_cvt_pk_bf16_f32 v184, v184, v185
    v_mfma_f32_16x16x32_bf16 v[240:243], a[240:243], a[24:27], v[240:243]
    buffer_load_dwordx4 v6, s[24:27], s53 offen offset:1024 lds
    v_mfma_f32_16x16x32_bf16 v[244:247], a[244:247], a[24:27], v[244:247]
    s_waitcnt lgkmcnt(2)
    ds_read_b128 a[24:27], v14 offset:53248
    v_mfma_f32_16x16x32_bf16 v[32:35], a[224:227], a[0:3], v[32:35]
    s_waitcnt vmcnt(8)
    ds_read_b64_tr_b16 a[232:233], v1 offset:6144
    v_mfma_f32_16x16x32_bf16 v[36:39], a[228:231], a[0:3], v[36:39]
    s_add_u32 m0, s58, 4096
    ds_read_b64_tr_b16 a[234:235], v1 offset:7168
    v_mfma_f32_16x16x32_bf16 v[64:67], a[224:227], a[4:7], v[64:67]
    ds_read_b64_tr_b16 a[236:237], v2 offset:6144
    v_cvt_pk_bf16_f32 v185, v186, v187
    v_mfma_f32_16x16x32_bf16 v[68:71], a[228:231], a[4:7], v[68:71]
    ds_read_b64_tr_b16 a[238:239], v2 offset:7168
    v_cvt_pk_bf16_f32 v186, v188, v189
    v_mfma_f32_16x16x32_bf16 v[96:99], a[224:227], a[8:11], v[96:99]
    buffer_load_dwordx4 v5, s[24:27], s52 offen offset:0 lds
    v_mfma_f32_16x16x32_bf16 v[100:103], a[228:231], a[8:11], v[100:103]
    buffer_load_dwordx4 v6, s[24:27], s52 offen offset:1024 lds
    v_mfma_f32_16x16x32_bf16 v[128:131], a[224:227], a[12:15], v[128:131]
    s_add_u32 m0, s58, 6144
    s_add_u32 s53, s46, 98496
    v_cvt_pk_bf16_f32 v187, v190, v191
    v_mfma_f32_16x16x32_bf16 v[132:135], a[228:231], a[12:15], v[132:135]
    s_waitcnt lgkmcnt(6)
    v_accvgpr_read_b32 v216, a208
    v_accvgpr_read_b32 v217, a209
    v_mfma_f32_16x16x32_bf16 v[160:163], a[224:227], a[16:19], v[160:163]
    ds_write_b128 v15, v[184:187] offset:25600
    v_mfma_f32_16x16x32_bf16 v[164:167], a[228:231], a[16:19], v[164:167]
    s_waitcnt lgkmcnt(1)
    v_accvgpr_read_b32 v218, a210
    v_accvgpr_read_b32 v219, a211
    v_mfma_f32_16x16x32_bf16 v[192:195], a[224:227], a[20:23], v[192:195]
    buffer_load_dwordx4 v5, s[24:27], s53 offen offset:0 lds
    v_mfma_f32_16x16x32_bf16 v[196:199], a[228:231], a[20:23], v[196:199]
    s_waitcnt vmcnt(9)
    ds_read_b64_tr_b16 a[240:241], v3 offset:0
    v_mfma_f32_16x16x32_bf16 v[224:227], a[224:227], a[24:27], v[224:227]
    ds_read_b64_tr_b16 a[242:243], v3 offset:1024
    v_accvgpr_read_b32 v220, a212
    v_mfma_f32_16x16x32_bf16 v[228:231], a[228:231], a[24:27], v[228:231]
    ds_read_b64_tr_b16 a[244:245], v4 offset:0
    v_accvgpr_read_b32 v221, a213
    v_mfma_f32_16x16x32_bf16 v[40:43], a[232:235], a[0:3], v[40:43]
    ds_read_b64_tr_b16 a[246:247], v4 offset:1024
    v_accvgpr_read_b32 v222, a214
    v_mfma_f32_16x16x32_bf16 v[44:47], a[236:239], a[0:3], v[44:47]
    buffer_load_dwordx4 v6, s[24:27], s53 offen offset:1024 lds
    v_mfma_f32_16x16x32_bf16 v[72:75], a[232:235], a[4:7], v[72:75]
    s_add_u32 m0, s59, 0
    s_add_u32 s53, s46, 229376
    v_accvgpr_read_b32 v223, a215
    v_mfma_f32_16x16x32_bf16 v[76:79], a[236:239], a[4:7], v[76:79]
    v_mul_f32 v216, v216, v21
    v_mul_f32 v217, v217, v21
    v_mfma_f32_16x16x32_bf16 v[104:107], a[232:235], a[8:11], v[104:107]
    v_mul_f32 v218, v218, v21
    v_mul_f32 v219, v219, v21
    v_mfma_f32_16x16x32_bf16 v[108:111], a[236:239], a[8:11], v[108:111]
    s_waitcnt lgkmcnt(0)
    v_mul_f32 v220, v220, v21
    v_mul_f32 v221, v221, v21
    v_mfma_f32_16x16x32_bf16 v[136:139], a[232:235], a[12:15], v[136:139]
    buffer_load_dwordx4 v5, s[24:27], s53 offen offset:0 lds
    v_mfma_f32_16x16x32_bf16 v[140:143], a[236:239], a[12:15], v[140:143]
    s_waitcnt vmcnt(9)
    ds_read_b64_tr_b16 a[112:113], v3 offset:2048
    v_mfma_f32_16x16x32_bf16 v[168:171], a[232:235], a[16:19], v[168:171]
    ds_read_b64_tr_b16 a[114:115], v3 offset:3072
    v_mul_f32 v222, v222, v21
    v_mfma_f32_16x16x32_bf16 v[172:175], a[236:239], a[16:19], v[172:175]
    ds_read_b64_tr_b16 a[116:117], v4 offset:2048
    v_mul_f32 v223, v223, v21
    v_mfma_f32_16x16x32_bf16 v[200:203], a[232:235], a[20:23], v[200:203]
    ds_read_b64_tr_b16 a[118:119], v4 offset:3072
    v_cvt_pk_bf16_f32 v216, v216, v217
    v_mfma_f32_16x16x32_bf16 v[204:207], a[236:239], a[20:23], v[204:207]
    buffer_load_dwordx4 v6, s[24:27], s53 offen offset:1024 lds
    v_mfma_f32_16x16x32_bf16 v[232:235], a[232:235], a[24:27], v[232:235]
    s_add_u32 m0, s59, 2048
    s_add_u32 s53, s46, 229440
    v_cvt_pk_bf16_f32 v217, v218, v219
    v_mfma_f32_16x16x32_bf16 v[236:239], a[236:239], a[24:27], v[236:239]
    v_cvt_pk_bf16_f32 v218, v220, v221
    v_cvt_pk_bf16_f32 v219, v222, v223
    ds_write_b128 v15, v[216:219] offset:26624
    v_accvgpr_read_b32 v248, a216
    v_accvgpr_read_b32 v249, a217
    v_accvgpr_read_b32 v250, a218
    v_accvgpr_read_b32 v251, a219
    v_accvgpr_read_b32 v252, a220
    v_accvgpr_read_b32 v253, a221
    v_accvgpr_read_b32 v254, a222
    v_accvgpr_read_b32 v255, a223
    v_mul_f32 v248, v248, v22
    v_mul_f32 v249, v249, v22
    v_mul_f32 v250, v250, v22
    v_mul_f32 v251, v251, v22
    v_mul_f32 v252, v252, v22
    v_mul_f32 v253, v253, v22
    v_mul_f32 v254, v254, v22
    v_mul_f32 v255, v255, v22
    v_cvt_pk_bf16_f32 v248, v248, v249
    v_cvt_pk_bf16_f32 v249, v250, v251
    v_cvt_pk_bf16_f32 v250, v252, v253
    v_cvt_pk_bf16_f32 v251, v254, v255
    ds_write_b128 v15, v[248:251] offset:27648
    s_waitcnt lgkmcnt(0)
    s_barrier
    v_mfma_f32_16x16x32_bf16 v[48:51], a[240:243], a[0:3], v[48:51]
    s_add_u32 s52, s46, 229504
    v_mfma_f32_16x16x32_bf16 v[52:55], a[244:247], a[0:3], v[52:55]
    ds_read_b128 a[0:3], v13 offset:21504
    v_mfma_f32_16x16x32_bf16 v[80:83], a[240:243], a[4:7], v[80:83]
    s_waitcnt vmcnt(8)
    ds_read_b64_tr_b16 a[224:225], v1 offset:0
    v_mfma_f32_16x16x32_bf16 v[84:87], a[244:247], a[4:7], v[84:87]
    s_waitcnt lgkmcnt(4)
    ds_read_b128 a[4:7], v13 offset:22528
    v_mfma_f32_16x16x32_bf16 v[112:115], a[240:243], a[8:11], v[112:115]
    ds_read_b64_tr_b16 a[226:227], v1 offset:1024
    v_mfma_f32_16x16x32_bf16 v[116:119], a[244:247], a[8:11], v[116:119]
    ds_read_b128 a[8:11], v13 offset:23552
    v_mfma_f32_16x16x32_bf16 v[144:147], a[240:243], a[12:15], v[144:147]
    ds_read_b64_tr_b16 a[228:229], v2 offset:0
    v_mfma_f32_16x16x32_bf16 v[148:151], a[244:247], a[12:15], v[148:151]
    ds_read_b128 a[12:15], v13 offset:24576
    v_mfma_f32_16x16x32_bf16 v[176:179], a[240:243], a[16:19], v[176:179]
    ds_read_b64_tr_b16 a[230:231], v2 offset:1024
    v_mfma_f32_16x16x32_bf16 v[180:183], a[244:247], a[16:19], v[180:183]
    ds_read_b128 a[16:19], v13 offset:25600
    v_mfma_f32_16x16x32_bf16 v[208:211], a[240:243], a[20:23], v[208:211]
    buffer_load_dwordx4 v5, s[24:27], s53 offen offset:0 lds
    v_mfma_f32_16x16x32_bf16 v[212:215], a[244:247], a[20:23], v[212:215]
    ds_read_b128 a[20:23], v13 offset:26624
    v_mfma_f32_16x16x32_bf16 v[240:243], a[240:243], a[24:27], v[240:243]
    buffer_load_dwordx4 v6, s[24:27], s53 offen offset:1024 lds
    v_mfma_f32_16x16x32_bf16 v[244:247], a[244:247], a[24:27], v[244:247]
    s_waitcnt lgkmcnt(2)
    ds_read_b128 a[24:27], v13 offset:27648
    v_mfma_f32_16x16x32_bf16 v[32:35], a[224:227], a[0:3], v[32:35]
    s_waitcnt vmcnt(8)
    ds_read_b64_tr_b16 a[232:233], v1 offset:2048
    v_mfma_f32_16x16x32_bf16 v[36:39], a[228:231], a[0:3], v[36:39]
    s_add_u32 m0, s58, 0
    ds_read_b64_tr_b16 a[234:235], v1 offset:3072
    v_mfma_f32_16x16x32_bf16 v[64:67], a[224:227], a[4:7], v[64:67]
    ds_read_b64_tr_b16 a[236:237], v2 offset:2048
    v_mfma_f32_16x16x32_bf16 v[68:71], a[228:231], a[4:7], v[68:71]
    ds_read_b64_tr_b16 a[238:239], v2 offset:3072
    v_mfma_f32_16x16x32_bf16 v[96:99], a[224:227], a[8:11], v[96:99]
    buffer_load_dwordx4 v5, s[24:27], s52 offen offset:0 lds
    v_mfma_f32_16x16x32_bf16 v[100:103], a[228:231], a[8:11], v[100:103]
    buffer_load_dwordx4 v6, s[24:27], s52 offen offset:1024 lds
    v_mfma_f32_16x16x32_bf16 v[128:131], a[224:227], a[12:15], v[128:131]
    s_add_u32 m0, s58, 2048
    s_add_u32 s53, s46, 229568
    v_mfma_f32_16x16x32_bf16 v[132:135], a[228:231], a[12:15], v[132:135]
    s_waitcnt lgkmcnt(6)
    v_mfma_f32_16x16x32_bf16 v[160:163], a[224:227], a[16:19], v[160:163]
    v_mfma_f32_16x16x32_bf16 v[164:167], a[228:231], a[16:19], v[164:167]
    s_waitcnt lgkmcnt(0)
    v_mfma_f32_16x16x32_bf16 v[192:195], a[224:227], a[20:23], v[192:195]
    buffer_load_dwordx4 v5, s[24:27], s53 offen offset:0 lds
    v_mfma_f32_16x16x32_bf16 v[196:199], a[228:231], a[20:23], v[196:199]
    s_waitcnt vmcnt(9)
    ds_read_b64_tr_b16 a[240:241], v1 offset:4096
    v_mfma_f32_16x16x32_bf16 v[224:227], a[224:227], a[24:27], v[224:227]
    ds_read_b64_tr_b16 a[242:243], v1 offset:5120
    v_mfma_f32_16x16x32_bf16 v[228:231], a[228:231], a[24:27], v[228:231]
    ds_read_b64_tr_b16 a[244:245], v2 offset:4096
    v_mfma_f32_16x16x32_bf16 v[40:43], a[232:235], a[0:3], v[40:43]
    ds_read_b64_tr_b16 a[246:247], v2 offset:5120
    v_mfma_f32_16x16x32_bf16 v[44:47], a[236:239], a[0:3], v[44:47]
    buffer_load_dwordx4 v6, s[24:27], s53 offen offset:1024 lds
    v_mfma_f32_16x16x32_bf16 v[72:75], a[232:235], a[4:7], v[72:75]
    s_add_u32 m0, s58, 4096
    s_add_u32 s53, s46, 360448
    v_mfma_f32_16x16x32_bf16 v[76:79], a[236:239], a[4:7], v[76:79]
    v_mfma_f32_16x16x32_bf16 v[104:107], a[232:235], a[8:11], v[104:107]
    v_mfma_f32_16x16x32_bf16 v[108:111], a[236:239], a[8:11], v[108:111]
    s_waitcnt lgkmcnt(0)
    v_mfma_f32_16x16x32_bf16 v[136:139], a[232:235], a[12:15], v[136:139]
    buffer_load_dwordx4 v5, s[24:27], s53 offen offset:0 lds
    v_mfma_f32_16x16x32_bf16 v[140:143], a[236:239], a[12:15], v[140:143]
    s_waitcnt vmcnt(9)
    ds_read_b64_tr_b16 a[120:121], v1 offset:6144
    v_mfma_f32_16x16x32_bf16 v[168:171], a[232:235], a[16:19], v[168:171]
    ds_read_b64_tr_b16 a[122:123], v1 offset:7168
    v_mfma_f32_16x16x32_bf16 v[172:175], a[236:239], a[16:19], v[172:175]
    ds_read_b64_tr_b16 a[124:125], v2 offset:6144
    v_mfma_f32_16x16x32_bf16 v[200:203], a[232:235], a[20:23], v[200:203]
    ds_read_b64_tr_b16 a[126:127], v2 offset:7168
    v_mfma_f32_16x16x32_bf16 v[204:207], a[236:239], a[20:23], v[204:207]
    buffer_load_dwordx4 v6, s[24:27], s53 offen offset:1024 lds
    v_mfma_f32_16x16x32_bf16 v[232:235], a[232:235], a[24:27], v[232:235]
    s_add_u32 m0, s58, 6144
    s_add_u32 s53, s46, 360512
    v_mfma_f32_16x16x32_bf16 v[236:239], a[236:239], a[24:27], v[236:239]
    v_mfma_f32_16x16x32_bf16 v[48:51], a[240:243], a[0:3], v[48:51]
    s_add_u32 s52, s46, 360576
    v_mfma_f32_16x16x32_bf16 v[52:55], a[244:247], a[0:3], v[52:55]
    ds_read_b128 a[0:3], v13 offset:54272
    v_mfma_f32_16x16x32_bf16 v[80:83], a[240:243], a[4:7], v[80:83]
    s_waitcnt vmcnt(8)
    ds_read_b64_tr_b16 a[224:225], v3 offset:0
    v_mfma_f32_16x16x32_bf16 v[84:87], a[244:247], a[4:7], v[84:87]
    s_waitcnt lgkmcnt(2)
    ds_read_b128 a[4:7], v13 offset:55296
    v_mfma_f32_16x16x32_bf16 v[112:115], a[240:243], a[8:11], v[112:115]
    ds_read_b64_tr_b16 a[226:227], v3 offset:1024
    v_mfma_f32_16x16x32_bf16 v[116:119], a[244:247], a[8:11], v[116:119]
    ds_read_b128 a[8:11], v13 offset:56320
    v_mfma_f32_16x16x32_bf16 v[144:147], a[240:243], a[12:15], v[144:147]
    ds_read_b64_tr_b16 a[228:229], v4 offset:0
    v_mfma_f32_16x16x32_bf16 v[148:151], a[244:247], a[12:15], v[148:151]
    ds_read_b128 a[12:15], v13 offset:57344
    v_mfma_f32_16x16x32_bf16 v[176:179], a[240:243], a[16:19], v[176:179]
    ds_read_b64_tr_b16 a[230:231], v4 offset:1024
    v_mfma_f32_16x16x32_bf16 v[180:183], a[244:247], a[16:19], v[180:183]
    ds_read_b128 a[16:19], v13 offset:58368
    v_mfma_f32_16x16x32_bf16 v[208:211], a[240:243], a[20:23], v[208:211]
    buffer_load_dwordx4 v5, s[24:27], s53 offen offset:0 lds
    v_mfma_f32_16x16x32_bf16 v[212:215], a[244:247], a[20:23], v[212:215]
    ds_read_b128 a[20:23], v13 offset:59392
    v_mfma_f32_16x16x32_bf16 v[240:243], a[240:243], a[24:27], v[240:243]
    buffer_load_dwordx4 v6, s[24:27], s53 offen offset:1024 lds
    v_mfma_f32_16x16x32_bf16 v[244:247], a[244:247], a[24:27], v[244:247]
    s_waitcnt lgkmcnt(2)
    ds_read_b128 a[24:27], v13 offset:60416
    v_mfma_f32_16x16x32_bf16 v[32:35], a[224:227], a[0:3], v[32:35]
    s_waitcnt vmcnt(8)
    ds_read_b64_tr_b16 a[232:233], v3 offset:2048
    v_mfma_f32_16x16x32_bf16 v[36:39], a[228:231], a[0:3], v[36:39]
    s_add_u32 m0, s59, 0
    ds_read_b64_tr_b16 a[234:235], v3 offset:3072
    v_mfma_f32_16x16x32_bf16 v[64:67], a[224:227], a[4:7], v[64:67]
    ds_read_b64_tr_b16 a[236:237], v4 offset:2048
    v_mfma_f32_16x16x32_bf16 v[68:71], a[228:231], a[4:7], v[68:71]
    ds_read_b64_tr_b16 a[238:239], v4 offset:3072
    v_mfma_f32_16x16x32_bf16 v[96:99], a[224:227], a[8:11], v[96:99]
    buffer_load_dwordx4 v5, s[24:27], s52 offen offset:0 lds
    v_mfma_f32_16x16x32_bf16 v[100:103], a[228:231], a[8:11], v[100:103]
    buffer_load_dwordx4 v6, s[24:27], s52 offen offset:1024 lds
    v_mfma_f32_16x16x32_bf16 v[128:131], a[224:227], a[12:15], v[128:131]
    s_add_u32 m0, s59, 2048
    s_add_u32 s53, s46, 360640
    v_mfma_f32_16x16x32_bf16 v[132:135], a[228:231], a[12:15], v[132:135]
    s_waitcnt lgkmcnt(6)
    v_mfma_f32_16x16x32_bf16 v[160:163], a[224:227], a[16:19], v[160:163]
    v_mfma_f32_16x16x32_bf16 v[164:167], a[228:231], a[16:19], v[164:167]
    s_waitcnt lgkmcnt(0)
    v_mfma_f32_16x16x32_bf16 v[192:195], a[224:227], a[20:23], v[192:195]
    buffer_load_dwordx4 v5, s[24:27], s53 offen offset:0 lds
    v_mfma_f32_16x16x32_bf16 v[196:199], a[228:231], a[20:23], v[196:199]
    s_waitcnt vmcnt(9)
    ds_read_b64_tr_b16 a[240:241], v1 offset:0
    v_mfma_f32_16x16x32_bf16 v[224:227], a[224:227], a[24:27], v[224:227]
    ds_read_b64_tr_b16 a[242:243], v1 offset:1024
    v_mfma_f32_16x16x32_bf16 v[228:231], a[228:231], a[24:27], v[228:231]
    ds_read_b64_tr_b16 a[244:245], v2 offset:0
    v_mfma_f32_16x16x32_bf16 v[40:43], a[232:235], a[0:3], v[40:43]
    ds_read_b64_tr_b16 a[246:247], v2 offset:1024
    v_mfma_f32_16x16x32_bf16 v[44:47], a[236:239], a[0:3], v[44:47]
    buffer_load_dwordx4 v6, s[24:27], s53 offen offset:1024 lds
    v_mfma_f32_16x16x32_bf16 v[72:75], a[232:235], a[4:7], v[72:75]
    s_add_u32 m0, s58, 0
    s_add_u32 s53, s46, 491520
    v_mfma_f32_16x16x32_bf16 v[76:79], a[236:239], a[4:7], v[76:79]
    s_mov_b32 s8, s64
    s_and_b32 s9, s65, 65535
    s_mov_b32 s10, 3670016
    s_lshl_b32 s3, s44, 3
    s_add_u32 s3, s3, s7
    s_mul_i32 s3, s3, 224
    s_mul_i32 s57, s4, 56
    s_add_u32 s3, s3, s57
    s_add_u32 s3, s3, s95
    s_lshl_b32 s94, s3, 10
    s_cmp_eq_u32 s7, 7
    s_cselect_b32 s61, s94, 0x7fff0000
    v_cmp_gt_u32 vcc, 8, v0
    v_mov_b32 v11, 1073741824
    v_lshlrev_b32 v10, 2, v0
    v_lshlrev_b32 v12, 3, v23
    v_mov_b32 v9, 1
    v_cndmask_b32 v10, v11, v10, vcc
    v_lshl_add_u32 v12, v31, 10, v12
    s_lshl_b32 s47, s44, 12
    v_mfma_f32_16x16x32_bf16 v[104:107], a[232:235], a[8:11], v[104:107]
    v_mfma_f32_16x16x32_bf16 v[108:111], a[236:239], a[8:11], v[108:111]
    s_waitcnt lgkmcnt(0)
    v_mfma_f32_16x16x32_bf16 v[136:139], a[232:235], a[12:15], v[136:139]
    buffer_load_dwordx4 v5, s[24:27], s53 offen offset:0 lds
    v_mfma_f32_16x16x32_bf16 v[140:143], a[236:239], a[12:15], v[140:143]
    s_waitcnt vmcnt(9)
    ds_read_b64_tr_b16 a[128:129], v1 offset:2048
    v_mfma_f32_16x16x32_bf16 v[168:171], a[232:235], a[16:19], v[168:171]
    ds_read_b64_tr_b16 a[130:131], v1 offset:3072
    v_mfma_f32_16x16x32_bf16 v[172:175], a[236:239], a[16:19], v[172:175]
    ds_read_b64_tr_b16 a[132:133], v2 offset:2048
    v_mfma_f32_16x16x32_bf16 v[200:203], a[232:235], a[20:23], v[200:203]
    ds_read_b64_tr_b16 a[134:135], v2 offset:3072
    v_mfma_f32_16x16x32_bf16 v[204:207], a[236:239], a[20:23], v[204:207]
    buffer_load_dwordx4 v6, s[24:27], s53 offen offset:1024 lds
    v_mfma_f32_16x16x32_bf16 v[232:235], a[232:235], a[24:27], v[232:235]
    s_add_u32 m0, s58, 2048
    s_add_u32 s53, s46, 491584
    v_mfma_f32_16x16x32_bf16 v[236:239], a[236:239], a[24:27], v[236:239]
    v_mfma_f32_16x16x32_bf16 v[48:51], a[240:243], a[0:3], v[48:51]
    s_add_u32 s52, s46, 491648
    v_mfma_f32_16x16x32_bf16 v[52:55], a[244:247], a[0:3], v[52:55]
    ds_read_b128 a[0:3], v14 offset:21504
    v_mfma_f32_16x16x32_bf16 v[80:83], a[240:243], a[4:7], v[80:83]
    s_waitcnt vmcnt(8)
    ds_read_b64_tr_b16 a[224:225], v1 offset:4096
    v_mfma_f32_16x16x32_bf16 v[84:87], a[244:247], a[4:7], v[84:87]
    s_waitcnt lgkmcnt(2)
    ds_read_b128 a[4:7], v14 offset:22528
    v_mfma_f32_16x16x32_bf16 v[112:115], a[240:243], a[8:11], v[112:115]
    ds_read_b64_tr_b16 a[226:227], v1 offset:5120
    v_mfma_f32_16x16x32_bf16 v[116:119], a[244:247], a[8:11], v[116:119]
    ds_read_b128 a[8:11], v14 offset:23552
    v_mfma_f32_16x16x32_bf16 v[144:147], a[240:243], a[12:15], v[144:147]
    ds_read_b64_tr_b16 a[228:229], v2 offset:4096
    v_mfma_f32_16x16x32_bf16 v[148:151], a[244:247], a[12:15], v[148:151]
    ds_read_b128 a[12:15], v14 offset:24576
    v_mfma_f32_16x16x32_bf16 v[176:179], a[240:243], a[16:19], v[176:179]
    ds_read_b64_tr_b16 a[230:231], v2 offset:5120
    v_mfma_f32_16x16x32_bf16 v[180:183], a[244:247], a[16:19], v[180:183]
    ds_read_b128 a[16:19], v14 offset:25600
    v_mfma_f32_16x16x32_bf16 v[208:211], a[240:243], a[20:23], v[208:211]
    buffer_load_dwordx4 v5, s[24:27], s53 offen offset:0 lds
    v_mfma_f32_16x16x32_bf16 v[212:215], a[244:247], a[20:23], v[212:215]
    ds_read_b128 a[20:23], v14 offset:26624
    v_mfma_f32_16x16x32_bf16 v[240:243], a[240:243], a[24:27], v[240:243]
    buffer_load_dwordx4 v6, s[24:27], s53 offen offset:1024 lds
    v_mfma_f32_16x16x32_bf16 v[244:247], a[244:247], a[24:27], v[244:247]
    s_waitcnt lgkmcnt(2)
    ds_read_b128 a[24:27], v14 offset:27648
    v_mfma_f32_16x16x32_bf16 v[32:35], a[224:227], a[0:3], v[32:35]
    s_waitcnt vmcnt(8)
    ds_read_b64_tr_b16 a[232:233], v1 offset:6144
    v_mfma_f32_16x16x32_bf16 v[36:39], a[228:231], a[0:3], v[36:39]
    s_add_u32 m0, s58, 4096
    ds_read_b64_tr_b16 a[234:235], v1 offset:7168
    v_mfma_f32_16x16x32_bf16 v[64:67], a[224:227], a[4:7], v[64:67]
    ds_read_b64_tr_b16 a[236:237], v2 offset:6144
    v_mfma_f32_16x16x32_bf16 v[68:71], a[228:231], a[4:7], v[68:71]
    ds_read_b64_tr_b16 a[238:239], v2 offset:7168
    v_mfma_f32_16x16x32_bf16 v[96:99], a[224:227], a[8:11], v[96:99]
    buffer_load_dwordx4 v5, s[24:27], s52 offen offset:0 lds
    v_mfma_f32_16x16x32_bf16 v[100:103], a[228:231], a[8:11], v[100:103]
    buffer_load_dwordx4 v6, s[24:27], s52 offen offset:1024 lds
    v_mfma_f32_16x16x32_bf16 v[128:131], a[224:227], a[12:15], v[128:131]
    s_add_u32 m0, s58, 6144
    s_add_u32 s53, s46, 491712
    v_mfma_f32_16x16x32_bf16 v[132:135], a[228:231], a[12:15], v[132:135]
    s_waitcnt lgkmcnt(6)
    v_mfma_f32_16x16x32_bf16 v[160:163], a[224:227], a[16:19], v[160:163]
    v_mfma_f32_16x16x32_bf16 v[164:167], a[228:231], a[16:19], v[164:167]
    s_waitcnt lgkmcnt(0)
    v_mfma_f32_16x16x32_bf16 v[192:195], a[224:227], a[20:23], v[192:195]
    buffer_load_dwordx4 v5, s[24:27], s53 offen offset:0 lds
    v_mfma_f32_16x16x32_bf16 v[196:199], a[228:231], a[20:23], v[196:199]
    s_waitcnt vmcnt(9)
    ds_read_b64_tr_b16 a[240:241], v3 offset:0
    v_mfma_f32_16x16x32_bf16 v[224:227], a[224:227], a[24:27], v[224:227]
    ds_read_b64_tr_b16 a[242:243], v3 offset:1024
    v_mfma_f32_16x16x32_bf16 v[228:231], a[228:231], a[24:27], v[228:231]
    ds_read_b64_tr_b16 a[244:245], v4 offset:0
    v_mfma_f32_16x16x32_bf16 v[40:43], a[232:235], a[0:3], v[40:43]
    ds_read_b64_tr_b16 a[246:247], v4 offset:1024
    v_mfma_f32_16x16x32_bf16 v[44:47], a[236:239], a[0:3], v[44:47]
    buffer_load_dwordx4 v6, s[24:27], s53 offen offset:1024 lds
    v_mfma_f32_16x16x32_bf16 v[72:75], a[232:235], a[4:7], v[72:75]
    v_mfma_f32_16x16x32_bf16 v[76:79], a[236:239], a[4:7], v[76:79]
    v_mfma_f32_16x16x32_bf16 v[104:107], a[232:235], a[8:11], v[104:107]
    v_mfma_f32_16x16x32_bf16 v[108:111], a[236:239], a[8:11], v[108:111]
    s_waitcnt lgkmcnt(0)
    v_mfma_f32_16x16x32_bf16 v[136:139], a[232:235], a[12:15], v[136:139]
    v_mfma_f32_16x16x32_bf16 v[140:143], a[236:239], a[12:15], v[140:143]
    s_waitcnt vmcnt(8)
    ds_read_b64_tr_b16 a[136:137], v3 offset:2048
    v_mfma_f32_16x16x32_bf16 v[168:171], a[232:235], a[16:19], v[168:171]
    ds_read_b64_tr_b16 a[138:139], v3 offset:3072
    v_mfma_f32_16x16x32_bf16 v[172:175], a[236:239], a[16:19], v[172:175]
    ds_read_b64_tr_b16 a[140:141], v4 offset:2048
    v_mfma_f32_16x16x32_bf16 v[200:203], a[232:235], a[20:23], v[200:203]
    ds_read_b64_tr_b16 a[142:143], v4 offset:3072
    v_mfma_f32_16x16x32_bf16 v[204:207], a[236:239], a[20:23], v[204:207]
    v_mfma_f32_16x16x32_bf16 v[232:235], a[232:235], a[24:27], v[232:235]
    v_mfma_f32_16x16x32_bf16 v[236:239], a[236:239], a[24:27], v[236:239]
    v_mfma_f32_16x16x32_bf16 v[48:51], a[240:243], a[0:3], v[48:51]
    v_mfma_f32_16x16x32_bf16 v[52:55], a[244:247], a[0:3], v[52:55]
    ds_read_b128 a[0:3], v14 offset:54272
    v_mfma_f32_16x16x32_bf16 v[80:83], a[240:243], a[4:7], v[80:83]
    s_waitcnt vmcnt(6)
    ds_read_b64_tr_b16 a[224:225], v1 offset:0
    v_mfma_f32_16x16x32_bf16 v[84:87], a[244:247], a[4:7], v[84:87]
    s_waitcnt lgkmcnt(2)
    ds_read_b128 a[4:7], v14 offset:55296
    v_mfma_f32_16x16x32_bf16 v[112:115], a[240:243], a[8:11], v[112:115]
    ds_read_b64_tr_b16 a[226:227], v1 offset:1024
    v_mfma_f32_16x16x32_bf16 v[116:119], a[244:247], a[8:11], v[116:119]
    ds_read_b128 a[8:11], v14 offset:56320
    v_mfma_f32_16x16x32_bf16 v[144:147], a[240:243], a[12:15], v[144:147]
    ds_read_b64_tr_b16 a[228:229], v2 offset:0
    v_mfma_f32_16x16x32_bf16 v[148:151], a[244:247], a[12:15], v[148:151]
    ds_read_b128 a[12:15], v14 offset:57344
    v_mfma_f32_16x16x32_bf16 v[176:179], a[240:243], a[16:19], v[176:179]
    ds_read_b64_tr_b16 a[230:231], v2 offset:1024
    v_mfma_f32_16x16x32_bf16 v[180:183], a[244:247], a[16:19], v[180:183]
    ds_read_b128 a[16:19], v14 offset:58368
    v_mfma_f32_16x16x32_bf16 v[208:211], a[240:243], a[20:23], v[208:211]
    v_mfma_f32_16x16x32_bf16 v[212:215], a[244:247], a[20:23], v[212:215]
    ds_read_b128 a[20:23], v14 offset:59392
    v_mfma_f32_16x16x32_bf16 v[240:243], a[240:243], a[24:27], v[240:243]
    v_mfma_f32_16x16x32_bf16 v[244:247], a[244:247], a[24:27], v[244:247]
    s_waitcnt lgkmcnt(2)
    ds_read_b128 a[24:27], v14 offset:60416
    v_mfma_f32_16x16x32_bf16 v[32:35], a[224:227], a[0:3], v[32:35]
    s_waitcnt vmcnt(4)
    ds_read_b64_tr_b16 a[232:233], v1 offset:2048
    v_mfma_f32_16x16x32_bf16 v[36:39], a[228:231], a[0:3], v[36:39]
    ds_read_b64_tr_b16 a[234:235], v1 offset:3072
    v_mfma_f32_16x16x32_bf16 v[64:67], a[224:227], a[4:7], v[64:67]
    ds_read_b64_tr_b16 a[236:237], v2 offset:2048
    v_mfma_f32_16x16x32_bf16 v[68:71], a[228:231], a[4:7], v[68:71]
    ds_read_b64_tr_b16 a[238:239], v2 offset:3072
    v_mfma_f32_16x16x32_bf16 v[96:99], a[224:227], a[8:11], v[96:99]
    v_mfma_f32_16x16x32_bf16 v[100:103], a[228:231], a[8:11], v[100:103]
    v_mfma_f32_16x16x32_bf16 v[128:131], a[224:227], a[12:15], v[128:131]
    v_mfma_f32_16x16x32_bf16 v[132:135], a[228:231], a[12:15], v[132:135]
    s_waitcnt lgkmcnt(6)
    v_mfma_f32_16x16x32_bf16 v[160:163], a[224:227], a[16:19], v[160:163]
    v_mfma_f32_16x16x32_bf16 v[164:167], a[228:231], a[16:19], v[164:167]
    s_waitcnt lgkmcnt(0)
    v_mfma_f32_16x16x32_bf16 v[192:195], a[224:227], a[20:23], v[192:195]
    v_mfma_f32_16x16x32_bf16 v[196:199], a[228:231], a[20:23], v[196:199]
    s_waitcnt vmcnt(2)
    ds_read_b64_tr_b16 a[240:241], v1 offset:4096
    v_mfma_f32_16x16x32_bf16 v[224:227], a[224:227], a[24:27], v[224:227]
    ds_read_b64_tr_b16 a[242:243], v1 offset:5120
    v_mfma_f32_16x16x32_bf16 v[228:231], a[228:231], a[24:27], v[228:231]
    ds_read_b64_tr_b16 a[244:245], v2 offset:4096
    v_mfma_f32_16x16x32_bf16 v[40:43], a[232:235], a[0:3], v[40:43]
    ds_read_b64_tr_b16 a[246:247], v2 offset:5120
    v_mfma_f32_16x16x32_bf16 v[44:47], a[236:239], a[0:3], v[44:47]
    v_mfma_f32_16x16x32_bf16 v[72:75], a[232:235], a[4:7], v[72:75]
    v_mfma_f32_16x16x32_bf16 v[76:79], a[236:239], a[4:7], v[76:79]
    v_mfma_f32_16x16x32_bf16 v[104:107], a[232:235], a[8:11], v[104:107]
    v_mfma_f32_16x16x32_bf16 v[108:111], a[236:239], a[8:11], v[108:111]
    s_waitcnt lgkmcnt(0)
    v_mfma_f32_16x16x32_bf16 v[136:139], a[232:235], a[12:15], v[136:139]
    v_mfma_f32_16x16x32_bf16 v[140:143], a[236:239], a[12:15], v[140:143]
    s_waitcnt vmcnt(0)
    ds_read_b64_tr_b16 a[144:145], v1 offset:6144
    v_mfma_f32_16x16x32_bf16 v[168:171], a[232:235], a[16:19], v[168:171]
    ds_read_b64_tr_b16 a[146:147], v1 offset:7168
    v_cvt_pk_bf16_f32 v64, v64, v65
    v_mfma_f32_16x16x32_bf16 v[172:175], a[236:239], a[16:19], v[172:175]
    ds_read_b64_tr_b16 a[148:149], v2 offset:6144
    v_cvt_pk_bf16_f32 v65, v66, v67
    v_mfma_f32_16x16x32_bf16 v[200:203], a[232:235], a[20:23], v[200:203]
    ds_read_b64_tr_b16 a[150:151], v2 offset:7168
    v_cvt_pk_bf16_f32 v66, v68, v69
    v_mfma_f32_16x16x32_bf16 v[204:207], a[236:239], a[20:23], v[204:207]
    v_cvt_pk_bf16_f32 v67, v70, v71
    v_cvt_pk_bf16_f32 v96, v96, v97
    v_mfma_f32_16x16x32_bf16 v[232:235], a[232:235], a[24:27], v[232:235]
    s_add_u32 s62, s94, 0
    buffer_store_dwordx4 v[64:67], v13, s[28:31], s62 offen offset:1024 sc1
    v_mfma_f32_16x16x32_bf16 v[236:239], a[236:239], a[24:27], v[236:239]
    v_cvt_pk_bf16_f32 v97, v98, v99
    v_cvt_pk_bf16_f32 v98, v100, v101
    v_mfma_f32_16x16x32_bf16 v[48:51], a[240:243], a[0:3], v[48:51]
    v_cvt_pk_bf16_f32 v99, v102, v103
    v_cvt_pk_bf16_f32 v128, v128, v129
    v_mfma_f32_16x16x32_bf16 v[52:55], a[244:247], a[0:3], v[52:55]
    ds_read_b128 a[0:3], v13 offset:0
    v_cvt_pk_bf16_f32 v129, v130, v131
    v_mfma_f32_16x16x32_bf16 v[80:83], a[240:243], a[4:7], v[80:83]
    buffer_store_dwordx4 v[96:99], v13, s[28:31], s62 offen offset:2048 sc1
    v_mfma_f32_16x16x32_bf16 v[84:87], a[244:247], a[4:7], v[84:87]
    s_waitcnt lgkmcnt(1)
    ds_read_b128 a[4:7], v13 offset:1024
    v_mfma_f32_16x16x32_bf16 v[112:115], a[240:243], a[8:11], v[112:115]
    v_cvt_pk_bf16_f32 v130, v132, v133
    v_cvt_pk_bf16_f32 v131, v134, v135
    v_mfma_f32_16x16x32_bf16 v[116:119], a[244:247], a[8:11], v[116:119]
    ds_read_b128 a[8:11], v13 offset:2048
    v_cvt_pk_bf16_f32 v160, v160, v161
    v_mfma_f32_16x16x32_bf16 v[144:147], a[240:243], a[12:15], v[144:147]
    buffer_store_dwordx4 v[128:131], v13, s[28:31], s62 offen offset:3072 sc1
    v_mfma_f32_16x16x32_bf16 v[148:151], a[244:247], a[12:15], v[148:151]
    ds_read_b128 a[12:15], v13 offset:3072
    v_cvt_pk_bf16_f32 v161, v162, v163
    v_mfma_f32_16x16x32_bf16 v[176:179], a[240:243], a[16:19], v[176:179]
    v_cvt_pk_bf16_f32 v162, v164, v165
    v_cvt_pk_bf16_f32 v163, v166, v167
    v_mfma_f32_16x16x32_bf16 v[180:183], a[244:247], a[16:19], v[180:183]
    ds_read_b128 a[16:19], v13 offset:4096
    v_cvt_pk_bf16_f32 v192, v192, v193
    v_mfma_f32_16x16x32_bf16 v[208:211], a[240:243], a[20:23], v[208:211]
    s_add_u32 s62, s94, 4096
    buffer_store_dwordx4 v[160:163], v13, s[28:31], s62 offen offset:0 sc1
    v_mfma_f32_16x16x32_bf16 v[212:215], a[244:247], a[20:23], v[212:215]
    ds_read_b128 a[20:23], v13 offset:5120
    v_cvt_pk_bf16_f32 v193, v194, v195
    v_mfma_f32_16x16x32_bf16 v[240:243], a[240:243], a[24:27], v[240:243]
    v_cvt_pk_bf16_f32 v194, v196, v197
    v_cvt_pk_bf16_f32 v195, v198, v199
    v_mfma_f32_16x16x32_bf16 v[244:247], a[244:247], a[24:27], v[244:247]
    s_waitcnt lgkmcnt(3)
    ds_read_b128 a[24:27], v13 offset:6144
    v_mfma_f32_16x16x32_bf16 v[56:59], a[248:251], a[0:3], 0
    v_mfma_f32_16x16x32_bf16 v[60:63], a[252:255], a[0:3], 0
    ds_read_b128 a[0:3], v13 offset:32768
    v_mfma_f32_16x16x32_bf16 v[88:91], a[248:251], a[4:7], 0
    v_mfma_f32_16x16x32_bf16 v[92:95], a[252:255], a[4:7], 0
    ds_read_b128 a[4:7], v13 offset:33792
    v_mfma_f32_16x16x32_bf16 v[120:123], a[248:251], a[8:11], 0
    buffer_store_dwordx4 v[192:195], v13, s[28:31], s62 offen offset:1024 sc1
    v_mfma_f32_16x16x32_bf16 v[124:127], a[252:255], a[8:11], 0
    s_waitcnt lgkmcnt(3)
    ds_read_b128 a[8:11], v13 offset:34816
    v_mfma_f32_16x16x32_bf16 v[152:155], a[248:251], a[12:15], 0
    v_cvt_pk_bf16_f32 v224, v224, v225
    v_cvt_pk_bf16_f32 v225, v226, v227
    v_mfma_f32_16x16x32_bf16 v[156:159], a[252:255], a[12:15], 0
    ds_read_b128 a[12:15], v13 offset:35840
    v_cvt_pk_bf16_f32 v226, v228, v229
    v_mfma_f32_16x16x32_bf16 v[184:187], a[248:251], a[16:19], 0
    v_cvt_pk_bf16_f32 v227, v230, v231
    v_cvt_pk_bf16_f32 v24, v32, v33
    v_mfma_f32_16x16x32_bf16 v[188:191], a[252:255], a[16:19], 0
    ds_read_b128 a[16:19], v13 offset:36864
    v_cvt_pk_bf16_f32 v25, v34, v35
    v_mfma_f32_16x16x32_bf16 v[216:219], a[248:251], a[20:23], 0
    buffer_store_dwordx4 v[224:227], v13, s[28:31], s62 offen offset:2048 sc1
    v_mfma_f32_16x16x32_bf16 v[220:223], a[252:255], a[20:23], 0
    s_waitcnt lgkmcnt(5)
    ds_read_b128 a[20:23], v13 offset:37888
    v_mfma_f32_16x16x32_bf16 v[248:251], a[248:251], a[24:27], 0
    v_cvt_pk_bf16_f32 v26, v36, v37
    v_cvt_pk_bf16_f32 v27, v38, v39
    v_mfma_f32_16x16x32_bf16 v[252:255], a[252:255], a[24:27], 0
    s_waitcnt lgkmcnt(3)
    ds_read_b128 a[24:27], v13 offset:38912
    v_mfma_f32_16x16x32_bf16 v[56:59], a[28:31], a[0:3], v[56:59]
    s_add_u32 s62, s61, 0
    buffer_store_dwordx4 v[24:27], v13, s[28:31], s62 offen offset:0 sc1
    v_mfma_f32_16x16x32_bf16 v[60:63], a[32:35], a[0:3], v[60:63]
    ds_read_b128 a[0:3], v14 offset:0
    v_cvt_pk_bf16_f32 v72, v72, v73
    v_mfma_f32_16x16x32_bf16 v[88:91], a[28:31], a[4:7], v[88:91]
    v_cvt_pk_bf16_f32 v73, v74, v75
    v_cvt_pk_bf16_f32 v74, v76, v77
    v_mfma_f32_16x16x32_bf16 v[92:95], a[32:35], a[4:7], v[92:95]
    ds_read_b128 a[4:7], v14 offset:1024
    v_cvt_pk_bf16_f32 v75, v78, v79
    v_mfma_f32_16x16x32_bf16 v[120:123], a[28:31], a[8:11], v[120:123]
    s_add_u32 s62, s94, 14336
    buffer_store_dwordx4 v[72:75], v13, s[28:31], s62 offen offset:1024 sc1
    v_mfma_f32_16x16x32_bf16 v[124:127], a[32:35], a[8:11], v[124:127]
    s_waitcnt lgkmcnt(3)
    ds_read_b128 a[8:11], v14 offset:2048
    v_mfma_f32_16x16x32_bf16 v[152:155], a[28:31], a[12:15], v[152:155]
    v_cvt_pk_bf16_f32 v104, v104, v105
    v_cvt_pk_bf16_f32 v105, v106, v107
    v_mfma_f32_16x16x32_bf16 v[156:159], a[32:35], a[12:15], v[156:159]
    ds_read_b128 a[12:15], v14 offset:3072
    v_cvt_pk_bf16_f32 v106, v108, v109
    v_mfma_f32_16x16x32_bf16 v[184:187], a[28:31], a[16:19], v[184:187]
    v_cvt_pk_bf16_f32 v107, v110, v111
    v_cvt_pk_bf16_f32 v136, v136, v137
    v_mfma_f32_16x16x32_bf16 v[188:191], a[32:35], a[16:19], v[188:191]
    ds_read_b128 a[16:19], v14 offset:4096
    v_cvt_pk_bf16_f32 v137, v138, v139
    v_mfma_f32_16x16x32_bf16 v[216:219], a[28:31], a[20:23], v[216:219]
    buffer_store_dwordx4 v[104:107], v13, s[28:31], s62 offen offset:2048 sc1
    v_mfma_f32_16x16x32_bf16 v[220:223], a[32:35], a[20:23], v[220:223]
    s_waitcnt lgkmcnt(5)
    ds_read_b128 a[20:23], v14 offset:5120
    v_mfma_f32_16x16x32_bf16 v[248:251], a[28:31], a[24:27], v[248:251]
    v_cvt_pk_bf16_f32 v138, v140, v141
    v_cvt_pk_bf16_f32 v139, v142, v143
    v_mfma_f32_16x16x32_bf16 v[252:255], a[32:35], a[24:27], v[252:255]
    s_waitcnt lgkmcnt(3)
    ds_read_b128 a[24:27], v14 offset:6144
    v_mfma_f32_16x16x32_bf16 v[56:59], a[36:39], a[0:3], v[56:59]
    buffer_store_dwordx4 v[136:139], v13, s[28:31], s62 offen offset:3072 sc1
    v_mfma_f32_16x16x32_bf16 v[60:63], a[40:43], a[0:3], v[60:63]
    ds_read_b128 a[0:3], v14 offset:32768
    v_cvt_pk_bf16_f32 v168, v168, v169
    v_mfma_f32_16x16x32_bf16 v[88:91], a[36:39], a[4:7], v[88:91]
    v_cvt_pk_bf16_f32 v169, v170, v171
    v_cvt_pk_bf16_f32 v170, v172, v173
    v_mfma_f32_16x16x32_bf16 v[92:95], a[40:43], a[4:7], v[92:95]
    ds_read_b128 a[4:7], v14 offset:33792
    v_cvt_pk_bf16_f32 v171, v174, v175
    v_mfma_f32_16x16x32_bf16 v[120:123], a[36:39], a[8:11], v[120:123]
    s_add_u32 s62, s94, 18432
    buffer_store_dwordx4 v[168:171], v13, s[28:31], s62 offen offset:0 sc1
    v_mfma_f32_16x16x32_bf16 v[124:127], a[40:43], a[8:11], v[124:127]
    s_waitcnt lgkmcnt(3)
    ds_read_b128 a[8:11], v14 offset:34816
    v_mfma_f32_16x16x32_bf16 v[152:155], a[36:39], a[12:15], v[152:155]
    v_cvt_pk_bf16_f32 v200, v200, v201
    v_cvt_pk_bf16_f32 v201, v202, v203
    v_mfma_f32_16x16x32_bf16 v[156:159], a[40:43], a[12:15], v[156:159]
    ds_read_b128 a[12:15], v14 offset:35840
    v_cvt_pk_bf16_f32 v202, v204, v205
    v_mfma_f32_16x16x32_bf16 v[184:187], a[36:39], a[16:19], v[184:187]
    v_cvt_pk_bf16_f32 v203, v206, v207
    v_cvt_pk_bf16_f32 v232, v232, v233
    v_mfma_f32_16x16x32_bf16 v[188:191], a[40:43], a[16:19], v[188:191]
    ds_read_b128 a[16:19], v14 offset:36864
    v_cvt_pk_bf16_f32 v233, v234, v235
    v_mfma_f32_16x16x32_bf16 v[216:219], a[36:39], a[20:23], v[216:219]
    buffer_store_dwordx4 v[200:203], v13, s[28:31], s62 offen offset:1024 sc1
    v_mfma_f32_16x16x32_bf16 v[220:223], a[40:43], a[20:23], v[220:223]
    s_waitcnt lgkmcnt(5)
    ds_read_b128 a[20:23], v14 offset:37888
    v_mfma_f32_16x16x32_bf16 v[248:251], a[36:39], a[24:27], v[248:251]
    v_cvt_pk_bf16_f32 v234, v236, v237
    v_cvt_pk_bf16_f32 v235, v238, v239
    v_mfma_f32_16x16x32_bf16 v[252:255], a[40:43], a[24:27], v[252:255]
    s_waitcnt lgkmcnt(3)
    ds_read_b128 a[24:27], v14 offset:38912
    v_mfma_f32_16x16x32_bf16 v[56:59], a[44:47], a[0:3], v[56:59]
    buffer_store_dwordx4 v[232:235], v13, s[28:31], s62 offen offset:2048 sc1
    v_mfma_f32_16x16x32_bf16 v[60:63], a[48:51], a[0:3], v[60:63]
    ds_read_b128 a[0:3], v13 offset:7168
    v_cvt_pk_bf16_f32 v24, v40, v41
    v_mfma_f32_16x16x32_bf16 v[88:91], a[44:47], a[4:7], v[88:91]
    v_cvt_pk_bf16_f32 v25, v42, v43
    v_cvt_pk_bf16_f32 v26, v44, v45
    v_mfma_f32_16x16x32_bf16 v[92:95], a[48:51], a[4:7], v[92:95]
    ds_read_b128 a[4:7], v13 offset:8192
    v_cvt_pk_bf16_f32 v27, v46, v47
    v_mfma_f32_16x16x32_bf16 v[120:123], a[44:47], a[8:11], v[120:123]
    s_add_u32 s62, s61, 14336
    buffer_store_dwordx4 v[24:27], v13, s[28:31], s62 offen offset:0 sc1
    v_mfma_f32_16x16x32_bf16 v[124:127], a[48:51], a[8:11], v[124:127]
    s_waitcnt lgkmcnt(3)
    ds_read_b128 a[8:11], v13 offset:9216
    v_mfma_f32_16x16x32_bf16 v[152:155], a[44:47], a[12:15], v[152:155]
    v_cvt_pk_bf16_f32 v80, v80, v81
    v_cvt_pk_bf16_f32 v81, v82, v83
    v_mfma_f32_16x16x32_bf16 v[156:159], a[48:51], a[12:15], v[156:159]
    ds_read_b128 a[12:15], v13 offset:10240
    v_cvt_pk_bf16_f32 v82, v84, v85
    v_mfma_f32_16x16x32_bf16 v[184:187], a[44:47], a[16:19], v[184:187]
    v_cvt_pk_bf16_f32 v83, v86, v87
    v_cvt_pk_bf16_f32 v112, v112, v113
    v_mfma_f32_16x16x32_bf16 v[188:191], a[48:51], a[16:19], v[188:191]
    ds_read_b128 a[16:19], v13 offset:11264
    v_cvt_pk_bf16_f32 v113, v114, v115
    v_mfma_f32_16x16x32_bf16 v[216:219], a[44:47], a[20:23], v[216:219]
    s_add_u32 s62, s94, 28672
    buffer_store_dwordx4 v[80:83], v13, s[28:31], s62 offen offset:1024 sc1
    v_mfma_f32_16x16x32_bf16 v[220:223], a[48:51], a[20:23], v[220:223]
    s_waitcnt lgkmcnt(5)
    ds_read_b128 a[20:23], v13 offset:12288
    v_mfma_f32_16x16x32_bf16 v[248:251], a[44:47], a[24:27], v[248:251]
    v_cvt_pk_bf16_f32 v114, v116, v117
    v_cvt_pk_bf16_f32 v115, v118, v119
    v_mfma_f32_16x16x32_bf16 v[252:255], a[48:51], a[24:27], v[252:255]
    s_waitcnt lgkmcnt(3)
    ds_read_b128 a[24:27], v13 offset:13312
    v_mfma_f32_16x16x32_bf16 v[56:59], a[56:59], a[0:3], v[56:59]
    buffer_store_dwordx4 v[112:115], v13, s[28:31], s62 offen offset:2048 sc1
    v_mfma_f32_16x16x32_bf16 v[60:63], a[60:63], a[0:3], v[60:63]
    ds_read_b128 a[0:3], v13 offset:39936
    v_cvt_pk_bf16_f32 v144, v144, v145
    v_mfma_f32_16x16x32_bf16 v[88:91], a[56:59], a[4:7], v[88:91]
    v_cvt_pk_bf16_f32 v145, v146, v147
    v_cvt_pk_bf16_f32 v146, v148, v149
    v_mfma_f32_16x16x32_bf16 v[92:95], a[60:63], a[4:7], v[92:95]
    ds_read_b128 a[4:7], v13 offset:40960
    v_cvt_pk_bf16_f32 v147, v150, v151
    v_mfma_f32_16x16x32_bf16 v[120:123], a[56:59], a[8:11], v[120:123]
    buffer_store_dwordx4 v[144:147], v13, s[28:31], s62 offen offset:3072 sc1
    v_mfma_f32_16x16x32_bf16 v[124:127], a[60:63], a[8:11], v[124:127]
    s_waitcnt lgkmcnt(3)
    ds_read_b128 a[8:11], v13 offset:41984
    v_mfma_f32_16x16x32_bf16 v[152:155], a[56:59], a[12:15], v[152:155]
    v_cvt_pk_bf16_f32 v176, v176, v177
    v_cvt_pk_bf16_f32 v177, v178, v179
    v_mfma_f32_16x16x32_bf16 v[156:159], a[60:63], a[12:15], v[156:159]
    ds_read_b128 a[12:15], v13 offset:43008
    v_cvt_pk_bf16_f32 v178, v180, v181
    v_mfma_f32_16x16x32_bf16 v[184:187], a[56:59], a[16:19], v[184:187]
    v_cvt_pk_bf16_f32 v179, v182, v183
    v_cvt_pk_bf16_f32 v208, v208, v209
    v_mfma_f32_16x16x32_bf16 v[188:191], a[60:63], a[16:19], v[188:191]
    ds_read_b128 a[16:19], v13 offset:44032
    v_cvt_pk_bf16_f32 v209, v210, v211
    v_mfma_f32_16x16x32_bf16 v[216:219], a[56:59], a[20:23], v[216:219]
    s_add_u32 s62, s94, 32768
    buffer_store_dwordx4 v[176:179], v13, s[28:31], s62 offen offset:0 sc1
    v_mfma_f32_16x16x32_bf16 v[220:223], a[60:63], a[20:23], v[220:223]
    s_waitcnt lgkmcnt(5)
    ds_read_b128 a[20:23], v13 offset:45056
    v_mfma_f32_16x16x32_bf16 v[248:251], a[56:59], a[24:27], v[248:251]
    v_cvt_pk_bf16_f32 v210, v212, v213
    v_cvt_pk_bf16_f32 v211, v214, v215
    v_mfma_f32_16x16x32_bf16 v[252:255], a[60:63], a[24:27], v[252:255]
    s_waitcnt lgkmcnt(3)
    ds_read_b128 a[24:27], v13 offset:46080
    v_mfma_f32_16x16x32_bf16 v[56:59], a[64:67], a[0:3], v[56:59]
    buffer_store_dwordx4 v[208:211], v13, s[28:31], s62 offen offset:1024 sc1
    v_mfma_f32_16x16x32_bf16 v[60:63], a[68:71], a[0:3], v[60:63]
    ds_read_b128 a[0:3], v14 offset:7168
    v_cvt_pk_bf16_f32 v240, v240, v241
    v_mfma_f32_16x16x32_bf16 v[88:91], a[64:67], a[4:7], v[88:91]
    v_cvt_pk_bf16_f32 v241, v242, v243
    v_cvt_pk_bf16_f32 v242, v244, v245
    v_mfma_f32_16x16x32_bf16 v[92:95], a[68:71], a[4:7], v[92:95]
    ds_read_b128 a[4:7], v14 offset:8192
    v_cvt_pk_bf16_f32 v243, v246, v247
    v_mfma_f32_16x16x32_bf16 v[120:123], a[64:67], a[8:11], v[120:123]
    buffer_store_dwordx4 v[240:243], v13, s[28:31], s62 offen offset:2048 sc1
    v_mfma_f32_16x16x32_bf16 v[124:127], a[68:71], a[8:11], v[124:127]
    s_waitcnt lgkmcnt(3)
    ds_read_b128 a[8:11], v14 offset:9216
    v_mfma_f32_16x16x32_bf16 v[152:155], a[64:67], a[12:15], v[152:155]
    v_cvt_pk_bf16_f32 v24, v48, v49
    v_cvt_pk_bf16_f32 v25, v50, v51
    v_mfma_f32_16x16x32_bf16 v[156:159], a[68:71], a[12:15], v[156:159]
    ds_read_b128 a[12:15], v14 offset:10240
    v_cvt_pk_bf16_f32 v26, v52, v53
    v_mfma_f32_16x16x32_bf16 v[184:187], a[64:67], a[16:19], v[184:187]
    v_cvt_pk_bf16_f32 v27, v54, v55
    v_mfma_f32_16x16x32_bf16 v[188:191], a[68:71], a[16:19], v[188:191]
    ds_read_b128 a[16:19], v14 offset:11264
    v_mfma_f32_16x16x32_bf16 v[216:219], a[64:67], a[20:23], v[216:219]
    s_add_u32 s62, s61, 28672
    buffer_store_dwordx4 v[24:27], v13, s[28:31], s62 offen offset:0 sc1
    v_mfma_f32_16x16x32_bf16 v[220:223], a[68:71], a[20:23], v[220:223]
    s_waitcnt lgkmcnt(5)
    ds_read_b128 a[20:23], v14 offset:12288
    v_mfma_f32_16x16x32_bf16 v[248:251], a[64:67], a[24:27], v[248:251]
    v_mfma_f32_16x16x32_bf16 v[252:255], a[68:71], a[24:27], v[252:255]
    s_waitcnt lgkmcnt(3)
    ds_read_b128 a[24:27], v14 offset:13312
    v_mfma_f32_16x16x32_bf16 v[56:59], a[72:75], a[0:3], v[56:59]
    v_mfma_f32_16x16x32_bf16 v[60:63], a[76:79], a[0:3], v[60:63]
    ds_read_b128 a[0:3], v14 offset:39936
    v_mfma_f32_16x16x32_bf16 v[88:91], a[72:75], a[4:7], v[88:91]
    v_mfma_f32_16x16x32_bf16 v[92:95], a[76:79], a[4:7], v[92:95]
    ds_read_b128 a[4:7], v14 offset:40960
    v_mfma_f32_16x16x32_bf16 v[120:123], a[72:75], a[8:11], v[120:123]
    v_mfma_f32_16x16x32_bf16 v[124:127], a[76:79], a[8:11], v[124:127]
    s_waitcnt lgkmcnt(3)
    ds_read_b128 a[8:11], v14 offset:41984
    v_mfma_f32_16x16x32_bf16 v[152:155], a[72:75], a[12:15], v[152:155]
    v_mfma_f32_16x16x32_bf16 v[156:159], a[76:79], a[12:15], v[156:159]
    ds_read_b128 a[12:15], v14 offset:43008
    v_mfma_f32_16x16x32_bf16 v[184:187], a[72:75], a[16:19], v[184:187]
    v_mfma_f32_16x16x32_bf16 v[188:191], a[76:79], a[16:19], v[188:191]
    ds_read_b128 a[16:19], v14 offset:44032
    v_mfma_f32_16x16x32_bf16 v[216:219], a[72:75], a[20:23], v[216:219]
    v_mfma_f32_16x16x32_bf16 v[220:223], a[76:79], a[20:23], v[220:223]
    s_waitcnt lgkmcnt(5)
    ds_read_b128 a[20:23], v14 offset:45056
    v_mfma_f32_16x16x32_bf16 v[248:251], a[72:75], a[24:27], v[248:251]
    v_mfma_f32_16x16x32_bf16 v[252:255], a[76:79], a[24:27], v[252:255]
    s_waitcnt lgkmcnt(3)
    ds_read_b128 a[24:27], v14 offset:46080
    v_mfma_f32_16x16x32_bf16 v[56:59], a[80:83], a[0:3], v[56:59]
    v_mfma_f32_16x16x32_bf16 v[60:63], a[84:87], a[0:3], v[60:63]
    ds_read_b128 a[0:3], v13 offset:14336
    v_mfma_f32_16x16x32_bf16 v[88:91], a[80:83], a[4:7], v[88:91]
    v_mfma_f32_16x16x32_bf16 v[92:95], a[84:87], a[4:7], v[92:95]
    ds_read_b128 a[4:7], v13 offset:15360
    v_mfma_f32_16x16x32_bf16 v[120:123], a[80:83], a[8:11], v[120:123]
    v_mfma_f32_16x16x32_bf16 v[124:127], a[84:87], a[8:11], v[124:127]
    s_waitcnt lgkmcnt(3)
    ds_read_b128 a[8:11], v13 offset:16384
    v_mfma_f32_16x16x32_bf16 v[152:155], a[80:83], a[12:15], v[152:155]
    v_mfma_f32_16x16x32_bf16 v[156:159], a[84:87], a[12:15], v[156:159]
    ds_read_b128 a[12:15], v13 offset:17408
    v_mfma_f32_16x16x32_bf16 v[184:187], a[80:83], a[16:19], v[184:187]
    v_mfma_f32_16x16x32_bf16 v[188:191], a[84:87], a[16:19], v[188:191]
    ds_read_b128 a[16:19], v13 offset:18432
    v_mfma_f32_16x16x32_bf16 v[216:219], a[80:83], a[20:23], v[216:219]
    v_mfma_f32_16x16x32_bf16 v[220:223], a[84:87], a[20:23], v[220:223]
    s_waitcnt lgkmcnt(5)
    ds_read_b128 a[20:23], v13 offset:19456
    v_mfma_f32_16x16x32_bf16 v[248:251], a[80:83], a[24:27], v[248:251]
    v_mfma_f32_16x16x32_bf16 v[252:255], a[84:87], a[24:27], v[252:255]
    s_waitcnt lgkmcnt(3)
    ds_read_b128 a[24:27], v13 offset:20480
    v_mfma_f32_16x16x32_bf16 v[56:59], a[88:91], a[0:3], v[56:59]
    v_mfma_f32_16x16x32_bf16 v[60:63], a[92:95], a[0:3], v[60:63]
    ds_read_b128 a[0:3], v13 offset:47104
    v_mfma_f32_16x16x32_bf16 v[88:91], a[88:91], a[4:7], v[88:91]
    v_mfma_f32_16x16x32_bf16 v[92:95], a[92:95], a[4:7], v[92:95]
    ds_read_b128 a[4:7], v13 offset:48128
    v_mfma_f32_16x16x32_bf16 v[120:123], a[88:91], a[8:11], v[120:123]
    v_mfma_f32_16x16x32_bf16 v[124:127], a[92:95], a[8:11], v[124:127]
    s_waitcnt lgkmcnt(3)
    ds_read_b128 a[8:11], v13 offset:49152
    v_mfma_f32_16x16x32_bf16 v[152:155], a[88:91], a[12:15], v[152:155]
    v_mfma_f32_16x16x32_bf16 v[156:159], a[92:95], a[12:15], v[156:159]
    ds_read_b128 a[12:15], v13 offset:50176
    v_mfma_f32_16x16x32_bf16 v[184:187], a[88:91], a[16:19], v[184:187]
    v_mfma_f32_16x16x32_bf16 v[188:191], a[92:95], a[16:19], v[188:191]
    ds_read_b128 a[16:19], v13 offset:51200
    v_mfma_f32_16x16x32_bf16 v[216:219], a[88:91], a[20:23], v[216:219]
    v_mfma_f32_16x16x32_bf16 v[220:223], a[92:95], a[20:23], v[220:223]
    s_waitcnt lgkmcnt(5)
    ds_read_b128 a[20:23], v13 offset:52224
    v_mfma_f32_16x16x32_bf16 v[248:251], a[88:91], a[24:27], v[248:251]
    v_mfma_f32_16x16x32_bf16 v[252:255], a[92:95], a[24:27], v[252:255]
    s_waitcnt lgkmcnt(3)
    ds_read_b128 a[24:27], v13 offset:53248
    v_mfma_f32_16x16x32_bf16 v[56:59], a[96:99], a[0:3], v[56:59]
    v_mfma_f32_16x16x32_bf16 v[60:63], a[100:103], a[0:3], v[60:63]
    ds_read_b128 a[0:3], v14 offset:14336
    v_mfma_f32_16x16x32_bf16 v[88:91], a[96:99], a[4:7], v[88:91]
    v_mfma_f32_16x16x32_bf16 v[92:95], a[100:103], a[4:7], v[92:95]
    ds_read_b128 a[4:7], v14 offset:15360
    v_mfma_f32_16x16x32_bf16 v[120:123], a[96:99], a[8:11], v[120:123]
    v_mfma_f32_16x16x32_bf16 v[124:127], a[100:103], a[8:11], v[124:127]
    s_waitcnt lgkmcnt(3)
    ds_read_b128 a[8:11], v14 offset:16384
    v_mfma_f32_16x16x32_bf16 v[152:155], a[96:99], a[12:15], v[152:155]
    v_mfma_f32_16x16x32_bf16 v[156:159], a[100:103], a[12:15], v[156:159]
    ds_read_b128 a[12:15], v14 offset:17408
    v_mfma_f32_16x16x32_bf16 v[184:187], a[96:99], a[16:19], v[184:187]
    v_mfma_f32_16x16x32_bf16 v[188:191], a[100:103], a[16:19], v[188:191]
    ds_read_b128 a[16:19], v14 offset:18432
    v_mfma_f32_16x16x32_bf16 v[216:219], a[96:99], a[20:23], v[216:219]
    v_mfma_f32_16x16x32_bf16 v[220:223], a[100:103], a[20:23], v[220:223]
    s_waitcnt lgkmcnt(5)
    ds_read_b128 a[20:23], v14 offset:19456
    v_mfma_f32_16x16x32_bf16 v[248:251], a[96:99], a[24:27], v[248:251]
    v_mfma_f32_16x16x32_bf16 v[252:255], a[100:103], a[24:27], v[252:255]
    s_waitcnt lgkmcnt(3)
    ds_read_b128 a[24:27], v14 offset:20480
    v_mfma_f32_16x16x32_bf16 v[56:59], a[104:107], a[0:3], v[56:59]
    v_mfma_f32_16x16x32_bf16 v[60:63], a[108:111], a[0:3], v[60:63]
    ds_read_b128 a[0:3], v14 offset:47104
    v_mfma_f32_16x16x32_bf16 v[88:91], a[104:107], a[4:7], v[88:91]
    v_mfma_f32_16x16x32_bf16 v[92:95], a[108:111], a[4:7], v[92:95]
    ds_read_b128 a[4:7], v14 offset:48128
    v_mfma_f32_16x16x32_bf16 v[120:123], a[104:107], a[8:11], v[120:123]
    v_mfma_f32_16x16x32_bf16 v[124:127], a[108:111], a[8:11], v[124:127]
    s_waitcnt lgkmcnt(3)
    ds_read_b128 a[8:11], v14 offset:49152
    v_mfma_f32_16x16x32_bf16 v[152:155], a[104:107], a[12:15], v[152:155]
    v_mfma_f32_16x16x32_bf16 v[156:159], a[108:111], a[12:15], v[156:159]
    ds_read_b128 a[12:15], v14 offset:50176
    v_mfma_f32_16x16x32_bf16 v[184:187], a[104:107], a[16:19], v[184:187]
    v_mfma_f32_16x16x32_bf16 v[188:191], a[108:111], a[16:19], v[188:191]
    ds_read_b128 a[16:19], v14 offset:51200
    v_mfma_f32_16x16x32_bf16 v[216:219], a[104:107], a[20:23], v[216:219]
    v_mfma_f32_16x16x32_bf16 v[220:223], a[108:111], a[20:23], v[220:223]
    s_waitcnt lgkmcnt(5)
    ds_read_b128 a[20:23], v14 offset:52224
    v_mfma_f32_16x16x32_bf16 v[248:251], a[104:107], a[24:27], v[248:251]
    v_mfma_f32_16x16x32_bf16 v[252:255], a[108:111], a[24:27], v[252:255]
    s_waitcnt lgkmcnt(3)
    ds_read_b128 a[24:27], v14 offset:53248
    v_mfma_f32_16x16x32_bf16 v[56:59], a[112:115], a[0:3], v[56:59]
    v_mfma_f32_16x16x32_bf16 v[60:63], a[116:119], a[0:3], v[60:63]
    ds_read_b128 a[0:3], v13 offset:21504
    v_mfma_f32_16x16x32_bf16 v[88:91], a[112:115], a[4:7], v[88:91]
    v_mfma_f32_16x16x32_bf16 v[92:95], a[116:119], a[4:7], v[92:95]
    ds_read_b128 a[4:7], v13 offset:22528
    v_mfma_f32_16x16x32_bf16 v[120:123], a[112:115], a[8:11], v[120:123]
    v_mfma_f32_16x16x32_bf16 v[124:127], a[116:119], a[8:11], v[124:127]
    s_waitcnt lgkmcnt(3)
    ds_read_b128 a[8:11], v13 offset:23552
    v_mfma_f32_16x16x32_bf16 v[152:155], a[112:115], a[12:15], v[152:155]
    v_mfma_f32_16x16x32_bf16 v[156:159], a[116:119], a[12:15], v[156:159]
    ds_read_b128 a[12:15], v13 offset:24576
    v_mfma_f32_16x16x32_bf16 v[184:187], a[112:115], a[16:19], v[184:187]
    v_mfma_f32_16x16x32_bf16 v[188:191], a[116:119], a[16:19], v[188:191]
    ds_read_b128 a[16:19], v13 offset:25600
    v_mfma_f32_16x16x32_bf16 v[216:219], a[112:115], a[20:23], v[216:219]
    v_mfma_f32_16x16x32_bf16 v[220:223], a[116:119], a[20:23], v[220:223]
    s_waitcnt lgkmcnt(5)
    ds_read_b128 a[20:23], v13 offset:26624
    v_mfma_f32_16x16x32_bf16 v[248:251], a[112:115], a[24:27], v[248:251]
    v_mfma_f32_16x16x32_bf16 v[252:255], a[116:119], a[24:27], v[252:255]
    s_waitcnt lgkmcnt(3)
    ds_read_b128 a[24:27], v13 offset:27648
    v_mfma_f32_16x16x32_bf16 v[56:59], a[120:123], a[0:3], v[56:59]
    v_mfma_f32_16x16x32_bf16 v[60:63], a[124:127], a[0:3], v[60:63]
    ds_read_b128 a[0:3], v13 offset:54272
    v_mfma_f32_16x16x32_bf16 v[88:91], a[120:123], a[4:7], v[88:91]
    v_mfma_f32_16x16x32_bf16 v[92:95], a[124:127], a[4:7], v[92:95]
    ds_read_b128 a[4:7], v13 offset:55296
    v_mfma_f32_16x16x32_bf16 v[120:123], a[120:123], a[8:11], v[120:123]
    v_mfma_f32_16x16x32_bf16 v[124:127], a[124:127], a[8:11], v[124:127]
    s_waitcnt lgkmcnt(3)
    ds_read_b128 a[8:11], v13 offset:56320
    v_mfma_f32_16x16x32_bf16 v[152:155], a[120:123], a[12:15], v[152:155]
    v_mfma_f32_16x16x32_bf16 v[156:159], a[124:127], a[12:15], v[156:159]
    ds_read_b128 a[12:15], v13 offset:57344
    v_mfma_f32_16x16x32_bf16 v[184:187], a[120:123], a[16:19], v[184:187]
    v_mfma_f32_16x16x32_bf16 v[188:191], a[124:127], a[16:19], v[188:191]
    ds_read_b128 a[16:19], v13 offset:58368
    v_mfma_f32_16x16x32_bf16 v[216:219], a[120:123], a[20:23], v[216:219]
    v_mfma_f32_16x16x32_bf16 v[220:223], a[124:127], a[20:23], v[220:223]
    s_waitcnt lgkmcnt(5)
    ds_read_b128 a[20:23], v13 offset:59392
    v_mfma_f32_16x16x32_bf16 v[248:251], a[120:123], a[24:27], v[248:251]
    v_mfma_f32_16x16x32_bf16 v[252:255], a[124:127], a[24:27], v[252:255]
    s_waitcnt lgkmcnt(3)
    ds_read_b128 a[24:27], v13 offset:60416
    v_mfma_f32_16x16x32_bf16 v[56:59], a[128:131], a[0:3], v[56:59]
    v_mfma_f32_16x16x32_bf16 v[60:63], a[132:135], a[0:3], v[60:63]
    ds_read_b128 a[0:3], v14 offset:21504
    v_mfma_f32_16x16x32_bf16 v[88:91], a[128:131], a[4:7], v[88:91]
    v_mfma_f32_16x16x32_bf16 v[92:95], a[132:135], a[4:7], v[92:95]
    ds_read_b128 a[4:7], v14 offset:22528
    v_mfma_f32_16x16x32_bf16 v[120:123], a[128:131], a[8:11], v[120:123]
    v_mfma_f32_16x16x32_bf16 v[124:127], a[132:135], a[8:11], v[124:127]
    s_waitcnt lgkmcnt(3)
    ds_read_b128 a[8:11], v14 offset:23552
    v_mfma_f32_16x16x32_bf16 v[152:155], a[128:131], a[12:15], v[152:155]
    s_waitcnt vmcnt(0)
    s_barrier
    buffer_store_dword v9, v28, s[36:39], s45 offen offset:0 sc1
    v_mfma_f32_16x16x32_bf16 v[156:159], a[132:135], a[12:15], v[156:159]
    ds_read_b128 a[12:15], v14 offset:24576
    v_mfma_f32_16x16x32_bf16 v[184:187], a[128:131], a[16:19], v[184:187]
    v_mfma_f32_16x16x32_bf16 v[188:191], a[132:135], a[16:19], v[188:191]
    ds_read_b128 a[16:19], v14 offset:25600
    v_mfma_f32_16x16x32_bf16 v[216:219], a[128:131], a[20:23], v[216:219]
    v_mfma_f32_16x16x32_bf16 v[220:223], a[132:135], a[20:23], v[220:223]
    s_waitcnt lgkmcnt(5)
    ds_read_b128 a[20:23], v14 offset:26624
    v_mfma_f32_16x16x32_bf16 v[248:251], a[128:131], a[24:27], v[248:251]
    v_mfma_f32_16x16x32_bf16 v[252:255], a[132:135], a[24:27], v[252:255]
    s_waitcnt lgkmcnt(3)
    ds_read_b128 a[24:27], v14 offset:27648
    v_mfma_f32_16x16x32_bf16 v[56:59], a[136:139], a[0:3], v[56:59]
    v_mfma_f32_16x16x32_bf16 v[60:63], a[140:143], a[0:3], v[60:63]
    ds_read_b128 a[0:3], v14 offset:54272
    v_mfma_f32_16x16x32_bf16 v[88:91], a[136:139], a[4:7], v[88:91]
    v_mfma_f32_16x16x32_bf16 v[92:95], a[140:143], a[4:7], v[92:95]
    ds_read_b128 a[4:7], v14 offset:55296
    v_mfma_f32_16x16x32_bf16 v[120:123], a[136:139], a[8:11], v[120:123]
    v_mfma_f32_16x16x32_bf16 v[124:127], a[140:143], a[8:11], v[124:127]
    s_waitcnt lgkmcnt(3)
    ds_read_b128 a[8:11], v14 offset:56320
    v_mfma_f32_16x16x32_bf16 v[152:155], a[136:139], a[12:15], v[152:155]
    v_mfma_f32_16x16x32_bf16 v[156:159], a[140:143], a[12:15], v[156:159]
    ds_read_b128 a[12:15], v14 offset:57344
    v_mfma_f32_16x16x32_bf16 v[184:187], a[136:139], a[16:19], v[184:187]
    v_mfma_f32_16x16x32_bf16 v[188:191], a[140:143], a[16:19], v[188:191]
    ds_read_b128 a[16:19], v14 offset:58368
    v_mfma_f32_16x16x32_bf16 v[216:219], a[136:139], a[20:23], v[216:219]
    v_mfma_f32_16x16x32_bf16 v[220:223], a[140:143], a[20:23], v[220:223]
    s_waitcnt lgkmcnt(5)
    ds_read_b128 a[20:23], v14 offset:59392
    v_mfma_f32_16x16x32_bf16 v[248:251], a[136:139], a[24:27], v[248:251]
    v_mfma_f32_16x16x32_bf16 v[252:255], a[140:143], a[24:27], v[252:255]
    s_waitcnt lgkmcnt(3)
    ds_read_b128 a[24:27], v14 offset:60416
    v_mfma_f32_16x16x32_bf16 v[56:59], a[144:147], a[0:3], v[56:59]
    v_mfma_f32_16x16x32_bf16 v[60:63], a[148:151], a[0:3], v[60:63]
    v_mfma_f32_16x16x32_bf16 v[88:91], a[144:147], a[4:7], v[88:91]
    buffer_load_dword v11, v10, s[36:39], s47 offen offset:0 sc1
    v_mfma_f32_16x16x32_bf16 v[92:95], a[148:151], a[4:7], v[92:95]
    v_mfma_f32_16x16x32_bf16 v[120:123], a[144:147], a[8:11], v[120:123]
    v_mfma_f32_16x16x32_bf16 v[124:127], a[148:151], a[8:11], v[124:127]
    s_waitcnt lgkmcnt(1)
    v_mfma_f32_16x16x32_bf16 v[152:155], a[144:147], a[12:15], v[152:155]
    v_mfma_f32_16x16x32_bf16 v[156:159], a[148:151], a[12:15], v[156:159]
    v_mfma_f32_16x16x32_bf16 v[184:187], a[144:147], a[16:19], v[184:187]
    v_mfma_f32_16x16x32_bf16 v[188:191], a[148:151], a[16:19], v[188:191]
    v_mfma_f32_16x16x32_bf16 v[216:219], a[144:147], a[20:23], v[216:219]
    v_mfma_f32_16x16x32_bf16 v[220:223], a[148:151], a[20:23], v[220:223]
    s_waitcnt lgkmcnt(0)
    v_mfma_f32_16x16x32_bf16 v[248:251], a[144:147], a[24:27], v[248:251]
    v_mfma_f32_16x16x32_bf16 v[252:255], a[148:151], a[24:27], v[252:255]
    s_lshl_b32 s48, s7, 2
    s_add_u32 s48, s48, s4
    v_mov_b32 v9, 2
    v_mov_b32 v2, 256
    v_mov_b32 v3, 0
    s_cmp_eq_u32 s4, 0
    s_cselect_b32 s60, 1, 0
    s_cselect_b32 s50, s68, 0x40000000
    s_nop 1
    v_cvt_pk_bf16_f32 v88, v88, v89
    v_cvt_pk_bf16_f32 v89, v90, v91
    v_cvt_pk_bf16_f32 v90, v92, v93
    v_cvt_pk_bf16_f32 v91, v94, v95
    s_add_u32 s62, s94, 43008
    buffer_store_dwordx4 v[88:91], v13, s[28:31], s62 offen offset:1024 sc1
    v_cvt_pk_bf16_f32 v120, v120, v121
    v_cvt_pk_bf16_f32 v121, v122, v123
    v_cvt_pk_bf16_f32 v122, v124, v125
    v_cvt_pk_bf16_f32 v123, v126, v127
    buffer_store_dwordx4 v[120:123], v13, s[28:31], s62 offen offset:2048 sc1
    v_cvt_pk_bf16_f32 v152, v152, v153
    v_cvt_pk_bf16_f32 v153, v154, v155
    v_cvt_pk_bf16_f32 v154, v156, v157
    v_cvt_pk_bf16_f32 v155, v158, v159
    buffer_store_dwordx4 v[152:155], v13, s[28:31], s62 offen offset:3072 sc1
    v_cvt_pk_bf16_f32 v184, v184, v185
    v_cvt_pk_bf16_f32 v185, v186, v187
    v_cvt_pk_bf16_f32 v186, v188, v189
    v_cvt_pk_bf16_f32 v187, v190, v191
    s_add_u32 s62, s94, 47104
    buffer_store_dwordx4 v[184:187], v13, s[28:31], s62 offen offset:0 sc1
    v_cvt_pk_bf16_f32 v216, v216, v217
    v_cvt_pk_bf16_f32 v217, v218, v219
    v_cvt_pk_bf16_f32 v218, v220, v221
    v_cvt_pk_bf16_f32 v219, v222, v223
    buffer_store_dwordx4 v[216:219], v13, s[28:31], s62 offen offset:1024 sc1
    v_cvt_pk_bf16_f32 v248, v248, v249
    v_cvt_pk_bf16_f32 v249, v250, v251
    v_cvt_pk_bf16_f32 v250, v252, v253
    v_cvt_pk_bf16_f32 v251, v254, v255
    buffer_store_dwordx4 v[248:251], v13, s[28:31], s62 offen offset:2048 sc1
    v_cvt_pk_bf16_f32 v24, v56, v57
    v_cvt_pk_bf16_f32 v25, v58, v59
    v_cvt_pk_bf16_f32 v26, v60, v61
    v_cvt_pk_bf16_f32 v27, v62, v63
    s_add_u32 s62, s61, 43008
    buffer_store_dwordx4 v[24:27], v13, s[28:31], s62 offen offset:0 sc1
    s_mul_i32 s3, s44, 1792
    s_mul_i32 s57, s4, 56
    s_add_u32 s3, s3, s57
    s_add_u32 s3, s3, s7
    s_lshl_b32 s3, s3, 10
    s_cmp_eq_u32 s7, 7
    s_cselect_b32 s3, 0x70000000, s3
    s_add_u32 s16, s3, 0
    s_cmp_eq_u32 s7, 0
    s_cselect_b32 s16, 0x70000000, s16
    s_add_u32 s17, s3, 229376
    s_cmp_lt_u32 s7, 1
    s_cselect_b32 s57, 7168, 0
    s_add_u32 s17, s17, s57
    s_cmp_eq_u32 s7, 1
    s_cselect_b32 s17, 0x70000000, s17
    s_add_u32 s18, s3, 458752
    s_cmp_lt_u32 s7, 2
    s_cselect_b32 s57, 7168, 0
    s_add_u32 s18, s18, s57
    s_cmp_eq_u32 s7, 2
    s_cselect_b32 s18, 0x70000000, s18
    s_add_u32 s19, s3, 688128
    s_cmp_lt_u32 s7, 3
    s_cselect_b32 s57, 7168, 0
    s_add_u32 s19, s19, s57
    s_cmp_eq_u32 s7, 3
    s_cselect_b32 s19, 0x70000000, s19
    s_add_u32 s20, s3, 917504
    s_cmp_lt_u32 s7, 4
    s_cselect_b32 s57, 7168, 0
    s_add_u32 s20, s20, s57
    s_cmp_eq_u32 s7, 4
    s_cselect_b32 s20, 0x70000000, s20
    s_add_u32 s21, s3, 1146880
    s_cmp_lt_u32 s7, 5
    s_cselect_b32 s57, 7168, 0
    s_add_u32 s21, s21, s57
    s_cmp_eq_u32 s7, 5
    s_cselect_b32 s21, 0x70000000, s21
    s_add_u32 s22, s3, 1376256
    s_cmp_lt_u32 s7, 6
    s_cselect_b32 s57, 7168, 0
    s_add_u32 s22, s22, s57
    s_cmp_eq_u32 s7, 6
    s_cselect_b32 s22, 0x70000000, s22
    s_add_u32 s23, s3, 1605632
    s_cmp_eq_u32 s7, 7
    s_cselect_b32 s23, 0x70000000, s23
    s_mul_i32 s57, s44, 112
    s_lshl_b32 s58, s7, 4
    s_add_u32 s57, s57, s58
    s_lshl_b32 s57, s57, 10
    s_lshl_b32 s58, s4, 8
    s_add_u32 s51, s57, s58
    s_cmp_eq_u32 s7, 7
    s_cselect_b32 s51, 0x70000000, s51
    s_cmp_lg_u32 s35, 0
    s_cbranch_scc1 L_slow1
    s_waitcnt vmcnt(7)
    v_cmp_le_u32 vcc, 1, v11
    s_mov_b32 s55, 4096
    s_nop 0
    s_cmp_eq_u32 vcc_lo, 0xff
    s_cbranch_scc1 L_p1_ok
L_p1_l:
    s_sub_u32 s55, s55, 1
    s_cbranch_scc1 L_slow1
    s_sleep 8
    buffer_load_dword v11, v10, s[36:39], s47 offen sc1
    s_waitcnt vmcnt(0)
    v_cmp_le_u32 vcc, 1, v11
    s_nop 1
    s_cmp_eq_u32 vcc_lo, 0xff
    s_cbranch_scc0 L_p1_l
L_p1_ok:
    s_add_u32 s57, s16, 0
    buffer_load_dwordx4 v[64:67], v13, s[28:31], s57 offen offset:0 sc1
    s_add_u32 s57, s17, 0
    buffer_load_dwordx4 v[68:71], v13, s[28:31], s57 offen offset:0 sc1
    s_add_u32 s57, s18, 0
    buffer_load_dwordx4 v[72:75], v13, s[28:31], s57 offen offset:0 sc1
    s_add_u32 s57, s19, 0
    buffer_load_dwordx4 v[76:79], v13, s[28:31], s57 offen offset:0 sc1
    s_add_u32 s57, s20, 0
    buffer_load_dwordx4 v[80:83], v13, s[28:31], s57 offen offset:0 sc1
    s_add_u32 s57, s21, 0
    buffer_load_dwordx4 v[84:87], v13, s[28:31], s57 offen offset:0 sc1
    s_add_u32 s57, s22, 0
    buffer_load_dwordx4 v[96:99], v13, s[28:31], s57 offen offset:0 sc1
    s_add_u32 s57, s23, 0
    buffer_load_dwordx4 v[100:103], v13, s[28:31], s57 offen offset:0 sc1
    s_add_u32 s57, s16, 14336
    buffer_load_dwordx4 v[104:107], v13, s[28:31], s57 offen offset:0 sc1
    s_add_u32 s57, s17, 14336
    buffer_load_dwordx4 v[108:111], v13, s[28:31], s57 offen offset:0 sc1
    s_add_u32 s57, s18, 14336
    buffer_load_dwordx4 v[112:115], v13, s[28:31], s57 offen offset:0 sc1
    s_add_u32 s57, s19, 14336
    buffer_load_dwordx4 v[116:119], v13, s[28:31], s57 offen offset:0 sc1
    s_add_u32 s57, s20, 14336
    buffer_load_dwordx4 v[128:131], v13, s[28:31], s57 offen offset:0 sc1
    s_add_u32 s57, s21, 14336
    buffer_load_dwordx4 v[132:135], v13, s[28:31], s57 offen offset:0 sc1
    s_add_u32 s57, s22, 14336
    buffer_load_dwordx4 v[136:139], v13, s[28:31], s57 offen offset:0 sc1
    s_add_u32 s57, s23, 14336
    buffer_load_dwordx4 v[140:143], v13, s[28:31], s57 offen offset:0 sc1
    s_add_u32 s57, s16, 28672
    buffer_load_dwordx4 v[144:147], v13, s[28:31], s57 offen offset:0 sc1
    s_add_u32 s57, s17, 28672
    buffer_load_dwordx4 v[148:151], v13, s[28:31], s57 offen offset:0 sc1
    s_add_u32 s57, s18, 28672
    buffer_load_dwordx4 v[160:163], v13, s[28:31], s57 offen offset:0 sc1
    s_add_u32 s57, s19, 28672
    buffer_load_dwordx4 v[164:167], v13, s[28:31], s57 offen offset:0 sc1
    s_add_u32 s57, s20, 28672
    buffer_load_dwordx4 v[168:171], v13, s[28:31], s57 offen offset:0 sc1
    s_add_u32 s57, s21, 28672
    buffer_load_dwordx4 v[172:175], v13, s[28:31], s57 offen offset:0 sc1
    s_add_u32 s57, s22, 28672
    buffer_load_dwordx4 v[176:179], v13, s[28:31], s57 offen offset:0 sc1
    s_add_u32 s57, s23, 28672
    buffer_load_dwordx4 v[180:183], v13, s[28:31], s57 offen offset:0 sc1
    s_waitcnt vmcnt(24)
    s_barrier
    buffer_store_dword v9, v28, s[36:39], s45 offen offset:0 sc1
    buffer_atomic_add_x2 v[2:3], v28, s[40:43], s50 offen sc0 sc1
    s_waitcnt vmcnt(25)
    v_lshlrev_b32 v232, 16, v64
    v_and_b32 v233, 4294901760, v64
    v_lshlrev_b32 v234, 16, v65
    v_and_b32 v235, 4294901760, v65
    v_lshlrev_b32 v236, 16, v66
    v_and_b32 v237, 4294901760, v66
    v_lshlrev_b32 v238, 16, v67
    v_and_b32 v239, 4294901760, v67
    v_pk_add_f32 v[240:241], v[32:33], v[232:233]
    v_pk_add_f32 v[242:243], v[34:35], v[234:235]
    v_pk_add_f32 v[244:245], v[36:37], v[236:237]
    v_pk_add_f32 v[246:247], v[38:39], v[238:239]
    s_waitcnt vmcnt(24)
    v_lshlrev_b32 v232, 16, v68
    v_and_b32 v233, 4294901760, v68
    v_lshlrev_b32 v234, 16, v69
    v_and_b32 v235, 4294901760, v69
    v_lshlrev_b32 v236, 16, v70
    v_and_b32 v237, 4294901760, v70
    v_lshlrev_b32 v238, 16, v71
    v_and_b32 v239, 4294901760, v71
    v_pk_add_f32 v[240:241], v[240:241], v[232:233]
    v_pk_add_f32 v[242:243], v[242:243], v[234:235]
    v_pk_add_f32 v[244:245], v[244:245], v[236:237]
    v_pk_add_f32 v[246:247], v[246:247], v[238:239]
    s_waitcnt vmcnt(23)
    v_lshlrev_b32 v232, 16, v72
    v_and_b32 v233, 4294901760, v72
    v_lshlrev_b32 v234, 16, v73
    v_and_b32 v235, 4294901760, v73
    v_lshlrev_b32 v236, 16, v74
    v_and_b32 v237, 4294901760, v74
    v_lshlrev_b32 v238, 16, v75
    v_and_b32 v239, 4294901760, v75
    v_pk_add_f32 v[240:241], v[240:241], v[232:233]
    v_pk_add_f32 v[242:243], v[242:243], v[234:235]
    v_pk_add_f32 v[244:245], v[244:245], v[236:237]
    v_pk_add_f32 v[246:247], v[246:247], v[238:239]
    s_waitcnt vmcnt(22)
    v_lshlrev_b32 v232, 16, v76
    v_and_b32 v233, 4294901760, v76
    v_lshlrev_b32 v234, 16, v77
    v_and_b32 v235, 4294901760, v77
    v_lshlrev_b32 v236, 16, v78
    v_and_b32 v237, 4294901760, v78
    v_lshlrev_b32 v238, 16, v79
    v_and_b32 v239, 4294901760, v79
    v_pk_add_f32 v[240:241], v[240:241], v[232:233]
    v_pk_add_f32 v[242:243], v[242:243], v[234:235]
    v_pk_add_f32 v[244:245], v[244:245], v[236:237]
    v_pk_add_f32 v[246:247], v[246:247], v[238:239]
    s_waitcnt vmcnt(21)
    v_lshlrev_b32 v232, 16, v80
    v_and_b32 v233, 4294901760, v80
    v_lshlrev_b32 v234, 16, v81
    v_and_b32 v235, 4294901760, v81
    v_lshlrev_b32 v236, 16, v82
    v_and_b32 v237, 4294901760, v82
    v_lshlrev_b32 v238, 16, v83
    v_and_b32 v239, 4294901760, v83
    v_pk_add_f32 v[240:241], v[240:241], v[232:233]
    v_pk_add_f32 v[242:243], v[242:243], v[234:235]
    v_pk_add_f32 v[244:245], v[244:245], v[236:237]
    v_pk_add_f32 v[246:247], v[246:247], v[238:239]
    s_waitcnt vmcnt(20)
    v_lshlrev_b32 v232, 16, v84
    v_and_b32 v233, 4294901760, v84
    v_lshlrev_b32 v234, 16, v85
    v_and_b32 v235, 4294901760, v85
    v_lshlrev_b32 v236, 16, v86
    v_and_b32 v237, 4294901760, v86
    v_lshlrev_b32 v238, 16, v87
    v_and_b32 v239, 4294901760, v87
    v_pk_add_f32 v[240:241], v[240:241], v[232:233]
    v_pk_add_f32 v[242:243], v[242:243], v[234:235]
    v_pk_add_f32 v[244:245], v[244:245], v[236:237]
    v_pk_add_f32 v[246:247], v[246:247], v[238:239]
    s_waitcnt vmcnt(19)
    v_lshlrev_b32 v232, 16, v96
    v_and_b32 v233, 4294901760, v96
    v_lshlrev_b32 v234, 16, v97
    v_and_b32 v235, 4294901760, v97
    v_lshlrev_b32 v236, 16, v98
    v_and_b32 v237, 4294901760, v98
    v_lshlrev_b32 v238, 16, v99
    v_and_b32 v239, 4294901760, v99
    v_pk_add_f32 v[240:241], v[240:241], v[232:233]
    v_pk_add_f32 v[242:243], v[242:243], v[234:235]
    v_pk_add_f32 v[244:245], v[244:245], v[236:237]
    v_pk_add_f32 v[246:247], v[246:247], v[238:239]
    s_waitcnt vmcnt(18)
    v_lshlrev_b32 v232, 16, v100
    v_and_b32 v233, 4294901760, v100
    v_lshlrev_b32 v234, 16, v101
    v_and_b32 v235, 4294901760, v101
    v_lshlrev_b32 v236, 16, v102
    v_and_b32 v237, 4294901760, v102
    v_lshlrev_b32 v238, 16, v103
    v_and_b32 v239, 4294901760, v103
    v_pk_add_f32 v[240:241], v[240:241], v[232:233]
    v_pk_add_f32 v[242:243], v[242:243], v[234:235]
    v_pk_add_f32 v[244:245], v[244:245], v[236:237]
    v_pk_add_f32 v[246:247], v[246:247], v[238:239]
    v_cvt_pk_bf16_f32 v64, v240, v241
    v_cvt_pk_bf16_f32 v65, v242, v243
    v_cvt_pk_bf16_f32 v66, v244, v245
    v_cvt_pk_bf16_f32 v67, v246, v247
    buffer_store_dwordx2 v[64:65], v12, s[8:11], s51 offen offset:0
    buffer_store_dwordx2 v[66:67], v12, s[8:11], s51 offen offset:32
    s_waitcnt vmcnt(19)
    v_lshlrev_b32 v232, 16, v104
    v_and_b32 v233, 4294901760, v104
    v_lshlrev_b32 v234, 16, v105
    v_and_b32 v235, 4294901760, v105
    v_lshlrev_b32 v236, 16, v106
    v_and_b32 v237, 4294901760, v106
    v_lshlrev_b32 v238, 16, v107
    v_and_b32 v239, 4294901760, v107
    v_pk_add_f32 v[240:241], v[40:41], v[232:233]
    v_pk_add_f32 v[242:243], v[42:43], v[234:235]
    v_pk_add_f32 v[244:245], v[44:45], v[236:237]
    v_pk_add_f32 v[246:247], v[46:47], v[238:239]
    s_waitcnt vmcnt(18)
    v_lshlrev_b32 v232, 16, v108
    v_and_b32 v233, 4294901760, v108
    v_lshlrev_b32 v234, 16, v109
    v_and_b32 v235, 4294901760, v109
    v_lshlrev_b32 v236, 16, v110
    v_and_b32 v237, 4294901760, v110
    v_lshlrev_b32 v238, 16, v111
    v_and_b32 v239, 4294901760, v111
    v_pk_add_f32 v[240:241], v[240:241], v[232:233]
    v_pk_add_f32 v[242:243], v[242:243], v[234:235]
    v_pk_add_f32 v[244:245], v[244:245], v[236:237]
    v_pk_add_f32 v[246:247], v[246:247], v[238:239]
    s_waitcnt vmcnt(17)
    v_lshlrev_b32 v232, 16, v112
    v_and_b32 v233, 4294901760, v112
    v_lshlrev_b32 v234, 16, v113
    v_and_b32 v235, 4294901760, v113
    v_lshlrev_b32 v236, 16, v114
    v_and_b32 v237, 4294901760, v114
    v_lshlrev_b32 v238, 16, v115
    v_and_b32 v239, 4294901760, v115
    v_pk_add_f32 v[240:241], v[240:241], v[232:233]
    v_pk_add_f32 v[242:243], v[242:243], v[234:235]
    v_pk_add_f32 v[244:245], v[244:245], v[236:237]
    v_pk_add_f32 v[246:247], v[246:247], v[238:239]
    s_waitcnt vmcnt(16)
    v_lshlrev_b32 v232, 16, v116
    v_and_b32 v233, 4294901760, v116
    v_lshlrev_b32 v234, 16, v117
    v_and_b32 v235, 4294901760, v117
    v_lshlrev_b32 v236, 16, v118
    v_and_b32 v237, 4294901760, v118
    v_lshlrev_b32 v238, 16, v119
    v_and_b32 v239, 4294901760, v119
    v_pk_add_f32 v[240:241], v[240:241], v[232:233]
    v_pk_add_f32 v[242:243], v[242:243], v[234:235]
    v_pk_add_f32 v[244:245], v[244:245], v[236:237]
    v_pk_add_f32 v[246:247], v[246:247], v[238:239]
    s_waitcnt vmcnt(15)
    v_lshlrev_b32 v232, 16, v128
    v_and_b32 v233, 4294901760, v128
    v_lshlrev_b32 v234, 16, v129
    v_and_b32 v235, 4294901760, v129
    v_lshlrev_b32 v236, 16, v130
    v_and_b32 v237, 4294901760, v130
    v_lshlrev_b32 v238, 16, v131
    v_and_b32 v239, 4294901760, v131
    v_pk_add_f32 v[240:241], v[240:241], v[232:233]
    v_pk_add_f32 v[242:243], v[242:243], v[234:235]
    v_pk_add_f32 v[244:245], v[244:245], v[236:237]
    v_pk_add_f32 v[246:247], v[246:247], v[238:239]
    s_waitcnt vmcnt(14)
    v_lshlrev_b32 v232, 16, v132
    v_and_b32 v233, 4294901760, v132
    v_lshlrev_b32 v234, 16, v133
    v_and_b32 v235, 4294901760, v133
    v_lshlrev_b32 v236, 16, v134
    v_and_b32 v237, 4294901760, v134
    v_lshlrev_b32 v238, 16, v135
    v_and_b32 v239, 4294901760, v135
    v_pk_add_f32 v[240:241], v[240:241], v[232:233]
    v_pk_add_f32 v[242:243], v[242:243], v[234:235]
    v_pk_add_f32 v[244:245], v[244:245], v[236:237]
    v_pk_add_f32 v[246:247], v[246:247], v[238:239]
    s_waitcnt vmcnt(13)
    v_lshlrev_b32 v232, 16, v136
    v_and_b32 v233, 4294901760, v136
    v_lshlrev_b32 v234, 16, v137
    v_and_b32 v235, 4294901760, v137
    v_lshlrev_b32 v236, 16, v138
    v_and_b32 v237, 4294901760, v138
    v_lshlrev_b32 v238, 16, v139
    v_and_b32 v239, 4294901760, v139
    v_pk_add_f32 v[240:241], v[240:241], v[232:233]
    v_pk_add_f32 v[242:243], v[242:243], v[234:235]
    v_pk_add_f32 v[244:245], v[244:245], v[236:237]
    v_pk_add_f32 v[246:247], v[246:247], v[238:239]
    s_waitcnt vmcnt(12)
    v_lshlrev_b32 v232, 16, v140
    v_and_b32 v233, 4294901760, v140
    v_lshlrev_b32 v234, 16, v141
    v_and_b32 v235, 4294901760, v141
    v_lshlrev_b32 v236, 16, v142
    v_and_b32 v237, 4294901760, v142
    v_lshlrev_b32 v238, 16, v143
    v_and_b32 v239, 4294901760, v143
    v_pk_add_f32 v[240:241], v[240:241], v[232:233]
    v_pk_add_f32 v[242:243], v[242:243], v[234:235]
    v_pk_add_f32 v[244:245], v[244:245], v[236:237]
    v_pk_add_f32 v[246:247], v[246:247], v[238:239]
    v_cvt_pk_bf16_f32 v104, v240, v241
    v_cvt_pk_bf16_f32 v105, v242, v243
    v_cvt_pk_bf16_f32 v106, v244, v245
    v_cvt_pk_bf16_f32 v107, v246, v247
    buffer_store_dwordx2 v[104:105], v12, s[8:11], s51 offen offset:64
    buffer_store_dwordx2 v[106:107], v12, s[8:11], s51 offen offset:96
    s_waitcnt vmcnt(13)
    v_lshlrev_b32 v232, 16, v144
    v_and_b32 v233, 4294901760, v144
    v_lshlrev_b32 v234, 16, v145
    v_and_b32 v235, 4294901760, v145
    v_lshlrev_b32 v236, 16, v146
    v_and_b32 v237, 4294901760, v146
    v_lshlrev_b32 v238, 16, v147
    v_and_b32 v239, 4294901760, v147
    v_pk_add_f32 v[240:241], v[48:49], v[232:233]
    v_pk_add_f32 v[242:243], v[50:51], v[234:235]
    v_pk_add_f32 v[244:245], v[52:53], v[236:237]
    v_pk_add_f32 v[246:247], v[54:55], v[238:239]
    s_waitcnt vmcnt(12)
    v_lshlrev_b32 v232, 16, v148
    v_and_b32 v233, 4294901760, v148
    v_lshlrev_b32 v234, 16, v149
    v_and_b32 v235, 4294901760, v149
    v_lshlrev_b32 v236, 16, v150
    v_and_b32 v237, 4294901760, v150
    v_lshlrev_b32 v238, 16, v151
    v_and_b32 v239, 4294901760, v151
    v_pk_add_f32 v[240:241], v[240:241], v[232:233]
    v_pk_add_f32 v[242:243], v[242:243], v[234:235]
    v_pk_add_f32 v[244:245], v[244:245], v[236:237]
    v_pk_add_f32 v[246:247], v[246:247], v[238:239]
    s_waitcnt vmcnt(11)
    v_lshlrev_b32 v232, 16, v160
    v_and_b32 v233, 4294901760, v160
    v_lshlrev_b32 v234, 16, v161
    v_and_b32 v235, 4294901760, v161
    v_lshlrev_b32 v236, 16, v162
    v_and_b32 v237, 4294901760, v162
    v_lshlrev_b32 v238, 16, v163
    v_and_b32 v239, 4294901760, v163
    v_pk_add_f32 v[240:241], v[240:241], v[232:233]
    v_pk_add_f32 v[242:243], v[242:243], v[234:235]
    v_pk_add_f32 v[244:245], v[244:245], v[236:237]
    v_pk_add_f32 v[246:247], v[246:247], v[238:239]
    s_waitcnt vmcnt(10)
    v_lshlrev_b32 v232, 16, v164
    v_and_b32 v233, 4294901760, v164
    v_lshlrev_b32 v234, 16, v165
    v_and_b32 v235, 4294901760, v165
    v_lshlrev_b32 v236, 16, v166
    v_and_b32 v237, 4294901760, v166
    v_lshlrev_b32 v238, 16, v167
    v_and_b32 v239, 4294901760, v167
    v_pk_add_f32 v[240:241], v[240:241], v[232:233]
    v_pk_add_f32 v[242:243], v[242:243], v[234:235]
    v_pk_add_f32 v[244:245], v[244:245], v[236:237]
    v_pk_add_f32 v[246:247], v[246:247], v[238:239]
    s_waitcnt vmcnt(9)
    v_lshlrev_b32 v232, 16, v168
    v_and_b32 v233, 4294901760, v168
    v_lshlrev_b32 v234, 16, v169
    v_and_b32 v235, 4294901760, v169
    v_lshlrev_b32 v236, 16, v170
    v_and_b32 v237, 4294901760, v170
    v_lshlrev_b32 v238, 16, v171
    v_and_b32 v239, 4294901760, v171
    v_pk_add_f32 v[240:241], v[240:241], v[232:233]
    v_pk_add_f32 v[242:243], v[242:243], v[234:235]
    v_pk_add_f32 v[244:245], v[244:245], v[236:237]
    v_pk_add_f32 v[246:247], v[246:247], v[238:239]
    s_waitcnt vmcnt(8)
    v_lshlrev_b32 v232, 16, v172
    v_and_b32 v233, 4294901760, v172
    v_lshlrev_b32 v234, 16, v173
    v_and_b32 v235, 4294901760, v173
    v_lshlrev_b32 v236, 16, v174
    v_and_b32 v237, 4294901760, v174
    v_lshlrev_b32 v238, 16, v175
    v_and_b32 v239, 4294901760, v175
    v_pk_add_f32 v[240:241], v[240:241], v[232:233]
    v_pk_add_f32 v[242:243], v[242:243], v[234:235]
    v_pk_add_f32 v[244:245], v[244:245], v[236:237]
    v_pk_add_f32 v[246:247], v[246:247], v[238:239]
    s_waitcnt vmcnt(7)
    v_lshlrev_b32 v232, 16, v176
    v_and_b32 v233, 4294901760, v176
    v_lshlrev_b32 v234, 16, v177
    v_and_b32 v235, 4294901760, v177
    v_lshlrev_b32 v236, 16, v178
    v_and_b32 v237, 4294901760, v178
    v_lshlrev_b32 v238, 16, v179
    v_and_b32 v239, 4294901760, v179
    v_pk_add_f32 v[240:241], v[240:241], v[232:233]
    v_pk_add_f32 v[242:243], v[242:243], v[234:235]
    v_pk_add_f32 v[244:245], v[244:245], v[236:237]
    v_pk_add_f32 v[246:247], v[246:247], v[238:239]
    s_waitcnt vmcnt(6)
    v_lshlrev_b32 v232, 16, v180
    v_and_b32 v233, 4294901760, v180
    v_lshlrev_b32 v234, 16, v181
    v_and_b32 v235, 4294901760, v181
    v_lshlrev_b32 v236, 16, v182
    v_and_b32 v237, 4294901760, v182
    v_lshlrev_b32 v238, 16, v183
    v_and_b32 v239, 4294901760, v183
    v_pk_add_f32 v[240:241], v[240:241], v[232:233]
    v_pk_add_f32 v[242:243], v[242:243], v[234:235]
    v_pk_add_f32 v[244:245], v[244:245], v[236:237]
    v_pk_add_f32 v[246:247], v[246:247], v[238:239]
    v_cvt_pk_bf16_f32 v144, v240, v241
    v_cvt_pk_bf16_f32 v145, v242, v243
    v_cvt_pk_bf16_f32 v146, v244, v245
    v_cvt_pk_bf16_f32 v147, v246, v247
    buffer_store_dwordx2 v[144:145], v12, s[8:11], s51 offen offset:128
    buffer_store_dwordx2 v[146:147], v12, s[8:11], s51 offen offset:160
    s_mov_b32 s55, 4096
    s_branch L_p2_f
L_p2_l:
    s_sub_u32 s55, s55, 1
    s_cbranch_scc1 L_sloww
    s_sleep 8
L_p2_f:
    buffer_load_dword v11, v10, s[36:39], s47 offen sc1
    s_waitcnt vmcnt(0)
    v_cmp_le_u32 vcc, 2, v11
    s_nop 1
    s_cmp_eq_u32 vcc_lo, 0xff
    s_cbranch_scc0 L_p2_l
L_p2_ok:
    s_add_u32 s57, s16, 43008
    buffer_load_dwordx4 v[192:195], v13, s[28:31], s57 offen offset:0 sc1
    s_add_u32 s57, s17, 43008
    buffer_load_dwordx4 v[196:199], v13, s[28:31], s57 offen offset:0 sc1
    s_add_u32 s57, s18, 43008
    buffer_load_dwordx4 v[200:203], v13, s[28:31], s57 offen offset:0 sc1
    s_add_u32 s57, s19, 43008
    buffer_load_dwordx4 v[204:207], v13, s[28:31], s57 offen offset:0 sc1
    s_add_u32 s57, s20, 43008
    buffer_load_dwordx4 v[208:211], v13, s[28:31], s57 offen offset:0 sc1
    s_add_u32 s57, s21, 43008
    buffer_load_dwordx4 v[212:215], v13, s[28:31], s57 offen offset:0 sc1
    s_add_u32 s57, s22, 43008
    buffer_load_dwordx4 v[224:227], v13, s[28:31], s57 offen offset:0 sc1
    s_add_u32 s57, s23, 43008
    buffer_load_dwordx4 v[228:231], v13, s[28:31], s57 offen offset:0 sc1
    s_waitcnt vmcnt(7)
    v_lshlrev_b32 v232, 16, v192
    v_and_b32 v233, 4294901760, v192
    v_lshlrev_b32 v234, 16, v193
    v_and_b32 v235, 4294901760, v193
    v_lshlrev_b32 v236, 16, v194
    v_and_b32 v237, 4294901760, v194
    v_lshlrev_b32 v238, 16, v195
    v_and_b32 v239, 4294901760, v195
    v_pk_add_f32 v[240:241], v[56:57], v[232:233]
    v_pk_add_f32 v[242:243], v[58:59], v[234:235]
    v_pk_add_f32 v[244:245], v[60:61], v[236:237]
    v_pk_add_f32 v[246:247], v[62:63], v[238:239]
    s_waitcnt vmcnt(6)
    v_lshlrev_b32 v232, 16, v196
    v_and_b32 v233, 4294901760, v196
    v_lshlrev_b32 v234, 16, v197
    v_and_b32 v235, 4294901760, v197
    v_lshlrev_b32 v236, 16, v198
    v_and_b32 v237, 4294901760, v198
    v_lshlrev_b32 v238, 16, v199
    v_and_b32 v239, 4294901760, v199
    v_pk_add_f32 v[240:241], v[240:241], v[232:233]
    v_pk_add_f32 v[242:243], v[242:243], v[234:235]
    v_pk_add_f32 v[244:245], v[244:245], v[236:237]
    v_pk_add_f32 v[246:247], v[246:247], v[238:239]
    s_waitcnt vmcnt(5)
    v_lshlrev_b32 v232, 16, v200
    v_and_b32 v233, 4294901760, v200
    v_lshlrev_b32 v234, 16, v201
    v_and_b32 v235, 4294901760, v201
    v_lshlrev_b32 v236, 16, v202
    v_and_b32 v237, 4294901760, v202
    v_lshlrev_b32 v238, 16, v203
    v_and_b32 v239, 4294901760, v203
    v_pk_add_f32 v[240:241], v[240:241], v[232:233]
    v_pk_add_f32 v[242:243], v[242:243], v[234:235]
    v_pk_add_f32 v[244:245], v[244:245], v[236:237]
    v_pk_add_f32 v[246:247], v[246:247], v[238:239]
    s_waitcnt vmcnt(4)
    v_lshlrev_b32 v232, 16, v204
    v_and_b32 v233, 4294901760, v204
    v_lshlrev_b32 v234, 16, v205
    v_and_b32 v235, 4294901760, v205
    v_lshlrev_b32 v236, 16, v206
    v_and_b32 v237, 4294901760, v206
    v_lshlrev_b32 v238, 16, v207
    v_and_b32 v239, 4294901760, v207
    v_pk_add_f32 v[240:241], v[240:241], v[232:233]
    v_pk_add_f32 v[242:243], v[242:243], v[234:235]
    v_pk_add_f32 v[244:245], v[244:245], v[236:237]
    v_pk_add_f32 v[246:247], v[246:247], v[238:239]
    s_waitcnt vmcnt(3)
    v_lshlrev_b32 v232, 16, v208
    v_and_b32 v233, 4294901760, v208
    v_lshlrev_b32 v234, 16, v209
    v_and_b32 v235, 4294901760, v209
    v_lshlrev_b32 v236, 16, v210
    v_and_b32 v237, 4294901760, v210
    v_lshlrev_b32 v238, 16, v211
    v_and_b32 v239, 4294901760, v211
    v_pk_add_f32 v[240:241], v[240:241], v[232:233]
    v_pk_add_f32 v[242:243], v[242:243], v[234:235]
    v_pk_add_f32 v[244:245], v[244:245], v[236:237]
    v_pk_add_f32 v[246:247], v[246:247], v[238:239]
    s_waitcnt vmcnt(2)
    v_lshlrev_b32 v232, 16, v212
    v_and_b32 v233, 4294901760, v212
    v_lshlrev_b32 v234, 16, v213
    v_and_b32 v235, 4294901760, v213
    v_lshlrev_b32 v236, 16, v214
    v_and_b32 v237, 4294901760, v214
    v_lshlrev_b32 v238, 16, v215
    v_and_b32 v239, 4294901760, v215
    v_pk_add_f32 v[240:241], v[240:241], v[232:233]
    v_pk_add_f32 v[242:243], v[242:243], v[234:235]
    v_pk_add_f32 v[244:245], v[244:245], v[236:237]
    v_pk_add_f32 v[246:247], v[246:247], v[238:239]
    s_waitcnt vmcnt(1)
    v_lshlrev_b32 v232, 16, v224
    v_and_b32 v233, 4294901760, v224
    v_lshlrev_b32 v234, 16, v225
    v_and_b32 v235, 4294901760, v225
    v_lshlrev_b32 v236, 16, v226
    v_and_b32 v237, 4294901760, v226
    v_lshlrev_b32 v238, 16, v227
    v_and_b32 v239, 4294901760, v227
    v_pk_add_f32 v[240:241], v[240:241], v[232:233]
    v_pk_add_f32 v[242:243], v[242:243], v[234:235]
    v_pk_add_f32 v[244:245], v[244:245], v[236:237]
    v_pk_add_f32 v[246:247], v[246:247], v[238:239]
    s_waitcnt vmcnt(0)
    v_lshlrev_b32 v232, 16, v228
    v_and_b32 v233, 4294901760, v228
    v_lshlrev_b32 v234, 16, v229
    v_and_b32 v235, 4294901760, v229
    v_lshlrev_b32 v236, 16, v230
    v_and_b32 v237, 4294901760, v230
    v_lshlrev_b32 v238, 16, v231
    v_and_b32 v239, 4294901760, v231
    v_pk_add_f32 v[240:241], v[240:241], v[232:233]
    v_pk_add_f32 v[242:243], v[242:243], v[234:235]
    v_pk_add_f32 v[244:245], v[244:245], v[236:237]
    v_pk_add_f32 v[246:247], v[246:247], v[238:239]
    v_cvt_pk_bf16_f32 v192, v240, v241
    v_cvt_pk_bf16_f32 v193, v242, v243
    v_cvt_pk_bf16_f32 v194, v244, v245
    v_cvt_pk_bf16_f32 v195, v246, v247
    buffer_store_dwordx2 v[192:193], v12, s[8:11], s51 offen offset:192
    buffer_store_dwordx2 v[194:195], v12, s[8:11], s51 offen offset:224
L_fin:
    s_cmp_eq_u32 s60, 0
    s_cbranch_scc1 L_done
    s_mov_b32 s60, 0
    s_waitcnt vmcnt(2)
    v_readfirstlane_b32 s3, v2
    v_readfirstlane_b32 s59, v3
    s_nop 1
    s_bfe_u32 s3, s3, 0x80008
    s_cmp_lg_u32 s3, 7
    s_cbranch_scc1 L_done
    s_cmp_lg_u32 s59, 0
    s_cbranch_scc1 L_redo
L_done:
L_end:
    s_endpgm
L_fallback:
    s_mov_b32 s60, 1
    s_mov_b32 s51, 0
    s_mov_b32 s52, 0
    v_mov_b32 v240, 4286578688
    v_mov_b32 v241, 4286578688
    v_mov_b32 v242, 4286578688
    v_mov_b32 v243, 4286578688
    v_mov_b32 v244, 4286578688
    v_mov_b32 v245, 4286578688
    v_mov_b32 v246, 4286578688
    v_add_u32 v1, s48, v220
    v_add_u32 v2, s48, v221
    v_add_u32 v3, s48, v222
    v_add_u32 v4, s48, v223
    s_mov_b32 s55, 16
L_fb:
    s_add_u32 m0, s48, 0
    s_nop 0
    buffer_load_dwordx4 v15, s[16:19], s51 offen offset:0 nt lds
    buffer_load_dwordx4 v16, s[16:19], s51 offen offset:1024 nt lds
    buffer_load_dwordx4 v17, s[16:19], s51 offen offset:2048 nt lds
    buffer_load_dwordx4 v18, s[16:19], s51 offen offset:3072 nt lds
    s_add_u32 s51, s51, 4096
    s_add_u32 m0, s48, 4096
    s_nop 0
    buffer_load_dwordx4 v15, s[16:19], s51 offen offset:0 nt lds
    buffer_load_dwordx4 v16, s[16:19], s51 offen offset:1024 nt lds
    buffer_load_dwordx4 v17, s[16:19], s51 offen offset:2048 nt lds
    buffer_load_dwordx4 v18, s[16:19], s51 offen offset:3072 nt lds
    s_add_u32 s51, s51, 4096
    s_waitcnt vmcnt(0)
    ds_read_b128 v[48:51], v1 offset:0
    ds_read_b128 v[52:55], v2 offset:0
    ds_read_b128 v[56:59], v3 offset:0
    ds_read_b128 v[60:63], v4 offset:0
    ds_read_b128 v[80:83], v1 offset:4096
    ds_read_b128 v[84:87], v2 offset:4096
    ds_read_b128 v[88:91], v3 offset:4096
    ds_read_b128 v[92:95], v4 offset:4096
    s_waitcnt lgkmcnt(0)
    v_mfma_f32_16x16x32_bf16 v[112:115], v[48:51], v[32:35], 0
    v_mfma_f32_16x16x32_bf16 v[112:115], v[52:55], v[36:39], v[112:115]
    v_mfma_f32_16x16x32_bf16 v[112:115], v[56:59], v[40:43], v[112:115]
    v_mfma_f32_16x16x32_bf16 v[112:115], v[60:63], v[44:47], v[112:115]
    v_mfma_f32_16x16x32_bf16 v[116:119], v[80:83], v[32:35], 0
    v_mfma_f32_16x16x32_bf16 v[116:119], v[84:87], v[36:39], v[116:119]
    v_mfma_f32_16x16x32_bf16 v[116:119], v[88:91], v[40:43], v[116:119]
    v_mfma_f32_16x16x32_bf16 v[116:119], v[92:95], v[44:47], v[116:119]
    s_nop 7
    v_max3_f32 v240, v240, v112, v113
    v_max3_f32 v240, v240, v114, v115
    v_max3_f32 v240, v240, v116, v117
    v_max3_f32 v240, v240, v118, v119
    s_nop 1
    v_mfma_f32_16x16x32_bf16 v[112:115], v[48:51], v[64:67], 0
    v_mfma_f32_16x16x32_bf16 v[112:115], v[52:55], v[68:71], v[112:115]
    v_mfma_f32_16x16x32_bf16 v[112:115], v[56:59], v[72:75], v[112:115]
    v_mfma_f32_16x16x32_bf16 v[112:115], v[60:63], v[76:79], v[112:115]
    v_mfma_f32_16x16x32_bf16 v[116:119], v[80:83], v[64:67], 0
    v_mfma_f32_16x16x32_bf16 v[116:119], v[84:87], v[68:71], v[116:119]
    v_mfma_f32_16x16x32_bf16 v[116:119], v[88:91], v[72:75], v[116:119]
    v_mfma_f32_16x16x32_bf16 v[116:119], v[92:95], v[76:79], v[116:119]
    s_nop 7
    v_max3_f32 v241, v241, v112, v113
    v_max3_f32 v241, v241, v114, v115
    v_max3_f32 v241, v241, v116, v117
    v_max3_f32 v241, v241, v118, v119
    s_nop 1
    v_mfma_f32_16x16x32_bf16 v[112:115], v[48:51], v[96:99], 0
    v_mfma_f32_16x16x32_bf16 v[112:115], v[52:55], v[100:103], v[112:115]
    v_mfma_f32_16x16x32_bf16 v[112:115], v[56:59], v[104:107], v[112:115]
    v_mfma_f32_16x16x32_bf16 v[112:115], v[60:63], v[108:111], v[112:115]
    v_mfma_f32_16x16x32_bf16 v[116:119], v[80:83], v[96:99], 0
    v_mfma_f32_16x16x32_bf16 v[116:119], v[84:87], v[100:103], v[116:119]
    v_mfma_f32_16x16x32_bf16 v[116:119], v[88:91], v[104:107], v[116:119]
    v_mfma_f32_16x16x32_bf16 v[116:119], v[92:95], v[108:111], v[116:119]
    s_nop 7
    v_max3_f32 v242, v242, v112, v113
    v_max3_f32 v242, v242, v114, v115
    v_max3_f32 v242, v242, v116, v117
    v_max3_f32 v242, v242, v118, v119
    s_nop 1
    v_mfma_f32_16x16x32_bf16 v[112:115], v[48:51], v[128:131], 0
    v_mfma_f32_16x16x32_bf16 v[112:115], v[52:55], v[132:135], v[112:115]
    v_mfma_f32_16x16x32_bf16 v[112:115], v[56:59], v[136:139], v[112:115]
    v_mfma_f32_16x16x32_bf16 v[112:115], v[60:63], v[140:143], v[112:115]
    v_mfma_f32_16x16x32_bf16 v[116:119], v[80:83], v[128:131], 0
    v_mfma_f32_16x16x32_bf16 v[116:119], v[84:87], v[132:135], v[116:119]
    v_mfma_f32_16x16x32_bf16 v[116:119], v[88:91], v[136:139], v[116:119]
    v_mfma_f32_16x16x32_bf16 v[116:119], v[92:95], v[140:143], v[116:119]
    s_nop 7
    v_max3_f32 v243, v243, v112, v113
    v_max3_f32 v243, v243, v114, v115
    v_max3_f32 v243, v243, v116, v117
    v_max3_f32 v243, v243, v118, v119
    s_nop 1
    v_mfma_f32_16x16x32_bf16 v[112:115], v[48:51], v[160:163], 0
    v_mfma_f32_16x16x32_bf16 v[112:115], v[52:55], v[164:167], v[112:115]
    v_mfma_f32_16x16x32_bf16 v[112:115], v[56:59], v[168:171], v[112:115]
    v_mfma_f32_16x16x32_bf16 v[112:115], v[60:63], v[172:175], v[112:115]
    v_mfma_f32_16x16x32_bf16 v[116:119], v[80:83], v[160:163], 0
    v_mfma_f32_16x16x32_bf16 v[116:119], v[84:87], v[164:167], v[116:119]
    v_mfma_f32_16x16x32_bf16 v[116:119], v[88:91], v[168:171], v[116:119]
    v_mfma_f32_16x16x32_bf16 v[116:119], v[92:95], v[172:175], v[116:119]
    s_nop 7
    v_max3_f32 v244, v244, v112, v113
    v_max3_f32 v244, v244, v114, v115
    v_max3_f32 v244, v244, v116, v117
    v_max3_f32 v244, v244, v118, v119
    s_nop 1
    v_mfma_f32_16x16x32_bf16 v[112:115], v[48:51], v[192:195], 0
    v_mfma_f32_16x16x32_bf16 v[112:115], v[52:55], v[196:199], v[112:115]
    v_mfma_f32_16x16x32_bf16 v[112:115], v[56:59], v[200:203], v[112:115]
    v_mfma_f32_16x16x32_bf16 v[112:115], v[60:63], v[204:207], v[112:115]
    v_mfma_f32_16x16x32_bf16 v[116:119], v[80:83], v[192:195], 0
    v_mfma_f32_16x16x32_bf16 v[116:119], v[84:87], v[196:199], v[116:119]
    v_mfma_f32_16x16x32_bf16 v[116:119], v[88:91], v[200:203], v[116:119]
    v_mfma_f32_16x16x32_bf16 v[116:119], v[92:95], v[204:207], v[116:119]
    s_nop 7
    v_max3_f32 v245, v245, v112, v113
    v_max3_f32 v245, v245, v114, v115
    v_max3_f32 v245, v245, v116, v117
    v_max3_f32 v245, v245, v118, v119
    s_nop 1
    v_mfma_f32_16x16x32_bf16 v[112:115], v[48:51], v[224:227], 0
    v_mfma_f32_16x16x32_bf16 v[112:115], v[52:55], v[228:231], v[112:115]
    v_mfma_f32_16x16x32_bf16 v[112:115], v[56:59], v[232:235], v[112:115]
    v_mfma_f32_16x16x32_bf16 v[112:115], v[60:63], v[236:239], v[112:115]
    v_mfma_f32_16x16x32_bf16 v[116:119], v[80:83], v[224:227], 0
    v_mfma_f32_16x16x32_bf16 v[116:119], v[84:87], v[228:231], v[116:119]
    v_mfma_f32_16x16x32_bf16 v[116:119], v[88:91], v[232:235], v[116:119]
    v_mfma_f32_16x16x32_bf16 v[116:119], v[92:95], v[236:239], v[116:119]
    s_nop 7
    v_max3_f32 v246, v246, v112, v113
    v_max3_f32 v246, v246, v114, v115
    v_max3_f32 v246, v246, v116, v117
    v_max3_f32 v246, v246, v118, v119
    s_nop 1
    s_sub_u32 s55, s55, 1
    s_cmp_lg_u32 s55, 0
    s_cbranch_scc1 L_fb
    v_mov_b32 v247, v240
    v_mov_b32 v248, v241
    v_mov_b32 v249, v242
    v_mov_b32 v250, v243
    v_mov_b32 v251, v244
    v_mov_b32 v252, v245
    v_mov_b32 v253, v246
    s_nop 0
    s_nop 0
    v_permlane16_swap_b32 v240, v247
    v_permlane16_swap_b32 v241, v248
    v_permlane16_swap_b32 v242, v249
    v_permlane16_swap_b32 v243, v250
    v_permlane16_swap_b32 v244, v251
    v_permlane16_swap_b32 v245, v252
    v_permlane16_swap_b32 v246, v253
    s_nop 0
    v_max_f32 v240, v240, v247
    v_max_f32 v241, v241, v248
    v_max_f32 v242, v242, v249
    v_max_f32 v243, v243, v250
    v_max_f32 v244, v244, v251
    v_max_f32 v245, v245, v252
    v_max_f32 v246, v246, v253
    v_mov_b32 v247, v240
    v_mov_b32 v248, v241
    v_mov_b32 v249, v242
    v_mov_b32 v250, v243
    v_mov_b32 v251, v244
    v_mov_b32 v252, v245
    v_mov_b32 v253, v246
    s_nop 0
    s_nop 0
    v_permlane32_swap_b32 v240, v247
    v_permlane32_swap_b32 v241, v248
    v_permlane32_swap_b32 v242, v249
    v_permlane32_swap_b32 v243, v250
    v_permlane32_swap_b32 v244, v251
    v_permlane32_swap_b32 v245, v252
    v_permlane32_swap_b32 v246, v253
    s_nop 0
    v_max_f32 v240, v240, v247
    v_max_f32 v241, v241, v248
    v_max_f32 v242, v242, v249
    v_max_f32 v243, v243, v250
    v_max_f32 v244, v244, v251
    v_max_f32 v245, v245, v252
    v_max_f32 v246, v246, v253
    v_sub_f32 v144, 0, v240
    v_sub_f32 v145, 0, v240
    v_sub_f32 v146, 0, v240
    v_sub_f32 v147, 0, v240
    v_sub_f32 v148, 0, v241
    v_sub_f32 v149, 0, v241
    v_sub_f32 v150, 0, v241
    v_sub_f32 v151, 0, v241
    v_sub_f32 v152, 0, v242
    v_sub_f32 v153, 0, v242
    v_sub_f32 v154, 0, v242
    v_sub_f32 v155, 0, v242
    v_sub_f32 v156, 0, v243
    v_sub_f32 v157, 0, v243
    v_sub_f32 v158, 0, v243
    v_sub_f32 v159, 0, v243
    v_sub_f32 v176, 0, v244
    v_sub_f32 v177, 0, v244
    v_sub_f32 v178, 0, v244
    v_sub_f32 v179, 0, v244
    v_sub_f32 v180, 0, v245
    v_sub_f32 v181, 0, v245
    v_sub_f32 v182, 0, v245
    v_sub_f32 v183, 0, v245
    v_sub_f32 v184, 0, v246
    v_sub_f32 v185, 0, v246
    v_sub_f32 v186, 0, v246
    v_sub_f32 v187, 0, v246
    v_accvgpr_write_b32 a0, 0
    v_accvgpr_write_b32 a1, 0
    v_accvgpr_write_b32 a2, 0
    v_accvgpr_write_b32 a3, 0
    v_accvgpr_write_b32 a4, 0
    v_accvgpr_write_b32 a5, 0
    v_accvgpr_write_b32 a6, 0
    v_accvgpr_write_b32 a7, 0
    v_accvgpr_write_b32 a8, 0
    v_accvgpr_write_b32 a9, 0
    v_accvgpr_write_b32 a10, 0
    v_accvgpr_write_b32 a11, 0
    v_accvgpr_write_b32 a12, 0
    v_accvgpr_write_b32 a13, 0
    v_accvgpr_write_b32 a14, 0
    v_accvgpr_write_b32 a15, 0
    v_accvgpr_write_b32 a16, 0
    v_accvgpr_write_b32 a17, 0
    v_accvgpr_write_b32 a18, 0
    v_accvgpr_write_b32 a19, 0
    v_accvgpr_write_b32 a20, 0
    v_accvgpr_write_b32 a21, 0
    v_accvgpr_write_b32 a22, 0
    v_accvgpr_write_b32 a23, 0
    v_accvgpr_write_b32 a24, 0
    v_accvgpr_write_b32 a25, 0
    v_accvgpr_write_b32 a26, 0
    v_accvgpr_write_b32 a27, 0
    v_accvgpr_write_b32 a28, 0
    v_accvgpr_write_b32 a29, 0
    v_accvgpr_write_b32 a30, 0
    v_accvgpr_write_b32 a31, 0
    v_accvgpr_write_b32 a32, 0
    v_accvgpr_write_b32 a33, 0
    v_accvgpr_write_b32 a34, 0
    v_accvgpr_write_b32 a35, 0
    v_accvgpr_write_b32 a36, 0
    v_accvgpr_write_b32 a37, 0
    v_accvgpr_write_b32 a38, 0
    v_accvgpr_write_b32 a39, 0
    v_accvgpr_write_b32 a40, 0
    v_accvgpr_write_b32 a41, 0
    v_accvgpr_write_b32 a42, 0
    v_accvgpr_write_b32 a43, 0
    v_accvgpr_write_b32 a44, 0
    v_accvgpr_write_b32 a45, 0
    v_accvgpr_write_b32 a46, 0
    v_accvgpr_write_b32 a47, 0
    v_accvgpr_write_b32 a48, 0
    v_accvgpr_write_b32 a49, 0
    v_accvgpr_write_b32 a50, 0
    v_accvgpr_write_b32 a51, 0
    v_accvgpr_write_b32 a52, 0
    v_accvgpr_write_b32 a53, 0
    v_accvgpr_write_b32 a54, 0
    v_accvgpr_write_b32 a55, 0
    v_accvgpr_write_b32 a56, 0
    v_accvgpr_write_b32 a57, 0
    v_accvgpr_write_b32 a58, 0
    v_accvgpr_write_b32 a59, 0
    v_accvgpr_write_b32 a60, 0
    v_accvgpr_write_b32 a61, 0
    v_accvgpr_write_b32 a62, 0
    v_accvgpr_write_b32 a63, 0
    v_accvgpr_write_b32 a64, 0
    v_accvgpr_write_b32 a65, 0
    v_accvgpr_write_b32 a66, 0
    v_accvgpr_write_b32 a67, 0
    v_accvgpr_write_b32 a68, 0
    v_accvgpr_write_b32 a69, 0
    v_accvgpr_write_b32 a70, 0
    v_accvgpr_write_b32 a71, 0
    v_accvgpr_write_b32 a72, 0
    v_accvgpr_write_b32 a73, 0
    v_accvgpr_write_b32 a74, 0
    v_accvgpr_write_b32 a75, 0
    v_accvgpr_write_b32 a76, 0
    v_accvgpr_write_b32 a77, 0
    v_accvgpr_write_b32 a78, 0
    v_accvgpr_write_b32 a79, 0
    v_accvgpr_write_b32 a80, 0
    v_accvgpr_write_b32 a81, 0
    v_accvgpr_write_b32 a82, 0
    v_accvgpr_write_b32 a83, 0
    v_accvgpr_write_b32 a84, 0
    v_accvgpr_write_b32 a85, 0
    v_accvgpr_write_b32 a86, 0
    v_accvgpr_write_b32 a87, 0
    v_accvgpr_write_b32 a88, 0
    v_accvgpr_write_b32 a89, 0
    v_accvgpr_write_b32 a90, 0
    v_accvgpr_write_b32 a91, 0
    v_accvgpr_write_b32 a92, 0
    v_accvgpr_write_b32 a93, 0
    v_accvgpr_write_b32 a94, 0
    v_accvgpr_write_b32 a95, 0
    v_accvgpr_write_b32 a96, 0
    v_accvgpr_write_b32 a97, 0
    v_accvgpr_write_b32 a98, 0
    v_accvgpr_write_b32 a99, 0
    v_accvgpr_write_b32 a100, 0
    v_accvgpr_write_b32 a101, 0
    v_accvgpr_write_b32 a102, 0
    v_accvgpr_write_b32 a103, 0
    v_accvgpr_write_b32 a104, 0
    v_accvgpr_write_b32 a105, 0
    v_accvgpr_write_b32 a106, 0
    v_accvgpr_write_b32 a107, 0
    v_accvgpr_write_b32 a108, 0
    v_accvgpr_write_b32 a109, 0
    v_accvgpr_write_b32 a110, 0
    v_accvgpr_write_b32 a111, 0
    v_accvgpr_write_b32 a112, 0
    v_accvgpr_write_b32 a113, 0
    v_accvgpr_write_b32 a114, 0
    v_accvgpr_write_b32 a115, 0
    v_accvgpr_write_b32 a116, 0
    v_accvgpr_write_b32 a117, 0
    v_accvgpr_write_b32 a118, 0
    v_accvgpr_write_b32 a119, 0
    v_accvgpr_write_b32 a120, 0
    v_accvgpr_write_b32 a121, 0
    v_accvgpr_write_b32 a122, 0
    v_accvgpr_write_b32 a123, 0
    v_accvgpr_write_b32 a124, 0
    v_accvgpr_write_b32 a125, 0
    v_accvgpr_write_b32 a126, 0
    v_accvgpr_write_b32 a127, 0
    v_accvgpr_write_b32 a128, 0
    v_accvgpr_write_b32 a129, 0
    v_accvgpr_write_b32 a130, 0
    v_accvgpr_write_b32 a131, 0
    v_accvgpr_write_b32 a132, 0
    v_accvgpr_write_b32 a133, 0
    v_accvgpr_write_b32 a134, 0
    v_accvgpr_write_b32 a135, 0
    v_accvgpr_write_b32 a136, 0
    v_accvgpr_write_b32 a137, 0
    v_accvgpr_write_b32 a138, 0
    v_accvgpr_write_b32 a139, 0
    v_accvgpr_write_b32 a140, 0
    v_accvgpr_write_b32 a141, 0
    v_accvgpr_write_b32 a142, 0
    v_accvgpr_write_b32 a143, 0
    v_accvgpr_write_b32 a144, 0
    v_accvgpr_write_b32 a145, 0
    v_accvgpr_write_b32 a146, 0
    v_accvgpr_write_b32 a147, 0
    v_accvgpr_write_b32 a148, 0
    v_accvgpr_write_b32 a149, 0
    v_accvgpr_write_b32 a150, 0
    v_accvgpr_write_b32 a151, 0
    v_accvgpr_write_b32 a152, 0
    v_accvgpr_write_b32 a153, 0
    v_accvgpr_write_b32 a154, 0
    v_accvgpr_write_b32 a155, 0
    v_accvgpr_write_b32 a156, 0
    v_accvgpr_write_b32 a157, 0
    v_accvgpr_write_b32 a158, 0
    v_accvgpr_write_b32 a159, 0
    v_accvgpr_write_b32 a160, 0
    v_accvgpr_write_b32 a161, 0
    v_accvgpr_write_b32 a162, 0
    v_accvgpr_write_b32 a163, 0
    v_accvgpr_write_b32 a164, 0
    v_accvgpr_write_b32 a165, 0
    v_accvgpr_write_b32 a166, 0
    v_accvgpr_write_b32 a167, 0
    v_accvgpr_write_b32 a168, 0
    v_accvgpr_write_b32 a169, 0
    v_accvgpr_write_b32 a170, 0
    v_accvgpr_write_b32 a171, 0
    v_accvgpr_write_b32 a172, 0
    v_accvgpr_write_b32 a173, 0
    v_accvgpr_write_b32 a174, 0
    v_accvgpr_write_b32 a175, 0
    v_accvgpr_write_b32 a176, 0
    v_accvgpr_write_b32 a177, 0
    v_accvgpr_write_b32 a178, 0
    v_accvgpr_write_b32 a179, 0
    v_accvgpr_write_b32 a180, 0
    v_accvgpr_write_b32 a181, 0
    v_accvgpr_write_b32 a182, 0
    v_accvgpr_write_b32 a183, 0
    v_accvgpr_write_b32 a184, 0
    v_accvgpr_write_b32 a185, 0
    v_accvgpr_write_b32 a186, 0
    v_accvgpr_write_b32 a187, 0
    v_accvgpr_write_b32 a188, 0
    v_accvgpr_write_b32 a189, 0
    v_accvgpr_write_b32 a190, 0
    v_accvgpr_write_b32 a191, 0
    v_accvgpr_write_b32 a192, 0
    v_accvgpr_write_b32 a193, 0
    v_accvgpr_write_b32 a194, 0
    v_accvgpr_write_b32 a195, 0
    v_accvgpr_write_b32 a196, 0
    v_accvgpr_write_b32 a197, 0
    v_accvgpr_write_b32 a198, 0
    v_accvgpr_write_b32 a199, 0
    v_accvgpr_write_b32 a200, 0
    v_accvgpr_write_b32 a201, 0
    v_accvgpr_write_b32 a202, 0
    v_accvgpr_write_b32 a203, 0
    v_accvgpr_write_b32 a204, 0
    v_accvgpr_write_b32 a205, 0
    v_accvgpr_write_b32 a206, 0
    v_accvgpr_write_b32 a207, 0
    v_accvgpr_write_b32 a208, 0
    v_accvgpr_write_b32 a209, 0
    v_accvgpr_write_b32 a210, 0
    v_accvgpr_write_b32 a211, 0
    v_accvgpr_write_b32 a212, 0
    v_accvgpr_write_b32 a213, 0
    v_accvgpr_write_b32 a214, 0
    v_accvgpr_write_b32 a215, 0
    v_accvgpr_write_b32 a216, 0
    v_accvgpr_write_b32 a217, 0
    v_accvgpr_write_b32 a218, 0
    v_accvgpr_write_b32 a219, 0
    v_accvgpr_write_b32 a220, 0
    v_accvgpr_write_b32 a221, 0
    v_accvgpr_write_b32 a222, 0
    v_accvgpr_write_b32 a223, 0
    v_accvgpr_write_b32 a224, 0
    v_accvgpr_write_b32 a225, 0
    v_accvgpr_write_b32 a226, 0
    v_accvgpr_write_b32 a227, 0
    v_accvgpr_write_b32 a228, 0
    v_accvgpr_write_b32 a229, 0
    v_accvgpr_write_b32 a230, 0
    v_accvgpr_write_b32 a231, 0
    v_accvgpr_write_b32 a232, 0
    v_accvgpr_write_b32 a233, 0
    v_accvgpr_write_b32 a234, 0
    v_accvgpr_write_b32 a235, 0
    v_accvgpr_write_b32 a236, 0
    v_accvgpr_write_b32 a237, 0
    v_accvgpr_write_b32 a238, 0
    v_accvgpr_write_b32 a239, 0
    v_accvgpr_write_b32 a240, 0
    v_accvgpr_write_b32 a241, 0
    v_accvgpr_write_b32 a242, 0
    v_accvgpr_write_b32 a243, 0
    v_accvgpr_write_b32 a244, 0
    v_accvgpr_write_b32 a245, 0
    v_accvgpr_write_b32 a246, 0
    v_accvgpr_write_b32 a247, 0
    v_accvgpr_write_b32 a248, 0
    v_accvgpr_write_b32 a249, 0
    v_accvgpr_write_b32 a250, 0
    v_accvgpr_write_b32 a251, 0
    v_accvgpr_write_b32 a252, 0
    v_accvgpr_write_b32 a253, 0
    v_accvgpr_write_b32 a254, 0
    v_accvgpr_write_b32 a255, 0
    s_mov_b32 s51, 0
    s_add_u32 m0, s48, 0
    s_nop 0
    buffer_load_dwordx4 v15, s[16:19], s51 offen offset:0 nt lds
    buffer_load_dwordx4 v16, s[16:19], s51 offen offset:1024 nt lds
    buffer_load_dwordx4 v17, s[16:19], s51 offen offset:2048 nt lds
    buffer_load_dwordx4 v18, s[16:19], s51 offen offset:3072 nt lds
    s_add_u32 s51, s51, 4096
    s_add_u32 m0, s48, 4096
    s_nop 0
    buffer_load_dwordx4 v15, s[16:19], s51 offen offset:0 nt lds
    buffer_load_dwordx4 v16, s[16:19], s51 offen offset:1024 nt lds
    buffer_load_dwordx4 v17, s[16:19], s51 offen offset:2048 nt lds
    buffer_load_dwordx4 v18, s[16:19], s51 offen offset:3072 nt lds
    s_add_u32 s51, s51, 4096
    s_add_u32 m0, s48, 8192
    s_nop 0
    buffer_load_dwordx4 v19, s[20:23], s52 offen offset:0 nt lds
    buffer_load_dwordx4 v20, s[20:23], s52 offen offset:1024 nt lds
    buffer_load_dwordx4 v19, s[20:23], s52 offen offset:2048 nt lds
    buffer_load_dwordx4 v20, s[20:23], s52 offen offset:3072 nt lds
    s_add_u32 s52, s52, 4096
    s_add_u32 m0, s48, 12288
    s_nop 0
    buffer_load_dwordx4 v19, s[20:23], s52 offen offset:0 nt lds
    buffer_load_dwordx4 v20, s[20:23], s52 offen offset:1024 nt lds
    buffer_load_dwordx4 v19, s[20:23], s52 offen offset:2048 nt lds
    buffer_load_dwordx4 v20, s[20:23], s52 offen offset:3072 nt lds
    s_add_u32 s52, s52, 4096
    s_add_u32 m0, s48, 16384
    s_nop 0
    buffer_load_dwordx4 v15, s[16:19], s51 offen offset:0 nt lds
    buffer_load_dwordx4 v16, s[16:19], s51 offen offset:1024 nt lds
    buffer_load_dwordx4 v17, s[16:19], s51 offen offset:2048 nt lds
    buffer_load_dwordx4 v18, s[16:19], s51 offen offset:3072 nt lds
    s_add_u32 s51, s51, 4096
    s_add_u32 m0, s48, 20480
    s_nop 0
    buffer_load_dwordx4 v15, s[16:19], s51 offen offset:0 nt lds
    buffer_load_dwordx4 v16, s[16:19], s51 offen offset:1024 nt lds
    buffer_load_dwordx4 v17, s[16:19], s51 offen offset:2048 nt lds
    buffer_load_dwordx4 v18, s[16:19], s51 offen offset:3072 nt lds
    s_add_u32 s51, s51, 4096
    s_add_u32 m0, s48, 24576
    s_nop 0
    buffer_load_dwordx4 v19, s[20:23], s52 offen offset:0 nt lds
    buffer_load_dwordx4 v20, s[20:23], s52 offen offset:1024 nt lds
    buffer_load_dwordx4 v19, s[20:23], s52 offen offset:2048 nt lds
    buffer_load_dwordx4 v20, s[20:23], s52 offen offset:3072 nt lds
    s_add_u32 s52, s52, 4096
    s_add_u32 m0, s48, 28672
    s_nop 0
    buffer_load_dwordx4 v19, s[20:23], s52 offen offset:0 nt lds
    buffer_load_dwordx4 v20, s[20:23], s52 offen offset:1024 nt lds
    buffer_load_dwordx4 v19, s[20:23], s52 offen offset:2048 nt lds
    buffer_load_dwordx4 v20, s[20:23], s52 offen offset:3072 nt lds
    s_add_u32 s52, s52, 4096
    s_add_u32 s32, s48, 16384
    s_lshl_b32 s33, s4, 13
    s_add_u32 s33, s33, 131072
    s_mov_b32 s34, s48
    s_waitcnt vmcnt(24)
    ds_read_b128 v[48:51], v1 offset:0
    ds_read_b128 v[52:55], v2 offset:0
    ds_read_b128 v[56:59], v3 offset:0
    ds_read_b128 v[60:63], v4 offset:0
    ds_read_b128 v[80:83], v1 offset:4096
    ds_read_b128 v[84:87], v2 offset:4096
    ds_read_b128 v[88:91], v3 offset:4096
    ds_read_b128 v[92:95], v4 offset:4096
    s_waitcnt lgkmcnt(0)
    s_add_u32 m0, s48, 0
    s_nop 0
    buffer_load_dwordx4 v15, s[16:19], s51 offen offset:0 nt lds
    buffer_load_dwordx4 v16, s[16:19], s51 offen offset:1024 nt lds
    buffer_load_dwordx4 v17, s[16:19], s51 offen offset:2048 nt lds
    buffer_load_dwordx4 v18, s[16:19], s51 offen offset:3072 nt lds
    s_add_u32 s51, s51, 4096
    s_branch L_attn_go
L_slow1:
    s_waitcnt vmcnt(0)
    s_barrier
    buffer_store_dword v9, v28, s[36:39], s45 offen offset:0 sc1
    buffer_atomic_add_x2 v[2:3], v28, s[40:43], s50 offen sc0 sc1
L_sloww:
    s_waitcnt vmcnt(0)
    v_cvt_pk_bf16_f32 v24, v32, v33
    v_cvt_pk_bf16_f32 v25, v34, v35
    v_cvt_pk_bf16_f32 v26, v36, v37
    v_cvt_pk_bf16_f32 v27, v38, v39
    s_add_u32 s62, s94, 0
    buffer_store_dwordx4 v[24:27], v13, s[28:31], s62 offen offset:0 sc1
    s_nop 1
    v_cvt_pk_bf16_f32 v24, v40, v41
    v_cvt_pk_bf16_f32 v25, v42, v43
    v_cvt_pk_bf16_f32 v26, v44, v45
    v_cvt_pk_bf16_f32 v27, v46, v47
    s_add_u32 s62, s94, 14336
    buffer_store_dwordx4 v[24:27], v13, s[28:31], s62 offen offset:0 sc1
    s_nop 1
    v_cvt_pk_bf16_f32 v24, v48, v49
    v_cvt_pk_bf16_f32 v25, v50, v51
    v_cvt_pk_bf16_f32 v26, v52, v53
    v_cvt_pk_bf16_f32 v27, v54, v55
    s_add_u32 s62, s94, 28672
    buffer_store_dwordx4 v[24:27], v13, s[28:31], s62 offen offset:0 sc1
    s_nop 1
    v_cvt_pk_bf16_f32 v24, v56, v57
    v_cvt_pk_bf16_f32 v25, v58, v59
    v_cvt_pk_bf16_f32 v26, v60, v61
    v_cvt_pk_bf16_f32 v27, v62, v63
    s_add_u32 s62, s94, 43008
    buffer_store_dwordx4 v[24:27], v13, s[28:31], s62 offen offset:0 sc1
    s_nop 1
    s_waitcnt vmcnt(0)
    s_mov_b32 s55, 4096
L_sw_l:
    buffer_load_dword v11, v28, s[40:43], s68 offen sc1
    s_waitcnt vmcnt(0)
    v_readfirstlane_b32 s3, v11
    s_nop 1
    s_bfe_u32 s3, s3, 0x80008
    s_cmp_eq_u32 s3, 8
    s_cbranch_scc1 L_own
    s_sleep 64
    s_sub_u32 s55, s55, 1
    s_cbranch_scc0 L_sw_l
    s_lshl_b32 s3, 1, s48
    v_mov_b32 v4, 0
    v_mov_b32 v5, s3
    buffer_atomic_or_x2 v[4:5], v28, s[40:43], s68 offen sc0 sc1
    s_waitcnt vmcnt(0)
    v_readfirstlane_b32 s3, v4
    s_nop 1
    s_bfe_u32 s3, s3, 0x80008
    s_cmp_eq_u32 s3, 8
    s_cbranch_scc0 L_fin
L_own:
    s_lshl_b32 s59, 1, s48
L_redo:
    s_ff1_i32_b32 s49, s59
    s_bitset0_b32 s59, s49
    s_lshr_b32 s52, s49, 2
    s_and_b32 s53, s49, 3
    s_mul_i32 s3, s44, 1792
    s_mul_i32 s57, s53, 56
    s_add_u32 s3, s3, s57
    s_add_u32 s3, s3, s52
    s_lshl_b32 s3, s3, 10
    s_cmp_eq_u32 s52, 7
    s_cselect_b32 s3, 0x70000000, s3
    s_add_u32 s16, s3, 0
    s_add_u32 s17, s3, 229376
    s_cmp_lt_u32 s52, 1
    s_cselect_b32 s57, 7168, 0
    s_add_u32 s17, s17, s57
    s_add_u32 s18, s3, 458752
    s_cmp_lt_u32 s52, 2
    s_cselect_b32 s57, 7168, 0
    s_add_u32 s18, s18, s57
    s_add_u32 s19, s3, 688128
    s_cmp_lt_u32 s52, 3
    s_cselect_b32 s57, 7168, 0
    s_add_u32 s19, s19, s57
    s_add_u32 s20, s3, 917504
    s_cmp_lt_u32 s52, 4
    s_cselect_b32 s57, 7168, 0
    s_add_u32 s20, s20, s57
    s_add_u32 s21, s3, 1146880
    s_cmp_lt_u32 s52, 5
    s_cselect_b32 s57, 7168, 0
    s_add_u32 s21, s21, s57
    s_add_u32 s22, s3, 1376256
    s_cmp_lt_u32 s52, 6
    s_cselect_b32 s57, 7168, 0
    s_add_u32 s22, s22, s57
    s_add_u32 s23, s3, 1605632
    s_mul_i32 s57, s44, 112
    s_lshl_b32 s58, s52, 4
    s_add_u32 s57, s57, s58
    s_lshl_b32 s57, s57, 10
    s_lshl_b32 s58, s53, 8
    s_add_u32 s51, s57, s58
    s_cmp_eq_u32 s52, 7
    s_cselect_b32 s51, 0x70000000, s51
    s_waitcnt vmcnt(0)
    s_add_u32 s57, s16, 0
    buffer_load_dwordx4 v[64:67], v13, s[28:31], s57 offen offset:0 sc1
    s_add_u32 s57, s17, 0
    buffer_load_dwordx4 v[68:71], v13, s[28:31], s57 offen offset:0 sc1
    s_add_u32 s57, s18, 0
    buffer_load_dwordx4 v[72:75], v13, s[28:31], s57 offen offset:0 sc1
    s_add_u32 s57, s19, 0
    buffer_load_dwordx4 v[76:79], v13, s[28:31], s57 offen offset:0 sc1
    s_add_u32 s57, s20, 0
    buffer_load_dwordx4 v[80:83], v13, s[28:31], s57 offen offset:0 sc1
    s_add_u32 s57, s21, 0
    buffer_load_dwordx4 v[84:87], v13, s[28:31], s57 offen offset:0 sc1
    s_add_u32 s57, s22, 0
    buffer_load_dwordx4 v[96:99], v13, s[28:31], s57 offen offset:0 sc1
    s_add_u32 s57, s23, 0
    buffer_load_dwordx4 v[100:103], v13, s[28:31], s57 offen offset:0 sc1
    s_add_u32 s57, s16, 14336
    buffer_load_dwordx4 v[104:107], v13, s[28:31], s57 offen offset:0 sc1
    s_add_u32 s57, s17, 14336
    buffer_load_dwordx4 v[108:111], v13, s[28:31], s57 offen offset:0 sc1
    s_add_u32 s57, s18, 14336
    buffer_load_dwordx4 v[112:115], v13, s[28:31], s57 offen offset:0 sc1
    s_add_u32 s57, s19, 14336
    buffer_load_dwordx4 v[116:119], v13, s[28:31], s57 offen offset:0 sc1
    s_add_u32 s57, s20, 14336
    buffer_load_dwordx4 v[128:131], v13, s[28:31], s57 offen offset:0 sc1
    s_add_u32 s57, s21, 14336
    buffer_load_dwordx4 v[132:135], v13, s[28:31], s57 offen offset:0 sc1
    s_add_u32 s57, s22, 14336
    buffer_load_dwordx4 v[136:139], v13, s[28:31], s57 offen offset:0 sc1
    s_add_u32 s57, s23, 14336
    buffer_load_dwordx4 v[140:143], v13, s[28:31], s57 offen offset:0 sc1
    s_add_u32 s57, s16, 28672
    buffer_load_dwordx4 v[144:147], v13, s[28:31], s57 offen offset:0 sc1
    s_add_u32 s57, s17, 28672
    buffer_load_dwordx4 v[148:151], v13, s[28:31], s57 offen offset:0 sc1
    s_add_u32 s57, s18, 28672
    buffer_load_dwordx4 v[160:163], v13, s[28:31], s57 offen offset:0 sc1
    s_add_u32 s57, s19, 28672
    buffer_load_dwordx4 v[164:167], v13, s[28:31], s57 offen offset:0 sc1
    s_add_u32 s57, s20, 28672
    buffer_load_dwordx4 v[168:171], v13, s[28:31], s57 offen offset:0 sc1
    s_add_u32 s57, s21, 28672
    buffer_load_dwordx4 v[172:175], v13, s[28:31], s57 offen offset:0 sc1
    s_add_u32 s57, s22, 28672
    buffer_load_dwordx4 v[176:179], v13, s[28:31], s57 offen offset:0 sc1
    s_add_u32 s57, s23, 28672
    buffer_load_dwordx4 v[180:183], v13, s[28:31], s57 offen offset:0 sc1
    s_add_u32 s57, s16, 43008
    buffer_load_dwordx4 v[192:195], v13, s[28:31], s57 offen offset:0 sc1
    s_add_u32 s57, s17, 43008
    buffer_load_dwordx4 v[196:199], v13, s[28:31], s57 offen offset:0 sc1
    s_add_u32 s57, s18, 43008
    buffer_load_dwordx4 v[200:203], v13, s[28:31], s57 offen offset:0 sc1
    s_add_u32 s57, s19, 43008
    buffer_load_dwordx4 v[204:207], v13, s[28:31], s57 offen offset:0 sc1
    s_add_u32 s57, s20, 43008
    buffer_load_dwordx4 v[208:211], v13, s[28:31], s57 offen offset:0 sc1
    s_add_u32 s57, s21, 43008
    buffer_load_dwordx4 v[212:215], v13, s[28:31], s57 offen offset:0 sc1
    s_add_u32 s57, s22, 43008
    buffer_load_dwordx4 v[224:227], v13, s[28:31], s57 offen offset:0 sc1
    s_add_u32 s57, s23, 43008
    buffer_load_dwordx4 v[228:231], v13, s[28:31], s57 offen offset:0 sc1
    s_waitcnt vmcnt(31)
    v_lshlrev_b32 v240, 16, v64
    v_and_b32 v241, 4294901760, v64
    v_lshlrev_b32 v242, 16, v65
    v_and_b32 v243, 4294901760, v65
    v_lshlrev_b32 v244, 16, v66
    v_and_b32 v245, 4294901760, v66
    v_lshlrev_b32 v246, 16, v67
    v_and_b32 v247, 4294901760, v67
    s_waitcnt vmcnt(30)
    v_lshlrev_b32 v232, 16, v68
    v_and_b32 v233, 4294901760, v68
    v_lshlrev_b32 v234, 16, v69
    v_and_b32 v235, 4294901760, v69
    v_lshlrev_b32 v236, 16, v70
    v_and_b32 v237, 4294901760, v70
    v_lshlrev_b32 v238, 16, v71
    v_and_b32 v239, 4294901760, v71
    v_pk_add_f32 v[240:241], v[240:241], v[232:233]
    v_pk_add_f32 v[242:243], v[242:243], v[234:235]
    v_pk_add_f32 v[244:245], v[244:245], v[236:237]
    v_pk_add_f32 v[246:247], v[246:247], v[238:239]
    s_waitcnt vmcnt(29)
    v_lshlrev_b32 v232, 16, v72
    v_and_b32 v233, 4294901760, v72
    v_lshlrev_b32 v234, 16, v73
    v_and_b32 v235, 4294901760, v73
    v_lshlrev_b32 v236, 16, v74
    v_and_b32 v237, 4294901760, v74
    v_lshlrev_b32 v238, 16, v75
    v_and_b32 v239, 4294901760, v75
    v_pk_add_f32 v[240:241], v[240:241], v[232:233]
    v_pk_add_f32 v[242:243], v[242:243], v[234:235]
    v_pk_add_f32 v[244:245], v[244:245], v[236:237]
    v_pk_add_f32 v[246:247], v[246:247], v[238:239]
    s_waitcnt vmcnt(28)
    v_lshlrev_b32 v232, 16, v76
    v_and_b32 v233, 4294901760, v76
    v_lshlrev_b32 v234, 16, v77
    v_and_b32 v235, 4294901760, v77
    v_lshlrev_b32 v236, 16, v78
    v_and_b32 v237, 4294901760, v78
    v_lshlrev_b32 v238, 16, v79
    v_and_b32 v239, 4294901760, v79
    v_pk_add_f32 v[240:241], v[240:241], v[232:233]
    v_pk_add_f32 v[242:243], v[242:243], v[234:235]
    v_pk_add_f32 v[244:245], v[244:245], v[236:237]
    v_pk_add_f32 v[246:247], v[246:247], v[238:239]
    s_waitcnt vmcnt(27)
    v_lshlrev_b32 v232, 16, v80
    v_and_b32 v233, 4294901760, v80
    v_lshlrev_b32 v234, 16, v81
    v_and_b32 v235, 4294901760, v81
    v_lshlrev_b32 v236, 16, v82
    v_and_b32 v237, 4294901760, v82
    v_lshlrev_b32 v238, 16, v83
    v_and_b32 v239, 4294901760, v83
    v_pk_add_f32 v[240:241], v[240:241], v[232:233]
    v_pk_add_f32 v[242:243], v[242:243], v[234:235]
    v_pk_add_f32 v[244:245], v[244:245], v[236:237]
    v_pk_add_f32 v[246:247], v[246:247], v[238:239]
    s_waitcnt vmcnt(26)
    v_lshlrev_b32 v232, 16, v84
    v_and_b32 v233, 4294901760, v84
    v_lshlrev_b32 v234, 16, v85
    v_and_b32 v235, 4294901760, v85
    v_lshlrev_b32 v236, 16, v86
    v_and_b32 v237, 4294901760, v86
    v_lshlrev_b32 v238, 16, v87
    v_and_b32 v239, 4294901760, v87
    v_pk_add_f32 v[240:241], v[240:241], v[232:233]
    v_pk_add_f32 v[242:243], v[242:243], v[234:235]
    v_pk_add_f32 v[244:245], v[244:245], v[236:237]
    v_pk_add_f32 v[246:247], v[246:247], v[238:239]
    s_waitcnt vmcnt(25)
    v_lshlrev_b32 v232, 16, v96
    v_and_b32 v233, 4294901760, v96
    v_lshlrev_b32 v234, 16, v97
    v_and_b32 v235, 4294901760, v97
    v_lshlrev_b32 v236, 16, v98
    v_and_b32 v237, 4294901760, v98
    v_lshlrev_b32 v238, 16, v99
    v_and_b32 v239, 4294901760, v99
    v_pk_add_f32 v[240:241], v[240:241], v[232:233]
    v_pk_add_f32 v[242:243], v[242:243], v[234:235]
    v_pk_add_f32 v[244:245], v[244:245], v[236:237]
    v_pk_add_f32 v[246:247], v[246:247], v[238:239]
    s_waitcnt vmcnt(24)
    v_lshlrev_b32 v232, 16, v100
    v_and_b32 v233, 4294901760, v100
    v_lshlrev_b32 v234, 16, v101
    v_and_b32 v235, 4294901760, v101
    v_lshlrev_b32 v236, 16, v102
    v_and_b32 v237, 4294901760, v102
    v_lshlrev_b32 v238, 16, v103
    v_and_b32 v239, 4294901760, v103
    v_pk_add_f32 v[240:241], v[240:241], v[232:233]
    v_pk_add_f32 v[242:243], v[242:243], v[234:235]
    v_pk_add_f32 v[244:245], v[244:245], v[236:237]
    v_pk_add_f32 v[246:247], v[246:247], v[238:239]
    v_cvt_pk_bf16_f32 v64, v240, v241
    v_cvt_pk_bf16_f32 v65, v242, v243
    v_cvt_pk_bf16_f32 v66, v244, v245
    v_cvt_pk_bf16_f32 v67, v246, v247
    buffer_store_dwordx2 v[64:65], v12, s[8:11], s51 offen offset:0
    buffer_store_dwordx2 v[66:67], v12, s[8:11], s51 offen offset:32
    s_waitcnt vmcnt(25)
    v_lshlrev_b32 v240, 16, v104
    v_and_b32 v241, 4294901760, v104
    v_lshlrev_b32 v242, 16, v105
    v_and_b32 v243, 4294901760, v105
    v_lshlrev_b32 v244, 16, v106
    v_and_b32 v245, 4294901760, v106
    v_lshlrev_b32 v246, 16, v107
    v_and_b32 v247, 4294901760, v107
    s_waitcnt vmcnt(24)
    v_lshlrev_b32 v232, 16, v108
    v_and_b32 v233, 4294901760, v108
    v_lshlrev_b32 v234, 16, v109
    v_and_b32 v235, 4294901760, v109
    v_lshlrev_b32 v236, 16, v110
    v_and_b32 v237, 4294901760, v110
    v_lshlrev_b32 v238, 16, v111
    v_and_b32 v239, 4294901760, v111
    v_pk_add_f32 v[240:241], v[240:241], v[232:233]
    v_pk_add_f32 v[242:243], v[242:243], v[234:235]
    v_pk_add_f32 v[244:245], v[244:245], v[236:237]
    v_pk_add_f32 v[246:247], v[246:247], v[238:239]
    s_waitcnt vmcnt(23)
    v_lshlrev_b32 v232, 16, v112
    v_and_b32 v233, 4294901760, v112
    v_lshlrev_b32 v234, 16, v113
    v_and_b32 v235, 4294901760, v113
    v_lshlrev_b32 v236, 16, v114
    v_and_b32 v237, 4294901760, v114
    v_lshlrev_b32 v238, 16, v115
    v_and_b32 v239, 4294901760, v115
    v_pk_add_f32 v[240:241], v[240:241], v[232:233]
    v_pk_add_f32 v[242:243], v[242:243], v[234:235]
    v_pk_add_f32 v[244:245], v[244:245], v[236:237]
    v_pk_add_f32 v[246:247], v[246:247], v[238:239]
    s_waitcnt vmcnt(22)
    v_lshlrev_b32 v232, 16, v116
    v_and_b32 v233, 4294901760, v116
    v_lshlrev_b32 v234, 16, v117
    v_and_b32 v235, 4294901760, v117
    v_lshlrev_b32 v236, 16, v118
    v_and_b32 v237, 4294901760, v118
    v_lshlrev_b32 v238, 16, v119
    v_and_b32 v239, 4294901760, v119
    v_pk_add_f32 v[240:241], v[240:241], v[232:233]
    v_pk_add_f32 v[242:243], v[242:243], v[234:235]
    v_pk_add_f32 v[244:245], v[244:245], v[236:237]
    v_pk_add_f32 v[246:247], v[246:247], v[238:239]
    s_waitcnt vmcnt(21)
    v_lshlrev_b32 v232, 16, v128
    v_and_b32 v233, 4294901760, v128
    v_lshlrev_b32 v234, 16, v129
    v_and_b32 v235, 4294901760, v129
    v_lshlrev_b32 v236, 16, v130
    v_and_b32 v237, 4294901760, v130
    v_lshlrev_b32 v238, 16, v131
    v_and_b32 v239, 4294901760, v131
    v_pk_add_f32 v[240:241], v[240:241], v[232:233]
    v_pk_add_f32 v[242:243], v[242:243], v[234:235]
    v_pk_add_f32 v[244:245], v[244:245], v[236:237]
    v_pk_add_f32 v[246:247], v[246:247], v[238:239]
    s_waitcnt vmcnt(20)
    v_lshlrev_b32 v232, 16, v132
    v_and_b32 v233, 4294901760, v132
    v_lshlrev_b32 v234, 16, v133
    v_and_b32 v235, 4294901760, v133
    v_lshlrev_b32 v236, 16, v134
    v_and_b32 v237, 4294901760, v134
    v_lshlrev_b32 v238, 16, v135
    v_and_b32 v239, 4294901760, v135
    v_pk_add_f32 v[240:241], v[240:241], v[232:233]
    v_pk_add_f32 v[242:243], v[242:243], v[234:235]
    v_pk_add_f32 v[244:245], v[244:245], v[236:237]
    v_pk_add_f32 v[246:247], v[246:247], v[238:239]
    s_waitcnt vmcnt(19)
    v_lshlrev_b32 v232, 16, v136
    v_and_b32 v233, 4294901760, v136
    v_lshlrev_b32 v234, 16, v137
    v_and_b32 v235, 4294901760, v137
    v_lshlrev_b32 v236, 16, v138
    v_and_b32 v237, 4294901760, v138
    v_lshlrev_b32 v238, 16, v139
    v_and_b32 v239, 4294901760, v139
    v_pk_add_f32 v[240:241], v[240:241], v[232:233]
    v_pk_add_f32 v[242:243], v[242:243], v[234:235]
    v_pk_add_f32 v[244:245], v[244:245], v[236:237]
    v_pk_add_f32 v[246:247], v[246:247], v[238:239]
    s_waitcnt vmcnt(18)
    v_lshlrev_b32 v232, 16, v140
    v_and_b32 v233, 4294901760, v140
    v_lshlrev_b32 v234, 16, v141
    v_and_b32 v235, 4294901760, v141
    v_lshlrev_b32 v236, 16, v142
    v_and_b32 v237, 4294901760, v142
    v_lshlrev_b32 v238, 16, v143
    v_and_b32 v239, 4294901760, v143
    v_pk_add_f32 v[240:241], v[240:241], v[232:233]
    v_pk_add_f32 v[242:243], v[242:243], v[234:235]
    v_pk_add_f32 v[244:245], v[244:245], v[236:237]
    v_pk_add_f32 v[246:247], v[246:247], v[238:239]
    v_cvt_pk_bf16_f32 v104, v240, v241
    v_cvt_pk_bf16_f32 v105, v242, v243
    v_cvt_pk_bf16_f32 v106, v244, v245
    v_cvt_pk_bf16_f32 v107, v246, v247
    buffer_store_dwordx2 v[104:105], v12, s[8:11], s51 offen offset:64
    buffer_store_dwordx2 v[106:107], v12, s[8:11], s51 offen offset:96
    s_waitcnt vmcnt(19)
    v_lshlrev_b32 v240, 16, v144
    v_and_b32 v241, 4294901760, v144
    v_lshlrev_b32 v242, 16, v145
    v_and_b32 v243, 4294901760, v145
    v_lshlrev_b32 v244, 16, v146
    v_and_b32 v245, 4294901760, v146
    v_lshlrev_b32 v246, 16, v147
    v_and_b32 v247, 4294901760, v147
    s_waitcnt vmcnt(18)
    v_lshlrev_b32 v232, 16, v148
    v_and_b32 v233, 4294901760, v148
    v_lshlrev_b32 v234, 16, v149
    v_and_b32 v235, 4294901760, v149
    v_lshlrev_b32 v236, 16, v150
    v_and_b32 v237, 4294901760, v150
    v_lshlrev_b32 v238, 16, v151
    v_and_b32 v239, 4294901760, v151
    v_pk_add_f32 v[240:241], v[240:241], v[232:233]
    v_pk_add_f32 v[242:243], v[242:243], v[234:235]
    v_pk_add_f32 v[244:245], v[244:245], v[236:237]
    v_pk_add_f32 v[246:247], v[246:247], v[238:239]
    s_waitcnt vmcnt(17)
    v_lshlrev_b32 v232, 16, v160
    v_and_b32 v233, 4294901760, v160
    v_lshlrev_b32 v234, 16, v161
    v_and_b32 v235, 4294901760, v161
    v_lshlrev_b32 v236, 16, v162
    v_and_b32 v237, 4294901760, v162
    v_lshlrev_b32 v238, 16, v163
    v_and_b32 v239, 4294901760, v163
    v_pk_add_f32 v[240:241], v[240:241], v[232:233]
    v_pk_add_f32 v[242:243], v[242:243], v[234:235]
    v_pk_add_f32 v[244:245], v[244:245], v[236:237]
    v_pk_add_f32 v[246:247], v[246:247], v[238:239]
    s_waitcnt vmcnt(16)
    v_lshlrev_b32 v232, 16, v164
    v_and_b32 v233, 4294901760, v164
    v_lshlrev_b32 v234, 16, v165
    v_and_b32 v235, 4294901760, v165
    v_lshlrev_b32 v236, 16, v166
    v_and_b32 v237, 4294901760, v166
    v_lshlrev_b32 v238, 16, v167
    v_and_b32 v239, 4294901760, v167
    v_pk_add_f32 v[240:241], v[240:241], v[232:233]
    v_pk_add_f32 v[242:243], v[242:243], v[234:235]
    v_pk_add_f32 v[244:245], v[244:245], v[236:237]
    v_pk_add_f32 v[246:247], v[246:247], v[238:239]
    s_waitcnt vmcnt(15)
    v_lshlrev_b32 v232, 16, v168
    v_and_b32 v233, 4294901760, v168
    v_lshlrev_b32 v234, 16, v169
    v_and_b32 v235, 4294901760, v169
    v_lshlrev_b32 v236, 16, v170
    v_and_b32 v237, 4294901760, v170
    v_lshlrev_b32 v238, 16, v171
    v_and_b32 v239, 4294901760, v171
    v_pk_add_f32 v[240:241], v[240:241], v[232:233]
    v_pk_add_f32 v[242:243], v[242:243], v[234:235]
    v_pk_add_f32 v[244:245], v[244:245], v[236:237]
    v_pk_add_f32 v[246:247], v[246:247], v[238:239]
    s_waitcnt vmcnt(14)
    v_lshlrev_b32 v232, 16, v172
    v_and_b32 v233, 4294901760, v172
    v_lshlrev_b32 v234, 16, v173
    v_and_b32 v235, 4294901760, v173
    v_lshlrev_b32 v236, 16, v174
    v_and_b32 v237, 4294901760, v174
    v_lshlrev_b32 v238, 16, v175
    v_and_b32 v239, 4294901760, v175
    v_pk_add_f32 v[240:241], v[240:241], v[232:233]
    v_pk_add_f32 v[242:243], v[242:243], v[234:235]
    v_pk_add_f32 v[244:245], v[244:245], v[236:237]
    v_pk_add_f32 v[246:247], v[246:247], v[238:239]
    s_waitcnt vmcnt(13)
    v_lshlrev_b32 v232, 16, v176
    v_and_b32 v233, 4294901760, v176
    v_lshlrev_b32 v234, 16, v177
    v_and_b32 v235, 4294901760, v177
    v_lshlrev_b32 v236, 16, v178
    v_and_b32 v237, 4294901760, v178
    v_lshlrev_b32 v238, 16, v179
    v_and_b32 v239, 4294901760, v179
    v_pk_add_f32 v[240:241], v[240:241], v[232:233]
    v_pk_add_f32 v[242:243], v[242:243], v[234:235]
    v_pk_add_f32 v[244:245], v[244:245], v[236:237]
    v_pk_add_f32 v[246:247], v[246:247], v[238:239]
    s_waitcnt vmcnt(12)
    v_lshlrev_b32 v232, 16, v180
    v_and_b32 v233, 4294901760, v180
    v_lshlrev_b32 v234, 16, v181
    v_and_b32 v235, 4294901760, v181
    v_lshlrev_b32 v236, 16, v182
    v_and_b32 v237, 4294901760, v182
    v_lshlrev_b32 v238, 16, v183
    v_and_b32 v239, 4294901760, v183
    v_pk_add_f32 v[240:241], v[240:241], v[232:233]
    v_pk_add_f32 v[242:243], v[242:243], v[234:235]
    v_pk_add_f32 v[244:245], v[244:245], v[236:237]
    v_pk_add_f32 v[246:247], v[246:247], v[238:239]
    v_cvt_pk_bf16_f32 v144, v240, v241
    v_cvt_pk_bf16_f32 v145, v242, v243
    v_cvt_pk_bf16_f32 v146, v244, v245
    v_cvt_pk_bf16_f32 v147, v246, v247
    buffer_store_dwordx2 v[144:145], v12, s[8:11], s51 offen offset:128
    buffer_store_dwordx2 v[146:147], v12, s[8:11], s51 offen offset:160
    s_waitcnt vmcnt(13)
    v_lshlrev_b32 v240, 16, v192
    v_and_b32 v241, 4294901760, v192
    v_lshlrev_b32 v242, 16, v193
    v_and_b32 v243, 4294901760, v193
    v_lshlrev_b32 v244, 16, v194
    v_and_b32 v245, 4294901760, v194
    v_lshlrev_b32 v246, 16, v195
    v_and_b32 v247, 4294901760, v195
    s_waitcnt vmcnt(12)
    v_lshlrev_b32 v232, 16, v196
    v_and_b32 v233, 4294901760, v196
    v_lshlrev_b32 v234, 16, v197
    v_and_b32 v235, 4294901760, v197
    v_lshlrev_b32 v236, 16, v198
    v_and_b32 v237, 4294901760, v198
    v_lshlrev_b32 v238, 16, v199
    v_and_b32 v239, 4294901760, v199
    v_pk_add_f32 v[240:241], v[240:241], v[232:233]
    v_pk_add_f32 v[242:243], v[242:243], v[234:235]
    v_pk_add_f32 v[244:245], v[244:245], v[236:237]
    v_pk_add_f32 v[246:247], v[246:247], v[238:239]
    s_waitcnt vmcnt(11)
    v_lshlrev_b32 v232, 16, v200
    v_and_b32 v233, 4294901760, v200
    v_lshlrev_b32 v234, 16, v201
    v_and_b32 v235, 4294901760, v201
    v_lshlrev_b32 v236, 16, v202
    v_and_b32 v237, 4294901760, v202
    v_lshlrev_b32 v238, 16, v203
    v_and_b32 v239, 4294901760, v203
    v_pk_add_f32 v[240:241], v[240:241], v[232:233]
    v_pk_add_f32 v[242:243], v[242:243], v[234:235]
    v_pk_add_f32 v[244:245], v[244:245], v[236:237]
    v_pk_add_f32 v[246:247], v[246:247], v[238:239]
    s_waitcnt vmcnt(10)
    v_lshlrev_b32 v232, 16, v204
    v_and_b32 v233, 4294901760, v204
    v_lshlrev_b32 v234, 16, v205
    v_and_b32 v235, 4294901760, v205
    v_lshlrev_b32 v236, 16, v206
    v_and_b32 v237, 4294901760, v206
    v_lshlrev_b32 v238, 16, v207
    v_and_b32 v239, 4294901760, v207
    v_pk_add_f32 v[240:241], v[240:241], v[232:233]
    v_pk_add_f32 v[242:243], v[242:243], v[234:235]
    v_pk_add_f32 v[244:245], v[244:245], v[236:237]
    v_pk_add_f32 v[246:247], v[246:247], v[238:239]
    s_waitcnt vmcnt(9)
    v_lshlrev_b32 v232, 16, v208
    v_and_b32 v233, 4294901760, v208
    v_lshlrev_b32 v234, 16, v209
    v_and_b32 v235, 4294901760, v209
    v_lshlrev_b32 v236, 16, v210
    v_and_b32 v237, 4294901760, v210
    v_lshlrev_b32 v238, 16, v211
    v_and_b32 v239, 4294901760, v211
    v_pk_add_f32 v[240:241], v[240:241], v[232:233]
    v_pk_add_f32 v[242:243], v[242:243], v[234:235]
    v_pk_add_f32 v[244:245], v[244:245], v[236:237]
    v_pk_add_f32 v[246:247], v[246:247], v[238:239]
    s_waitcnt vmcnt(8)
    v_lshlrev_b32 v232, 16, v212
    v_and_b32 v233, 4294901760, v212
    v_lshlrev_b32 v234, 16, v213
    v_and_b32 v235, 4294901760, v213
    v_lshlrev_b32 v236, 16, v214
    v_and_b32 v237, 4294901760, v214
    v_lshlrev_b32 v238, 16, v215
    v_and_b32 v239, 4294901760, v215
    v_pk_add_f32 v[240:241], v[240:241], v[232:233]
    v_pk_add_f32 v[242:243], v[242:243], v[234:235]
    v_pk_add_f32 v[244:245], v[244:245], v[236:237]
    v_pk_add_f32 v[246:247], v[246:247], v[238:239]
    s_waitcnt vmcnt(7)
    v_lshlrev_b32 v232, 16, v224
    v_and_b32 v233, 4294901760, v224
    v_lshlrev_b32 v234, 16, v225
    v_and_b32 v235, 4294901760, v225
    v_lshlrev_b32 v236, 16, v226
    v_and_b32 v237, 4294901760, v226
    v_lshlrev_b32 v238, 16, v227
    v_and_b32 v239, 4294901760, v227
    v_pk_add_f32 v[240:241], v[240:241], v[232:233]
    v_pk_add_f32 v[242:243], v[242:243], v[234:235]
    v_pk_add_f32 v[244:245], v[244:245], v[236:237]
    v_pk_add_f32 v[246:247], v[246:247], v[238:239]
    s_waitcnt vmcnt(6)
    v_lshlrev_b32 v232, 16, v228
    v_and_b32 v233, 4294901760, v228
    v_lshlrev_b32 v234, 16, v229
    v_and_b32 v235, 4294901760, v229
    v_lshlrev_b32 v236, 16, v230
    v_and_b32 v237, 4294901760, v230
    v_lshlrev_b32 v238, 16, v231
    v_and_b32 v239, 4294901760, v231
    v_pk_add_f32 v[240:241], v[240:241], v[232:233]
    v_pk_add_f32 v[242:243], v[242:243], v[234:235]
    v_pk_add_f32 v[244:245], v[244:245], v[236:237]
    v_pk_add_f32 v[246:247], v[246:247], v[238:239]
    v_cvt_pk_bf16_f32 v192, v240, v241
    v_cvt_pk_bf16_f32 v193, v242, v243
    v_cvt_pk_bf16_f32 v194, v244, v245
    v_cvt_pk_bf16_f32 v195, v246, v247
    buffer_store_dwordx2 v[192:193], v12, s[8:11], s51 offen offset:192
    buffer_store_dwordx2 v[194:195], v12, s[8:11], s51 offen offset:224
    s_cmp_lg_u32 s59, 0
    s_cbranch_scc1 L_redo
    s_branch L_fin

.section .rodata,"a"
.p2align 6
.amdhsa_kernel standalone__gqa_block_cached__near_ridge_kernel
  .amdhsa_next_free_vgpr 512
  .amdhsa_next_free_sgpr 102
  .amdhsa_accum_offset 256
  .amdhsa_group_segment_fixed_size 0
  .amdhsa_kernarg_size 64
  .amdhsa_user_sgpr_count 2
  .amdhsa_user_sgpr_kernarg_segment_ptr 1
  .amdhsa_system_sgpr_workgroup_id_x 1
.end_amdhsa_kernel
```
